```python
import torch

def _softmax(x, axis=-1):
    return torch.softmax(x, dim=axis)
def _gelu(x):
    return torch.nn.functional.gelu(x, approximate="tanh")
def _silu(x):
    return torch.nn.functional.silu(x)
def _sigmoid(x):
    return torch.sigmoid(x)
def _layernorm(x, axis=-1, eps=1e-5):
    m = x.mean(dim=axis, keepdim=True)
    v = x.var(dim=axis, keepdim=True, unbiased=False)
    return (x - m) / torch.sqrt(v + eps)
def _scatter_add(tgt, idx, src, axis=0):
    return tgt.clone().index_add_(axis, idx, src)
def _segment_sum(src, seg, n):
    out = torch.zeros((n,) + src.shape[1:], dtype=src.dtype)
    return out.index_add_(0, seg, src)
def _pad(x, pw):
    flat = tuple(v for pair in reversed(pw) for v in pair)
    return torch.nn.functional.pad(x, flat)

kernel_name = 'concat_heads__mha_block_cached__mha_block_cached__near_ridge'

def setup_inputs():

    _w = (lambda a: (lambda t: t.to(torch.bfloat16) if t.is_floating_point() else t)(torch.as_tensor(a)))
    def _A_setup():
        B, Sq, D = 8, 144, 512
        H, Sk, Dh = 32, 512, 128
        return {
            "x": _w((lambda *s: torch.randn(*s, dtype=torch.bfloat16) * 0.8)(B, Sq, D)),
            "k_cache": _w((lambda *s: torch.randn(*s, dtype=torch.bfloat16) * 0.8)(B, H, Sk, Dh)),
            "v_cache": _w((lambda *s: torch.randn(*s, dtype=torch.bfloat16) * 0.05)(B, H, Sk, Dh)),
            "wq": _w((lambda *s: torch.randn(*s, dtype=torch.bfloat16) * 0.8)(D, H * Dh) * (D ** -0.5)),
            "wo": _w((lambda *s: torch.randn(*s, dtype=torch.bfloat16) * 0.05)(H * Dh, D) * ((H * Dh) ** -0.5)),
        }
    _A_in = _A_setup()

    def _B_setup():
        B, Sq, D = 8, 144, 512
        H, Sk, Dh = 32, 512, 128
        return {
            "x": _w((lambda *s: torch.randn(*s, dtype=torch.bfloat16) * 0.8)(B, Sq, D)),
            "k_cache": _w((lambda *s: torch.randn(*s, dtype=torch.bfloat16) * 0.8)(B, H, Sk, Dh)),
            "v_cache": _w((lambda *s: torch.randn(*s, dtype=torch.bfloat16) * 0.05)(B, H, Sk, Dh)),
            "wq": _w((lambda *s: torch.randn(*s, dtype=torch.bfloat16) * 0.8)(D, H * Dh) * (D ** -0.5)),
            "wo": _w((lambda *s: torch.randn(*s, dtype=torch.bfloat16) * 0.05)(H * Dh, D) * ((H * Dh) ** -0.5)),
        }
    _B_in = _B_setup()

    return {
        "A_x": _A_in["x"],
        "A_k_cache": _A_in["k_cache"],
        "A_v_cache": _A_in["v_cache"],
        "A_wq": _A_in["wq"],
        "A_wo": _A_in["wo"],
        "B_x": _B_in["x"],
        "B_k_cache": _B_in["k_cache"],
        "B_v_cache": _B_in["v_cache"],
        "B_wq": _B_in["wq"],
        "B_wo": _B_in["wo"],
    }

def reference(A_x, A_k_cache, A_v_cache, A_wq, A_wo, B_x, B_k_cache, B_v_cache, B_wq, B_wo):
    def _A_ref(x, k_cache, v_cache, wq, wo):
        B, Sq, D = x.shape
        H, Dh = 32, 128
        q = (lambda x, *d: x.permute(*d))((x @ wq).reshape(B, Sq, H, Dh), 0, 2, 1, 3)
        scores = torch.einsum("bhqd,bhkd->bhqk", q, k_cache) * (Dh ** -0.5)
        p = _softmax(scores, axis=-1)
        o = torch.einsum("bhqk,bhkd->bhqd", p, v_cache)
        return (lambda x, *d: x.permute(*d))(o, 0, 2, 1, 3).reshape(B, Sq, H * Dh) @ wo

    def _B_ref(x, k_cache, v_cache, wq, wo):
        B, Sq, D = x.shape
        H, Dh = 32, 128
        q = (lambda x, *d: x.permute(*d))((x @ wq).reshape(B, Sq, H, Dh), 0, 2, 1, 3)
        scores = torch.einsum("bhqd,bhkd->bhqk", q, k_cache) * (Dh ** -0.5)
        p = _softmax(scores, axis=-1)
        o = torch.einsum("bhqk,bhkd->bhqd", p, v_cache)
        return (lambda x, *d: x.permute(*d))(o, 0, 2, 1, 3).reshape(B, Sq, H * Dh) @ wo

    a = _A_ref(A_x, A_k_cache, A_v_cache, A_wq, A_wo)
    b = _B_ref(B_x, B_k_cache, B_v_cache, B_wq, B_wo)
    return torch.concatenate([a, b], axis=-1)
```

```asm
; @launch kernel=attn_kernel grid=(512,1,1) block=(128,1,1) lds=81920
; @launch kernel=oproj_kernel grid=(256,1,1) block=(256,1,1) lds=139264
; @launch kernel=reduce_kernel grid=(576,1,1) block=(256,1,1) lds=0
.amdgcn_target "amdgcn-amd-amdhsa--gfx950"
.text
.globl attn_kernel
.p2align 8
.type attn_kernel,@function
attn_kernel:
    s_cmp_ge_u32 s2, 512
    s_cbranch_scc1 attn_kernel_done
    s_load_dwordx8 s[4:11], s[0:1], 0
    s_load_dwordx8 s[40:47], s[0:1], 40
    s_load_dwordx2 s[12:13], s[0:1], 96
    v_and_b32 v10, 63, v0
    v_lshrrev_b32 v14, 6, v0
    v_lshrrev_b32 v11, 4, v10
    v_and_b32 v12, 15, v10
    v_readfirstlane_b32 s36, v14
    s_waitcnt lgkmcnt(0)
    s_lshr_b32 s38, s2, 2
    s_and_b32 s38, s38, 1
    s_cmp_eq_u32 s38, 0
    s_cselect_b32 s4, s4, s40
    s_cselect_b32 s5, s5, s41
    s_cselect_b32 s6, s6, s42
    s_cselect_b32 s7, s7, s43
    s_cselect_b32 s8, s8, s44
    s_cselect_b32 s9, s9, s45
    s_cselect_b32 s10, s10, s46
    s_cselect_b32 s11, s11, s47
    s_lshr_b32 s39, s2, 7
    s_and_b32 s51, s2, 2
    s_lshl_b32 s51, s51, 1
    s_add_u32 s39, s39, s51
    s_lshr_b32 s53, s2, 3
    s_and_b32 s53, s53, 15
    s_and_b32 s51, s2, 1
    s_lshl_b32 s51, s51, 4
    s_add_u32 s53, s53, s51
    s_mul_i32 s51, s39, 147456
    s_add_u32 s16, s4, s51
    s_addc_u32 s17, s5, 0
    s_mov_b32 s18, 147456
    s_mov_b32 s19, 0x00020000
    s_mov_b32 s20, s10
    s_mov_b32 s21, s11
    s_mov_b32 s22, 4194304
    s_mov_b32 s23, 0x00020000
    s_lshl_b32 s52, s39, 5
    s_add_u32 s52, s52, s53
    s_lshl_b32 s51, s52, 17
    s_add_u32 s24, s6, s51
    s_addc_u32 s25, s7, 0
    s_mov_b32 s26, 131072
    s_mov_b32 s27, 0x00020000
    s_add_u32 s28, s8, s51
    s_addc_u32 s29, s9, 0
    s_mov_b32 s30, 131072
    s_mov_b32 s31, 0x00020000
    s_mul_i32 s51, s38, 9437184
    s_mul_i32 s52, s52, 36864
    s_add_u32 s51, s51, s52
    s_add_u32 s32, s12, s51
    s_addc_u32 s33, s13, 0
    s_mov_b32 s34, 36864
    s_mov_b32 s35, 0x00020000
    s_lshl_b32 s48, s53, 8
    s_mov_b32 s37, 0x3e0293ee
    s_lshl_b32 s49, s36, 10
    s_lshl_b32 s51, s36, 2
    v_add_u32 v14, s51, v11
    v_xor_b32 v15, v12, v14
    v_lshlrev_b32 v15, 4, v15
    v_lshl_add_u32 v116, v14, 8, v15
    v_add_u32 v16, 8, v14
    v_xor_b32 v15, v12, v16
    v_lshlrev_b32 v15, 4, v15
    v_lshl_add_u32 v117, v16, 8, v15
    v_lshlrev_b32 v15, 1, v14
    v_xor_b32 v15, v12, v15
    v_lshlrev_b32 v15, 4, v15
    v_lshl_add_u32 v118, v14, 8, v15
    s_mov_b32 s57, 0
    s_mov_b32 s58, 0
    s_lshl_b32 s61, s36, 1
    s_lshl_b32 s62, s36, 13
    s_xor_b32 s51, s61, 0
    s_lshl_b32 s51, s51, 2
    v_add_u32 v14, s51, v11
    v_xor_b32 v14, v14, v12
    v_lshlrev_b32 v14, 4, v14
    v_lshl_add_u32 v14, v12, 8, v14
    v_add_u32 v14, 16384, v14
    v_add_u32 v208, s62, v14
    v_subrev_u32 v212, s62, v14
    s_xor_b32 s51, s61, 1
    s_lshl_b32 s51, s51, 2
    v_add_u32 v14, s51, v11
    v_xor_b32 v14, v14, v12
    v_lshlrev_b32 v14, 4, v14
    v_lshl_add_u32 v14, v12, 8, v14
    v_add_u32 v14, 16384, v14
    v_add_u32 v209, s62, v14
    v_subrev_u32 v213, s62, v14
    s_xor_b32 s51, s61, 2
    s_lshl_b32 s51, s51, 2
    v_add_u32 v14, s51, v11
    v_xor_b32 v14, v14, v12
    v_lshlrev_b32 v14, 4, v14
    v_lshl_add_u32 v14, v12, 8, v14
    v_add_u32 v14, 16384, v14
    v_add_u32 v210, s62, v14
    v_subrev_u32 v214, s62, v14
    s_xor_b32 s51, s61, 3
    s_lshl_b32 s51, s51, 2
    v_add_u32 v14, s51, v11
    v_xor_b32 v14, v14, v12
    v_lshlrev_b32 v14, 4, v14
    v_lshl_add_u32 v14, v12, 8, v14
    v_add_u32 v14, 16384, v14
    v_add_u32 v211, s62, v14
    v_subrev_u32 v215, s62, v14
    v_lshrrev_b32 v14, 2, v12
    v_lshl_add_u32 v14, v11, 2, v14
    v_and_b32 v15, 7, v14
    v_and_b32 v16, 3, v12
    v_lshlrev_b32 v16, 3, v16
    v_lshl_add_u32 v16, v14, 8, v16
    v_add_u32 v16, 16384, v16
    v_xor_b32 v14, 0, v15
    v_lshl_add_u32 v14, v14, 5, v16
    v_add_u32 v216, s62, v14
    v_subrev_u32 v224, s62, v14
    v_xor_b32 v14, 1, v15
    v_lshl_add_u32 v14, v14, 5, v16
    v_add_u32 v217, s62, v14
    v_subrev_u32 v225, s62, v14
    v_xor_b32 v14, 2, v15
    v_lshl_add_u32 v14, v14, 5, v16
    v_add_u32 v218, s62, v14
    v_subrev_u32 v226, s62, v14
    v_xor_b32 v14, 3, v15
    v_lshl_add_u32 v14, v14, 5, v16
    v_add_u32 v219, s62, v14
    v_subrev_u32 v227, s62, v14
    v_xor_b32 v14, 4, v15
    v_lshl_add_u32 v14, v14, 5, v16
    v_add_u32 v220, s62, v14
    v_subrev_u32 v228, s62, v14
    v_xor_b32 v14, 5, v15
    v_lshl_add_u32 v14, v14, 5, v16
    v_add_u32 v221, s62, v14
    v_subrev_u32 v229, s62, v14
    v_xor_b32 v14, 6, v15
    v_lshl_add_u32 v14, v14, 5, v16
    v_add_u32 v222, s62, v14
    v_subrev_u32 v230, s62, v14
    v_xor_b32 v14, 7, v15
    v_lshl_add_u32 v14, v14, 5, v16
    v_add_u32 v223, s62, v14
    v_subrev_u32 v231, s62, v14
    v_lshrrev_b32 v14, 2, v12
    v_lshl_add_u32 v15, v11, 3, v14
    v_and_b32 v16, 3, v12
    v_lshlrev_b32 v16, 4, v16
    v_lshl_add_u32 v16, v15, 8, v16
    v_and_b32 v17, 1, v14
    v_lshrrev_b32 v18, 3, v12
    v_and_b32 v19, 1, v11
    v_lshl_add_u32 v18, v19, 1, v18
    s_xor_b32 s51, s61, 0
    v_xor_b32 v14, s51, v18
    v_lshl_add_u32 v14, v14, 6, v16
    v_xor_b32 v15, 0, v17
    v_lshl_add_u32 v176, v15, 3, v14
    s_xor_b32 s51, s61, 0
    v_xor_b32 v14, s51, v18
    v_lshl_add_u32 v14, v14, 6, v16
    v_xor_b32 v15, 1, v17
    v_lshl_add_u32 v177, v15, 3, v14
    s_xor_b32 s51, s61, 1
    v_xor_b32 v14, s51, v18
    v_lshl_add_u32 v14, v14, 6, v16
    v_xor_b32 v15, 0, v17
    v_lshl_add_u32 v178, v15, 3, v14
    s_xor_b32 s51, s61, 1
    v_xor_b32 v14, s51, v18
    v_lshl_add_u32 v14, v14, 6, v16
    v_xor_b32 v15, 1, v17
    v_lshl_add_u32 v179, v15, 3, v14
    s_xor_b32 s51, s61, 2
    v_xor_b32 v14, s51, v18
    v_lshl_add_u32 v14, v14, 6, v16
    v_xor_b32 v15, 0, v17
    v_lshl_add_u32 v180, v15, 3, v14
    s_xor_b32 s51, s61, 2
    v_xor_b32 v14, s51, v18
    v_lshl_add_u32 v14, v14, 6, v16
    v_xor_b32 v15, 1, v17
    v_lshl_add_u32 v181, v15, 3, v14
    s_xor_b32 s51, s61, 3
    v_xor_b32 v14, s51, v18
    v_lshl_add_u32 v14, v14, 6, v16
    v_xor_b32 v15, 0, v17
    v_lshl_add_u32 v182, v15, 3, v14
    s_xor_b32 s51, s61, 3
    v_xor_b32 v14, s51, v18
    v_lshl_add_u32 v14, v14, 6, v16
    v_xor_b32 v15, 1, v17
    v_lshl_add_u32 v183, v15, 3, v14
    s_lshl_b32 s51, s36, 4
    v_lshl_add_u32 v14, v11, 1, s51
    v_lshlrev_b32 v15, 2, v19
    v_xor_b32 v15, v15, v12
    v_lshlrev_b32 v15, 4, v15
    v_lshl_add_u32 v184, v14, 8, v15
    v_xor_b32 v16, 128, v184
    v_add_u32 v185, 2048, v16
    v_lshlrev_b32 v15, 4, v12
    v_lshl_add_u32 v190, v14, 13, v15
    v_lshrrev_b32 v14, 1, v12
    s_lshl_b32 s51, s36, 13
    v_add_u32 v15, 0, v11
    v_xor_b32 v15, v15, v14
    v_lshlrev_b32 v15, 4, v15
    v_lshl_add_u32 v15, v12, 7, v15
    v_add_u32 v15, 24576, v15
    v_add_u32 v186, s51, v15
    v_add_u32 v188, 16384, v15
    v_add_u32 v15, 4, v11
    v_xor_b32 v15, v15, v14
    v_lshlrev_b32 v15, 4, v15
    v_lshl_add_u32 v15, v12, 7, v15
    v_add_u32 v15, 24576, v15
    v_add_u32 v187, s51, v15
    v_add_u32 v189, 16384, v15
    v_lshrrev_b32 v14, 3, v10
    s_lshl_b32 s51, s36, 2
    v_add_u32 v15, s51, v11
    v_and_b32 v16, 7, v10
    v_xor_b32 v15, v15, v16
    v_lshlrev_b32 v15, 4, v15
    v_lshl_add_u32 v191, v14, 10, v15
    s_lshl_b32 s51, s36, 13
    v_add_u32 v191, s51, v191
    v_lshlrev_b32 v203, 7, v10
    s_lshl_b32 s51, s36, 13
    v_add_u32 v203, s51, v203
    s_add_u32 s51, s48, 0
    buffer_load_dwordx4 a[104:107], v190, s[20:23], s51 offen
    s_add_u32 s51, s48, 8192
    buffer_load_dwordx4 a[108:111], v190, s[20:23], s51 offen
    s_add_u32 s51, s48, 65536
    buffer_load_dwordx4 a[112:115], v190, s[20:23], s51 offen
    s_add_u32 s51, s48, 73728
    buffer_load_dwordx4 a[116:119], v190, s[20:23], s51 offen
    s_add_u32 s51, s48, 262144
    buffer_load_dwordx4 a[120:123], v190, s[20:23], s51 offen
    s_add_u32 s51, s48, 270336
    buffer_load_dwordx4 a[124:127], v190, s[20:23], s51 offen
    s_add_u32 s51, s48, 327680
    buffer_load_dwordx4 a[128:131], v190, s[20:23], s51 offen
    s_add_u32 s51, s48, 335872
    buffer_load_dwordx4 a[132:135], v190, s[20:23], s51 offen
    s_add_u32 m0, s49, 24576
    s_mov_b32 s52, 0
    buffer_load_dwordx4 v191, s[16:19], s52 offen lds
    s_add_u32 m0, s49, 26624
    s_mov_b32 s52, 16384
    buffer_load_dwordx4 v191, s[16:19], s52 offen lds
    s_add_u32 m0, s49, 28672
    s_mov_b32 s52, 32768
    buffer_load_dwordx4 v191, s[16:19], s52 offen lds
    s_add_u32 m0, s49, 30720
    s_mov_b32 s52, 49152
    buffer_load_dwordx4 v191, s[16:19], s52 offen lds
    s_add_u32 m0, s49, 32768
    s_mov_b32 s52, 65536
    buffer_load_dwordx4 v191, s[16:19], s52 offen lds
    s_add_u32 m0, s49, 34816
    s_mov_b32 s52, 81920
    buffer_load_dwordx4 v191, s[16:19], s52 offen lds
    s_add_u32 m0, s49, 36864
    s_mov_b32 s52, 98304
    buffer_load_dwordx4 v191, s[16:19], s52 offen lds
    s_add_u32 m0, s49, 38912
    s_mov_b32 s52, 114688
    buffer_load_dwordx4 v191, s[16:19], s52 offen lds
    s_add_u32 m0, s49, 40960
    s_mov_b32 s52, 131072
    buffer_load_dwordx4 v191, s[16:19], s52 offen lds
    s_add_u32 s51, s48, 524288
    buffer_load_dwordx4 a[136:139], v190, s[20:23], s51 offen
    s_add_u32 s51, s48, 532480
    buffer_load_dwordx4 a[140:143], v190, s[20:23], s51 offen
    s_add_u32 s51, s48, 589824
    buffer_load_dwordx4 a[144:147], v190, s[20:23], s51 offen
    s_add_u32 s51, s48, 598016
    buffer_load_dwordx4 a[148:151], v190, s[20:23], s51 offen
    s_add_u32 s51, s48, 786432
    buffer_load_dwordx4 a[152:155], v190, s[20:23], s51 offen
    s_add_u32 s51, s48, 794624
    buffer_load_dwordx4 a[156:159], v190, s[20:23], s51 offen
    s_add_u32 s51, s48, 851968
    buffer_load_dwordx4 a[160:163], v190, s[20:23], s51 offen
    s_add_u32 s51, s48, 860160
    buffer_load_dwordx4 a[164:167], v190, s[20:23], s51 offen
    s_add_u32 m0, s49, 43008
    s_mov_b32 s52, 128
    buffer_load_dwordx4 v191, s[16:19], s52 offen lds
    s_add_u32 m0, s49, 45056
    s_mov_b32 s52, 16512
    buffer_load_dwordx4 v191, s[16:19], s52 offen lds
    s_add_u32 m0, s49, 47104
    s_mov_b32 s52, 32896
    buffer_load_dwordx4 v191, s[16:19], s52 offen lds
    s_add_u32 m0, s49, 49152
    s_mov_b32 s52, 49280
    buffer_load_dwordx4 v191, s[16:19], s52 offen lds
    s_add_u32 m0, s49, 51200
    s_mov_b32 s52, 65664
    buffer_load_dwordx4 v191, s[16:19], s52 offen lds
    s_add_u32 m0, s49, 53248
    s_mov_b32 s52, 82048
    buffer_load_dwordx4 v191, s[16:19], s52 offen lds
    s_add_u32 m0, s49, 55296
    s_mov_b32 s52, 98432
    buffer_load_dwordx4 v191, s[16:19], s52 offen lds
    s_add_u32 m0, s49, 57344
    s_mov_b32 s52, 114816
    buffer_load_dwordx4 v191, s[16:19], s52 offen lds
    s_add_u32 m0, s49, 59392
    s_mov_b32 s52, 131200
    buffer_load_dwordx4 v191, s[16:19], s52 offen lds
    v_mov_b32 v0, 0
    v_mov_b32 v1, 0
    v_mov_b32 v2, 0
    v_mov_b32 v3, 0
    v_mov_b32 v4, 0
    v_mov_b32 v5, 0
    v_mov_b32 v6, 0
    v_mov_b32 v7, 0
    v_mov_b32 v8, 0
    v_mov_b32 v9, 0
    v_mov_b32 v10, 0
    v_mov_b32 v11, 0
    v_mov_b32 v12, 0
    v_mov_b32 v13, 0
    v_mov_b32 v14, 0
    v_mov_b32 v15, 0
    v_mov_b32 v16, 0
    v_mov_b32 v17, 0
    v_mov_b32 v18, 0
    v_mov_b32 v19, 0
    v_mov_b32 v20, 0
    v_mov_b32 v21, 0
    v_mov_b32 v22, 0
    v_mov_b32 v23, 0
    v_mov_b32 v24, 0
    v_mov_b32 v25, 0
    v_mov_b32 v26, 0
    v_mov_b32 v27, 0
    v_mov_b32 v28, 0
    v_mov_b32 v29, 0
    v_mov_b32 v30, 0
    v_mov_b32 v31, 0
    v_mov_b32 v32, 0
    v_mov_b32 v33, 0
    v_mov_b32 v34, 0
    v_mov_b32 v35, 0
    v_mov_b32 v36, 0
    v_mov_b32 v37, 0
    v_mov_b32 v38, 0
    v_mov_b32 v39, 0
    v_mov_b32 v40, 0
    v_mov_b32 v41, 0
    v_mov_b32 v42, 0
    v_mov_b32 v43, 0
    v_mov_b32 v44, 0
    v_mov_b32 v45, 0
    v_mov_b32 v46, 0
    v_mov_b32 v47, 0
    v_mov_b32 v48, 0
    v_mov_b32 v49, 0
    v_mov_b32 v50, 0
    v_mov_b32 v51, 0
    v_mov_b32 v52, 0
    v_mov_b32 v53, 0
    v_mov_b32 v54, 0
    v_mov_b32 v55, 0
    v_mov_b32 v56, 0
    v_mov_b32 v57, 0
    v_mov_b32 v58, 0
    v_mov_b32 v59, 0
    v_mov_b32 v60, 0
    v_mov_b32 v61, 0
    v_mov_b32 v62, 0
    v_mov_b32 v63, 0
    v_mov_b32 v64, 0
    v_mov_b32 v65, 0
    v_mov_b32 v66, 0
    v_mov_b32 v67, 0
    v_mov_b32 v68, 0
    v_mov_b32 v69, 0
    v_mov_b32 v70, 0
    v_mov_b32 v71, 0
    v_mov_b32 v72, 0
    v_mov_b32 v73, 0
    v_mov_b32 v74, 0
    v_mov_b32 v75, 0
    v_mov_b32 v76, 0
    v_mov_b32 v77, 0
    v_mov_b32 v78, 0
    v_mov_b32 v79, 0
    v_mov_b32 v80, 0
    v_mov_b32 v81, 0
    v_mov_b32 v82, 0
    v_mov_b32 v83, 0
    v_mov_b32 v84, 0
    v_mov_b32 v85, 0
    v_mov_b32 v86, 0
    v_mov_b32 v87, 0
    v_mov_b32 v88, 0
    v_mov_b32 v89, 0
    v_mov_b32 v90, 0
    v_mov_b32 v91, 0
    v_mov_b32 v92, 0
    v_mov_b32 v93, 0
    v_mov_b32 v94, 0
    v_mov_b32 v95, 0
    v_mov_b32 v96, 0
    v_mov_b32 v97, 0
    v_mov_b32 v98, 0
    v_mov_b32 v99, 0
    v_mov_b32 v100, 0
    v_mov_b32 v101, 0
    v_mov_b32 v102, 0
    v_mov_b32 v103, 0
    v_mov_b32 v104, 0
    v_mov_b32 v105, 0
    v_mov_b32 v106, 0
    v_mov_b32 v107, 0
    v_mov_b32 v108, 0
    v_mov_b32 v109, 0
    v_mov_b32 v110, 0
    v_mov_b32 v111, 0
    v_mov_b32 v144, 0
    v_mov_b32 v145, 0
    v_mov_b32 v146, 0
    v_mov_b32 v147, 0
    v_mov_b32 v148, 0
    v_mov_b32 v149, 0
    v_mov_b32 v150, 0
    v_mov_b32 v151, 0
    v_mov_b32 v152, 0
    v_mov_b32 v153, 0
    v_mov_b32 v154, 0
    v_mov_b32 v155, 0
    v_mov_b32 v156, 0
    v_mov_b32 v157, 0
    v_mov_b32 v158, 0
    v_mov_b32 v159, 0
    v_mov_b32 v160, 0
    v_mov_b32 v161, 0
    v_mov_b32 v162, 0
    v_mov_b32 v163, 0
    v_mov_b32 v164, 0
    v_mov_b32 v165, 0
    v_mov_b32 v166, 0
    v_mov_b32 v167, 0
    v_mov_b32 v168, 0
    v_mov_b32 v169, 0
    v_mov_b32 v170, 0
    v_mov_b32 v171, 0
    v_mov_b32 v172, 0
    v_mov_b32 v173, 0
    v_mov_b32 v174, 0
    v_mov_b32 v175, 0
    s_waitcnt vmcnt(33)
    ds_write_b128 v184, a[104:107]
    s_waitcnt vmcnt(32)
    ds_write_b64 v184, a[108:109] offset:264
    ds_write_b64 v184, a[110:111] offset:256
    s_waitcnt vmcnt(31)
    ds_write_b128 v185, a[112:115]
    s_waitcnt vmcnt(30)
    ds_write_b64 v185, a[116:117] offset:264
    ds_write_b64 v185, a[118:119] offset:256
    s_waitcnt vmcnt(29)
    ds_write_b128 v184, a[120:123] offset:8192
    s_waitcnt vmcnt(28)
    ds_write_b64 v184, a[124:125] offset:8456
    ds_write_b64 v184, a[126:127] offset:8448
    s_waitcnt vmcnt(27)
    ds_write_b128 v185, a[128:131] offset:8192
    s_waitcnt vmcnt(26)
    ds_write_b64 v185, a[132:133] offset:8456
    ds_write_b64 v185, a[134:135] offset:8448
    s_add_u32 s51, s48, 1048576
    buffer_load_dwordx4 a[104:107], v190, s[20:23], s51 offen
    s_add_u32 s51, s48, 1056768
    buffer_load_dwordx4 a[108:111], v190, s[20:23], s51 offen
    s_add_u32 s51, s48, 1114112
    buffer_load_dwordx4 a[112:115], v190, s[20:23], s51 offen
    s_add_u32 s51, s48, 1122304
    buffer_load_dwordx4 a[116:119], v190, s[20:23], s51 offen
    s_add_u32 m0, s49, 65536
    s_nop 0
    buffer_load_dwordx4 v116, s[24:27], s57 offen nt lds
    s_add_u32 m0, s49, 67584
    s_nop 0
    buffer_load_dwordx4 v117, s[24:27], s57 offen nt lds
    s_add_u32 s57, s57, 4096
    s_add_u32 m0, s49, 69632
    s_nop 0
    buffer_load_dwordx4 v116, s[24:27], s57 offen nt lds
    s_add_u32 m0, s49, 71680
    s_nop 0
    buffer_load_dwordx4 v117, s[24:27], s57 offen nt lds
    s_add_u32 s57, s57, 4096
    s_add_u32 m0, s49, 73728
    s_nop 0
    buffer_load_dwordx4 v116, s[24:27], s57 offen nt lds
    s_add_u32 m0, s49, 75776
    s_nop 0
    buffer_load_dwordx4 v117, s[24:27], s57 offen nt lds
    s_add_u32 s57, s57, 4096
    s_add_u32 m0, s49, 77824
    s_nop 0
    buffer_load_dwordx4 v116, s[24:27], s57 offen nt lds
    s_add_u32 m0, s49, 79872
    s_nop 0
    buffer_load_dwordx4 v117, s[24:27], s57 offen nt lds
    s_add_u32 s57, s57, 4096
    s_waitcnt vmcnt(29) lgkmcnt(0)
    s_barrier
    ds_read_b128 a[32:35], v186
    ds_read_b128 a[36:39], v186 offset:2048
    ds_read_b128 a[40:43], v186 offset:4096
    ds_read_b128 a[44:47], v186 offset:6144
    ds_read_b128 a[48:51], v188
    ds_read_b64_tr_b16 a[0:1], v176
    ds_read_b64_tr_b16 a[2:3], v176 offset:1024
    ds_read_b64_tr_b16 a[4:5], v177
    ds_read_b64_tr_b16 a[6:7], v177 offset:1024
    ds_read_b64_tr_b16 a[8:9], v178
    ds_read_b64_tr_b16 a[10:11], v178 offset:1024
    ds_read_b64_tr_b16 a[12:13], v179
    ds_read_b64_tr_b16 a[14:15], v179 offset:1024
    ds_read_b64_tr_b16 a[16:17], v180
    ds_read_b64_tr_b16 a[18:19], v180 offset:1024
    ds_read_b64_tr_b16 a[20:21], v181
    ds_read_b64_tr_b16 a[22:23], v181 offset:1024
    ds_read_b64_tr_b16 a[24:25], v182
    ds_read_b64_tr_b16 a[26:27], v182 offset:1024
    ds_read_b64_tr_b16 a[28:29], v183
    ds_read_b64_tr_b16 a[30:31], v183 offset:1024
    s_waitcnt vmcnt(28)
    ds_write_b128 v184, a[136:139] offset:16384
    s_waitcnt lgkmcnt(15)
    v_mfma_f32_16x16x32_bf16 v[0:3], a[0:3], a[32:35], v[0:3]
    s_waitcnt vmcnt(27)
    ds_write_b64 v184, a[140:141] offset:16648
    v_mfma_f32_16x16x32_bf16 v[4:7], a[0:3], a[36:39], v[4:7]
    ds_write_b64 v184, a[142:143] offset:16640
    v_mfma_f32_16x16x32_bf16 v[8:11], a[0:3], a[40:43], v[8:11]
    s_waitcnt vmcnt(26)
    ds_write_b128 v185, a[144:147] offset:16384
    v_mfma_f32_16x16x32_bf16 v[12:15], a[0:3], a[44:47], v[12:15]
    s_waitcnt vmcnt(25)
    ds_write_b64 v185, a[148:149] offset:16648
    v_mfma_f32_16x16x32_bf16 v[160:163], a[0:3], a[48:51], v[160:163]
    ds_write_b64 v185, a[150:151] offset:16640
    s_waitcnt lgkmcnt(15)
    v_mfma_f32_16x16x32_bf16 v[16:19], a[4:7], a[32:35], v[16:19]
    ds_read_b128 a[84:87], v187
    v_mfma_f32_16x16x32_bf16 v[20:23], a[4:7], a[36:39], v[20:23]
    ds_read_b128 a[88:91], v187 offset:2048
    v_mfma_f32_16x16x32_bf16 v[24:27], a[4:7], a[40:43], v[24:27]
    ds_read_b128 a[92:95], v187 offset:4096
    v_mfma_f32_16x16x32_bf16 v[28:31], a[4:7], a[44:47], v[28:31]
    ds_read_b128 a[96:99], v187 offset:6144
    v_mfma_f32_16x16x32_bf16 v[164:167], a[4:7], a[48:51], v[164:167]
    ds_read_b128 a[100:103], v189
    s_add_u32 s51, s48, 1310720
    buffer_load_dwordx4 a[120:123], v190, s[20:23], s51 offen
    v_mfma_f32_16x16x32_bf16 v[32:35], a[8:11], a[32:35], v[32:35]
    ds_read_b64_tr_b16 a[52:53], v176 offset:8192
    s_add_u32 s51, s48, 1318912
    buffer_load_dwordx4 a[124:127], v190, s[20:23], s51 offen
    v_mfma_f32_16x16x32_bf16 v[36:39], a[8:11], a[36:39], v[36:39]
    ds_read_b64_tr_b16 a[54:55], v176 offset:9216
    s_add_u32 s51, s48, 1376256
    buffer_load_dwordx4 a[128:131], v190, s[20:23], s51 offen
    v_mfma_f32_16x16x32_bf16 v[40:43], a[8:11], a[40:43], v[40:43]
    ds_read_b64_tr_b16 a[56:57], v177 offset:8192
    s_add_u32 s51, s48, 1384448
    buffer_load_dwordx4 a[132:135], v190, s[20:23], s51 offen
    v_mfma_f32_16x16x32_bf16 v[44:47], a[8:11], a[44:47], v[44:47]
    ds_read_b64_tr_b16 a[58:59], v177 offset:9216
    v_mfma_f32_16x16x32_bf16 v[168:171], a[8:11], a[48:51], v[168:171]
    ds_read_b64_tr_b16 a[60:61], v178 offset:8192
    s_waitcnt lgkmcnt(15)
    v_mfma_f32_16x16x32_bf16 v[48:51], a[12:15], a[32:35], v[48:51]
    ds_read_b64_tr_b16 a[62:63], v178 offset:9216
    v_mfma_f32_16x16x32_bf16 v[52:55], a[12:15], a[36:39], v[52:55]
    ds_read_b64_tr_b16 a[64:65], v179 offset:8192
    v_mfma_f32_16x16x32_bf16 v[56:59], a[12:15], a[40:43], v[56:59]
    ds_read_b64_tr_b16 a[66:67], v179 offset:9216
    v_mfma_f32_16x16x32_bf16 v[60:63], a[12:15], a[44:47], v[60:63]
    ds_read_b64_tr_b16 a[68:69], v180 offset:8192
    v_mfma_f32_16x16x32_bf16 v[172:175], a[12:15], a[48:51], v[172:175]
    ds_read_b64_tr_b16 a[70:71], v180 offset:9216
    v_mfma_f32_16x16x32_bf16 v[64:67], a[16:19], a[32:35], v[64:67]
    ds_read_b64_tr_b16 a[72:73], v181 offset:8192
    v_mfma_f32_16x16x32_bf16 v[68:71], a[16:19], a[36:39], v[68:71]
    ds_read_b64_tr_b16 a[74:75], v181 offset:9216
    v_mfma_f32_16x16x32_bf16 v[72:75], a[16:19], a[40:43], v[72:75]
    ds_read_b64_tr_b16 a[76:77], v182 offset:8192
    v_mfma_f32_16x16x32_bf16 v[76:79], a[16:19], a[44:47], v[76:79]
    ds_read_b64_tr_b16 a[78:79], v182 offset:9216
    v_mfma_f32_16x16x32_bf16 v[80:83], a[20:23], a[32:35], v[80:83]
    ds_read_b64_tr_b16 a[80:81], v183 offset:8192
    v_mfma_f32_16x16x32_bf16 v[84:87], a[20:23], a[36:39], v[84:87]
    ds_read_b64_tr_b16 a[82:83], v183 offset:9216
    v_mfma_f32_16x16x32_bf16 v[88:91], a[20:23], a[40:43], v[88:91]
    v_mfma_f32_16x16x32_bf16 v[92:95], a[20:23], a[44:47], v[92:95]
    v_mfma_f32_16x16x32_bf16 v[96:99], a[24:27], a[32:35], v[96:99]
    v_mfma_f32_16x16x32_bf16 v[100:103], a[24:27], a[36:39], v[100:103]
    v_mfma_f32_16x16x32_bf16 v[104:107], a[24:27], a[40:43], v[104:107]
    v_mfma_f32_16x16x32_bf16 v[108:111], a[24:27], a[44:47], v[108:111]
    v_mfma_f32_16x16x32_bf16 v[144:147], a[28:31], a[32:35], v[144:147]
    v_mfma_f32_16x16x32_bf16 v[148:151], a[28:31], a[36:39], v[148:151]
    v_mfma_f32_16x16x32_bf16 v[152:155], a[28:31], a[40:43], v[152:155]
    v_mfma_f32_16x16x32_bf16 v[156:159], a[28:31], a[44:47], v[156:159]
    s_waitcnt vmcnt(16) lgkmcnt(0)
    s_barrier
    ds_write_b128 v184, a[152:155]
    v_mfma_f32_16x16x32_bf16 v[0:3], a[52:55], a[84:87], v[0:3]
    ds_write_b64 v184, a[156:157] offset:264
    s_add_u32 m0, s49, 24576
    s_mov_b32 s52, 256
    buffer_load_dwordx4 v191, s[16:19], s52 offen lds
    v_mfma_f32_16x16x32_bf16 v[4:7], a[52:55], a[88:91], v[4:7]
    ds_write_b64 v184, a[158:159] offset:256
    s_add_u32 m0, s49, 26624
    s_mov_b32 s52, 16640
    buffer_load_dwordx4 v191, s[16:19], s52 offen lds
    v_mfma_f32_16x16x32_bf16 v[8:11], a[52:55], a[92:95], v[8:11]
    ds_write_b128 v185, a[160:163]
    s_add_u32 m0, s49, 28672
    s_mov_b32 s52, 33024
    buffer_load_dwordx4 v191, s[16:19], s52 offen lds
    v_mfma_f32_16x16x32_bf16 v[12:15], a[52:55], a[96:99], v[12:15]
    ds_write_b64 v185, a[164:165] offset:264
    s_add_u32 m0, s49, 30720
    s_mov_b32 s52, 49408
    buffer_load_dwordx4 v191, s[16:19], s52 offen lds
    v_mfma_f32_16x16x32_bf16 v[160:163], a[52:55], a[100:103], v[160:163]
    ds_write_b64 v185, a[166:167] offset:256
    s_add_u32 m0, s49, 32768
    s_mov_b32 s52, 65792
    buffer_load_dwordx4 v191, s[16:19], s52 offen lds
    v_mfma_f32_16x16x32_bf16 v[16:19], a[56:59], a[84:87], v[16:19]
    ds_read_b128 a[32:35], v186 offset:18432
    s_add_u32 m0, s49, 34816
    s_mov_b32 s52, 82176
    buffer_load_dwordx4 v191, s[16:19], s52 offen lds
    v_mfma_f32_16x16x32_bf16 v[20:23], a[56:59], a[88:91], v[20:23]
    ds_read_b128 a[36:39], v186 offset:20480
    s_add_u32 m0, s49, 36864
    s_mov_b32 s52, 98560
    buffer_load_dwordx4 v191, s[16:19], s52 offen lds
    v_mfma_f32_16x16x32_bf16 v[24:27], a[56:59], a[92:95], v[24:27]
    ds_read_b128 a[40:43], v186 offset:22528
    s_add_u32 m0, s49, 38912
    s_mov_b32 s52, 114944
    buffer_load_dwordx4 v191, s[16:19], s52 offen lds
    v_mfma_f32_16x16x32_bf16 v[28:31], a[56:59], a[96:99], v[28:31]
    ds_read_b128 a[44:47], v186 offset:24576
    s_add_u32 m0, s49, 40960
    s_mov_b32 s52, 131328
    buffer_load_dwordx4 v191, s[16:19], s52 offen lds
    v_mfma_f32_16x16x32_bf16 v[164:167], a[56:59], a[100:103], v[164:167]
    ds_read_b128 a[48:51], v188 offset:18432
    s_add_u32 s51, s48, 1572864
    buffer_load_dwordx4 a[136:139], v190, s[20:23], s51 offen
    v_mfma_f32_16x16x32_bf16 v[32:35], a[60:63], a[84:87], v[32:35]
    ds_read_b64_tr_b16 a[0:1], v176 offset:16384
    s_add_u32 s51, s48, 1581056
    buffer_load_dwordx4 a[140:143], v190, s[20:23], s51 offen
    v_mfma_f32_16x16x32_bf16 v[36:39], a[60:63], a[88:91], v[36:39]
    ds_read_b64_tr_b16 a[2:3], v176 offset:17408
    s_add_u32 s51, s48, 1638400
    buffer_load_dwordx4 a[144:147], v190, s[20:23], s51 offen
    v_mfma_f32_16x16x32_bf16 v[40:43], a[60:63], a[92:95], v[40:43]
    ds_read_b64_tr_b16 a[4:5], v177 offset:16384
    s_add_u32 s51, s48, 1646592
    buffer_load_dwordx4 a[148:151], v190, s[20:23], s51 offen
    v_mfma_f32_16x16x32_bf16 v[44:47], a[60:63], a[96:99], v[44:47]
    ds_read_b64_tr_b16 a[6:7], v177 offset:17408
    v_mfma_f32_16x16x32_bf16 v[168:171], a[60:63], a[100:103], v[168:171]
    ds_read_b64_tr_b16 a[8:9], v178 offset:16384
    v_mfma_f32_16x16x32_bf16 v[48:51], a[64:67], a[84:87], v[48:51]
    ds_read_b64_tr_b16 a[10:11], v178 offset:17408
    v_mfma_f32_16x16x32_bf16 v[52:55], a[64:67], a[88:91], v[52:55]
    ds_read_b64_tr_b16 a[12:13], v179 offset:16384
    v_mfma_f32_16x16x32_bf16 v[56:59], a[64:67], a[92:95], v[56:59]
    ds_read_b64_tr_b16 a[14:15], v179 offset:17408
    v_mfma_f32_16x16x32_bf16 v[60:63], a[64:67], a[96:99], v[60:63]
    ds_read_b64_tr_b16 a[16:17], v180 offset:16384
    v_mfma_f32_16x16x32_bf16 v[172:175], a[64:67], a[100:103], v[172:175]
    ds_read_b64_tr_b16 a[18:19], v180 offset:17408
    v_mfma_f32_16x16x32_bf16 v[64:67], a[68:71], a[84:87], v[64:67]
    ds_read_b64_tr_b16 a[20:21], v181 offset:16384
    v_mfma_f32_16x16x32_bf16 v[68:71], a[68:71], a[88:91], v[68:71]
    ds_read_b64_tr_b16 a[22:23], v181 offset:17408
    v_mfma_f32_16x16x32_bf16 v[72:75], a[68:71], a[92:95], v[72:75]
    ds_read_b64_tr_b16 a[24:25], v182 offset:16384
    v_mfma_f32_16x16x32_bf16 v[76:79], a[68:71], a[96:99], v[76:79]
    ds_read_b64_tr_b16 a[26:27], v182 offset:17408
    v_mfma_f32_16x16x32_bf16 v[80:83], a[72:75], a[84:87], v[80:83]
    ds_read_b64_tr_b16 a[28:29], v183 offset:16384
    v_mfma_f32_16x16x32_bf16 v[84:87], a[72:75], a[88:91], v[84:87]
    ds_read_b64_tr_b16 a[30:31], v183 offset:17408
    v_mfma_f32_16x16x32_bf16 v[88:91], a[72:75], a[92:95], v[88:91]
    v_mfma_f32_16x16x32_bf16 v[92:95], a[72:75], a[96:99], v[92:95]
    v_mfma_f32_16x16x32_bf16 v[96:99], a[76:79], a[84:87], v[96:99]
    v_mfma_f32_16x16x32_bf16 v[100:103], a[76:79], a[88:91], v[100:103]
    v_mfma_f32_16x16x32_bf16 v[104:107], a[76:79], a[92:95], v[104:107]
    v_mfma_f32_16x16x32_bf16 v[108:111], a[76:79], a[96:99], v[108:111]
    v_mfma_f32_16x16x32_bf16 v[144:147], a[80:83], a[84:87], v[144:147]
    v_mfma_f32_16x16x32_bf16 v[148:151], a[80:83], a[88:91], v[148:151]
    v_mfma_f32_16x16x32_bf16 v[152:155], a[80:83], a[92:95], v[152:155]
    v_mfma_f32_16x16x32_bf16 v[156:159], a[80:83], a[96:99], v[156:159]
    s_waitcnt lgkmcnt(0)
    s_barrier
    s_waitcnt vmcnt(28)
    ds_write_b128 v184, a[104:107] offset:8192
    v_mfma_f32_16x16x32_bf16 v[0:3], a[0:3], a[32:35], v[0:3]
    s_waitcnt vmcnt(27)
    ds_write_b64 v184, a[108:109] offset:8456
    v_mfma_f32_16x16x32_bf16 v[4:7], a[0:3], a[36:39], v[4:7]
    ds_write_b64 v184, a[110:111] offset:8448
    v_mfma_f32_16x16x32_bf16 v[8:11], a[0:3], a[40:43], v[8:11]
    s_waitcnt vmcnt(26)
    ds_write_b128 v185, a[112:115] offset:8192
    v_mfma_f32_16x16x32_bf16 v[12:15], a[0:3], a[44:47], v[12:15]
    s_waitcnt vmcnt(25)
    ds_write_b64 v185, a[116:117] offset:8456
    v_mfma_f32_16x16x32_bf16 v[160:163], a[0:3], a[48:51], v[160:163]
    ds_write_b64 v185, a[118:119] offset:8448
    v_mfma_f32_16x16x32_bf16 v[16:19], a[4:7], a[32:35], v[16:19]
    ds_read_b128 a[84:87], v187 offset:18432
    v_mfma_f32_16x16x32_bf16 v[20:23], a[4:7], a[36:39], v[20:23]
    ds_read_b128 a[88:91], v187 offset:20480
    v_mfma_f32_16x16x32_bf16 v[24:27], a[4:7], a[40:43], v[24:27]
    ds_read_b128 a[92:95], v187 offset:22528
    v_mfma_f32_16x16x32_bf16 v[28:31], a[4:7], a[44:47], v[28:31]
    ds_read_b128 a[96:99], v187 offset:24576
    v_mfma_f32_16x16x32_bf16 v[164:167], a[4:7], a[48:51], v[164:167]
    ds_read_b128 a[100:103], v189 offset:18432
    s_add_u32 s51, s48, 1835008
    buffer_load_dwordx4 a[152:155], v190, s[20:23], s51 offen
    v_mfma_f32_16x16x32_bf16 v[32:35], a[8:11], a[32:35], v[32:35]
    ds_read_b64_tr_b16 a[52:53], v176
    s_add_u32 s51, s48, 1843200
    buffer_load_dwordx4 a[156:159], v190, s[20:23], s51 offen
    v_mfma_f32_16x16x32_bf16 v[36:39], a[8:11], a[36:39], v[36:39]
    ds_read_b64_tr_b16 a[54:55], v176 offset:1024
    s_add_u32 s51, s48, 1900544
    buffer_load_dwordx4 a[160:163], v190, s[20:23], s51 offen
    v_mfma_f32_16x16x32_bf16 v[40:43], a[8:11], a[40:43], v[40:43]
    ds_read_b64_tr_b16 a[56:57], v177
    s_add_u32 s51, s48, 1908736
    buffer_load_dwordx4 a[164:167], v190, s[20:23], s51 offen
    v_mfma_f32_16x16x32_bf16 v[44:47], a[8:11], a[44:47], v[44:47]
    ds_read_b64_tr_b16 a[58:59], v177 offset:1024
    v_mfma_f32_16x16x32_bf16 v[168:171], a[8:11], a[48:51], v[168:171]
    ds_read_b64_tr_b16 a[60:61], v178
    v_mfma_f32_16x16x32_bf16 v[48:51], a[12:15], a[32:35], v[48:51]
    ds_read_b64_tr_b16 a[62:63], v178 offset:1024
    v_mfma_f32_16x16x32_bf16 v[52:55], a[12:15], a[36:39], v[52:55]
    ds_read_b64_tr_b16 a[64:65], v179
    v_mfma_f32_16x16x32_bf16 v[56:59], a[12:15], a[40:43], v[56:59]
    ds_read_b64_tr_b16 a[66:67], v179 offset:1024
    v_mfma_f32_16x16x32_bf16 v[60:63], a[12:15], a[44:47], v[60:63]
    ds_read_b64_tr_b16 a[68:69], v180
    v_mfma_f32_16x16x32_bf16 v[172:175], a[12:15], a[48:51], v[172:175]
    ds_read_b64_tr_b16 a[70:71], v180 offset:1024
    v_mfma_f32_16x16x32_bf16 v[64:67], a[16:19], a[32:35], v[64:67]
    ds_read_b64_tr_b16 a[72:73], v181
    v_mfma_f32_16x16x32_bf16 v[68:71], a[16:19], a[36:39], v[68:71]
    ds_read_b64_tr_b16 a[74:75], v181 offset:1024
    v_mfma_f32_16x16x32_bf16 v[72:75], a[16:19], a[40:43], v[72:75]
    ds_read_b64_tr_b16 a[76:77], v182
    v_mfma_f32_16x16x32_bf16 v[76:79], a[16:19], a[44:47], v[76:79]
    ds_read_b64_tr_b16 a[78:79], v182 offset:1024
    v_mfma_f32_16x16x32_bf16 v[80:83], a[20:23], a[32:35], v[80:83]
    ds_read_b64_tr_b16 a[80:81], v183
    v_mfma_f32_16x16x32_bf16 v[84:87], a[20:23], a[36:39], v[84:87]
    ds_read_b64_tr_b16 a[82:83], v183 offset:1024
    v_mfma_f32_16x16x32_bf16 v[88:91], a[20:23], a[40:43], v[88:91]
    v_mfma_f32_16x16x32_bf16 v[92:95], a[20:23], a[44:47], v[92:95]
    v_mfma_f32_16x16x32_bf16 v[96:99], a[24:27], a[32:35], v[96:99]
    v_mfma_f32_16x16x32_bf16 v[100:103], a[24:27], a[36:39], v[100:103]
    v_mfma_f32_16x16x32_bf16 v[104:107], a[24:27], a[40:43], v[104:107]
    v_mfma_f32_16x16x32_bf16 v[108:111], a[24:27], a[44:47], v[108:111]
    v_mfma_f32_16x16x32_bf16 v[144:147], a[28:31], a[32:35], v[144:147]
    v_mfma_f32_16x16x32_bf16 v[148:151], a[28:31], a[36:39], v[148:151]
    v_mfma_f32_16x16x32_bf16 v[152:155], a[28:31], a[40:43], v[152:155]
    v_mfma_f32_16x16x32_bf16 v[156:159], a[28:31], a[44:47], v[156:159]
    s_waitcnt vmcnt(8) lgkmcnt(0)
    s_barrier
    ds_write_b128 v184, a[120:123] offset:16384
    v_mfma_f32_16x16x32_bf16 v[0:3], a[52:55], a[84:87], v[0:3]
    ds_write_b64 v184, a[124:125] offset:16648
    s_add_u32 m0, s49, 43008
    s_mov_b32 s52, 384
    buffer_load_dwordx4 v191, s[16:19], s52 offen lds
    v_mfma_f32_16x16x32_bf16 v[4:7], a[52:55], a[88:91], v[4:7]
    ds_write_b64 v184, a[126:127] offset:16640
    s_add_u32 m0, s49, 45056
    s_mov_b32 s52, 16768
    buffer_load_dwordx4 v191, s[16:19], s52 offen lds
    v_mfma_f32_16x16x32_bf16 v[8:11], a[52:55], a[92:95], v[8:11]
    ds_write_b128 v185, a[128:131] offset:16384
    s_add_u32 m0, s49, 47104
    s_mov_b32 s52, 33152
    buffer_load_dwordx4 v191, s[16:19], s52 offen lds
    v_mfma_f32_16x16x32_bf16 v[12:15], a[52:55], a[96:99], v[12:15]
    ds_write_b64 v185, a[132:133] offset:16648
    s_add_u32 m0, s49, 49152
    s_mov_b32 s52, 49536
    buffer_load_dwordx4 v191, s[16:19], s52 offen lds
    v_mfma_f32_16x16x32_bf16 v[160:163], a[52:55], a[100:103], v[160:163]
    ds_write_b64 v185, a[134:135] offset:16640
    s_add_u32 m0, s49, 51200
    s_mov_b32 s52, 65920
    buffer_load_dwordx4 v191, s[16:19], s52 offen lds
    v_mfma_f32_16x16x32_bf16 v[16:19], a[56:59], a[84:87], v[16:19]
    ds_read_b128 a[32:35], v186
    s_add_u32 m0, s49, 53248
    s_mov_b32 s52, 82304
    buffer_load_dwordx4 v191, s[16:19], s52 offen lds
    v_mfma_f32_16x16x32_bf16 v[20:23], a[56:59], a[88:91], v[20:23]
    ds_read_b128 a[36:39], v186 offset:2048
    s_add_u32 m0, s49, 55296
    s_mov_b32 s52, 98688
    buffer_load_dwordx4 v191, s[16:19], s52 offen lds
    v_mfma_f32_16x16x32_bf16 v[24:27], a[56:59], a[92:95], v[24:27]
    ds_read_b128 a[40:43], v186 offset:4096
    s_add_u32 m0, s49, 57344
    s_mov_b32 s52, 115072
    buffer_load_dwordx4 v191, s[16:19], s52 offen lds
    v_mfma_f32_16x16x32_bf16 v[28:31], a[56:59], a[96:99], v[28:31]
    ds_read_b128 a[44:47], v186 offset:6144
    s_add_u32 m0, s49, 59392
    s_mov_b32 s52, 131456
    buffer_load_dwordx4 v191, s[16:19], s52 offen lds
    v_mfma_f32_16x16x32_bf16 v[164:167], a[56:59], a[100:103], v[164:167]
    ds_read_b128 a[48:51], v188
    s_add_u32 s51, s48, 2097152
    buffer_load_dwordx4 a[104:107], v190, s[20:23], s51 offen
    v_mfma_f32_16x16x32_bf16 v[32:35], a[60:63], a[84:87], v[32:35]
    ds_read_b64_tr_b16 a[0:1], v176 offset:8192
    s_add_u32 s51, s48, 2105344
    buffer_load_dwordx4 a[108:111], v190, s[20:23], s51 offen
    v_mfma_f32_16x16x32_bf16 v[36:39], a[60:63], a[88:91], v[36:39]
    ds_read_b64_tr_b16 a[2:3], v176 offset:9216
    s_add_u32 s51, s48, 2162688
    buffer_load_dwordx4 a[112:115], v190, s[20:23], s51 offen
    v_mfma_f32_16x16x32_bf16 v[40:43], a[60:63], a[92:95], v[40:43]
    ds_read_b64_tr_b16 a[4:5], v177 offset:8192
    s_add_u32 s51, s48, 2170880
    buffer_load_dwordx4 a[116:119], v190, s[20:23], s51 offen
    v_mfma_f32_16x16x32_bf16 v[44:47], a[60:63], a[96:99], v[44:47]
    ds_read_b64_tr_b16 a[6:7], v177 offset:9216
    v_mfma_f32_16x16x32_bf16 v[168:171], a[60:63], a[100:103], v[168:171]
    ds_read_b64_tr_b16 a[8:9], v178 offset:8192
    v_mfma_f32_16x16x32_bf16 v[48:51], a[64:67], a[84:87], v[48:51]
    ds_read_b64_tr_b16 a[10:11], v178 offset:9216
    v_mfma_f32_16x16x32_bf16 v[52:55], a[64:67], a[88:91], v[52:55]
    ds_read_b64_tr_b16 a[12:13], v179 offset:8192
    v_mfma_f32_16x16x32_bf16 v[56:59], a[64:67], a[92:95], v[56:59]
    ds_read_b64_tr_b16 a[14:15], v179 offset:9216
    v_mfma_f32_16x16x32_bf16 v[60:63], a[64:67], a[96:99], v[60:63]
    ds_read_b64_tr_b16 a[16:17], v180 offset:8192
    v_mfma_f32_16x16x32_bf16 v[172:175], a[64:67], a[100:103], v[172:175]
    ds_read_b64_tr_b16 a[18:19], v180 offset:9216
    v_mfma_f32_16x16x32_bf16 v[64:67], a[68:71], a[84:87], v[64:67]
    ds_read_b64_tr_b16 a[20:21], v181 offset:8192
    v_mfma_f32_16x16x32_bf16 v[68:71], a[68:71], a[88:91], v[68:71]
    ds_read_b64_tr_b16 a[22:23], v181 offset:9216
    v_mfma_f32_16x16x32_bf16 v[72:75], a[68:71], a[92:95], v[72:75]
    ds_read_b64_tr_b16 a[24:25], v182 offset:8192
    v_mfma_f32_16x16x32_bf16 v[76:79], a[68:71], a[96:99], v[76:79]
    ds_read_b64_tr_b16 a[26:27], v182 offset:9216
    v_mfma_f32_16x16x32_bf16 v[80:83], a[72:75], a[84:87], v[80:83]
    ds_read_b64_tr_b16 a[28:29], v183 offset:8192
    v_mfma_f32_16x16x32_bf16 v[84:87], a[72:75], a[88:91], v[84:87]
    ds_read_b64_tr_b16 a[30:31], v183 offset:9216
    v_mfma_f32_16x16x32_bf16 v[88:91], a[72:75], a[92:95], v[88:91]
    v_mfma_f32_16x16x32_bf16 v[92:95], a[72:75], a[96:99], v[92:95]
    v_mfma_f32_16x16x32_bf16 v[96:99], a[76:79], a[84:87], v[96:99]
    v_mfma_f32_16x16x32_bf16 v[100:103], a[76:79], a[88:91], v[100:103]
    v_mfma_f32_16x16x32_bf16 v[104:107], a[76:79], a[92:95], v[104:107]
    v_mfma_f32_16x16x32_bf16 v[108:111], a[76:79], a[96:99], v[108:111]
    v_mfma_f32_16x16x32_bf16 v[144:147], a[80:83], a[84:87], v[144:147]
    v_mfma_f32_16x16x32_bf16 v[148:151], a[80:83], a[88:91], v[148:151]
    v_mfma_f32_16x16x32_bf16 v[152:155], a[80:83], a[92:95], v[152:155]
    v_mfma_f32_16x16x32_bf16 v[156:159], a[80:83], a[96:99], v[156:159]
    s_waitcnt lgkmcnt(0)
    s_barrier
    s_waitcnt vmcnt(20)
    ds_write_b128 v184, a[136:139]
    v_mfma_f32_16x16x32_bf16 v[0:3], a[0:3], a[32:35], v[0:3]
    s_waitcnt vmcnt(19)
    ds_write_b64 v184, a[140:141] offset:264
    v_mfma_f32_16x16x32_bf16 v[4:7], a[0:3], a[36:39], v[4:7]
    ds_write_b64 v184, a[142:143] offset:256
    v_mfma_f32_16x16x32_bf16 v[8:11], a[0:3], a[40:43], v[8:11]
    s_waitcnt vmcnt(18)
    ds_write_b128 v185, a[144:147]
    v_mfma_f32_16x16x32_bf16 v[12:15], a[0:3], a[44:47], v[12:15]
    s_waitcnt vmcnt(17)
    ds_write_b64 v185, a[148:149] offset:264
    v_mfma_f32_16x16x32_bf16 v[160:163], a[0:3], a[48:51], v[160:163]
    ds_write_b64 v185, a[150:151] offset:256
    v_mfma_f32_16x16x32_bf16 v[16:19], a[4:7], a[32:35], v[16:19]
    ds_read_b128 a[84:87], v187
    v_mfma_f32_16x16x32_bf16 v[20:23], a[4:7], a[36:39], v[20:23]
    ds_read_b128 a[88:91], v187 offset:2048
    v_mfma_f32_16x16x32_bf16 v[24:27], a[4:7], a[40:43], v[24:27]
    ds_read_b128 a[92:95], v187 offset:4096
    v_mfma_f32_16x16x32_bf16 v[28:31], a[4:7], a[44:47], v[28:31]
    ds_read_b128 a[96:99], v187 offset:6144
    v_mfma_f32_16x16x32_bf16 v[164:167], a[4:7], a[48:51], v[164:167]
    ds_read_b128 a[100:103], v189
    s_add_u32 s51, s48, 2359296
    buffer_load_dwordx4 a[120:123], v190, s[20:23], s51 offen
    v_mfma_f32_16x16x32_bf16 v[32:35], a[8:11], a[32:35], v[32:35]
    ds_read_b64_tr_b16 a[52:53], v176 offset:16384
    s_add_u32 s51, s48, 2367488
    buffer_load_dwordx4 a[124:127], v190, s[20:23], s51 offen
    v_mfma_f32_16x16x32_bf16 v[36:39], a[8:11], a[36:39], v[36:39]
    ds_read_b64_tr_b16 a[54:55], v176 offset:17408
    s_add_u32 s51, s48, 2424832
    buffer_load_dwordx4 a[128:131], v190, s[20:23], s51 offen
    v_mfma_f32_16x16x32_bf16 v[40:43], a[8:11], a[40:43], v[40:43]
    ds_read_b64_tr_b16 a[56:57], v177 offset:16384
    s_add_u32 s51, s48, 2433024
    buffer_load_dwordx4 a[132:135], v190, s[20:23], s51 offen
    v_mfma_f32_16x16x32_bf16 v[44:47], a[8:11], a[44:47], v[44:47]
    ds_read_b64_tr_b16 a[58:59], v177 offset:17408
    buffer_load_dwordx4 a[168:171], v118, s[28:31], s58 offen nt
    s_add_u32 s58, s58, 2048
    v_mfma_f32_16x16x32_bf16 v[168:171], a[8:11], a[48:51], v[168:171]
    ds_read_b64_tr_b16 a[60:61], v178 offset:16384
    buffer_load_dwordx4 a[172:175], v118, s[28:31], s58 offen nt
    s_add_u32 s58, s58, 2048
    v_mfma_f32_16x16x32_bf16 v[48:51], a[12:15], a[32:35], v[48:51]
    ds_read_b64_tr_b16 a[62:63], v178 offset:17408
    v_mfma_f32_16x16x32_bf16 v[52:55], a[12:15], a[36:39], v[52:55]
    ds_read_b64_tr_b16 a[64:65], v179 offset:16384
    v_mfma_f32_16x16x32_bf16 v[56:59], a[12:15], a[40:43], v[56:59]
    ds_read_b64_tr_b16 a[66:67], v179 offset:17408
    v_mfma_f32_16x16x32_bf16 v[60:63], a[12:15], a[44:47], v[60:63]
    ds_read_b64_tr_b16 a[68:69], v180 offset:16384
    v_mfma_f32_16x16x32_bf16 v[172:175], a[12:15], a[48:51], v[172:175]
    ds_read_b64_tr_b16 a[70:71], v180 offset:17408
    v_mfma_f32_16x16x32_bf16 v[64:67], a[16:19], a[32:35], v[64:67]
    ds_read_b64_tr_b16 a[72:73], v181 offset:16384
    v_mfma_f32_16x16x32_bf16 v[68:71], a[16:19], a[36:39], v[68:71]
    ds_read_b64_tr_b16 a[74:75], v181 offset:17408
    v_mfma_f32_16x16x32_bf16 v[72:75], a[16:19], a[40:43], v[72:75]
    ds_read_b64_tr_b16 a[76:77], v182 offset:16384
    v_mfma_f32_16x16x32_bf16 v[76:79], a[16:19], a[44:47], v[76:79]
    ds_read_b64_tr_b16 a[78:79], v182 offset:17408
    v_mfma_f32_16x16x32_bf16 v[80:83], a[20:23], a[32:35], v[80:83]
    ds_read_b64_tr_b16 a[80:81], v183 offset:16384
    v_mfma_f32_16x16x32_bf16 v[84:87], a[20:23], a[36:39], v[84:87]
    ds_read_b64_tr_b16 a[82:83], v183 offset:17408
    v_mfma_f32_16x16x32_bf16 v[88:91], a[20:23], a[40:43], v[88:91]
    v_mfma_f32_16x16x32_bf16 v[92:95], a[20:23], a[44:47], v[92:95]
    v_mfma_f32_16x16x32_bf16 v[96:99], a[24:27], a[32:35], v[96:99]
    v_mfma_f32_16x16x32_bf16 v[100:103], a[24:27], a[36:39], v[100:103]
    v_mfma_f32_16x16x32_bf16 v[104:107], a[24:27], a[40:43], v[104:107]
    v_mfma_f32_16x16x32_bf16 v[108:111], a[24:27], a[44:47], v[108:111]
    v_mfma_f32_16x16x32_bf16 v[144:147], a[28:31], a[32:35], v[144:147]
    v_mfma_f32_16x16x32_bf16 v[148:151], a[28:31], a[36:39], v[148:151]
    v_mfma_f32_16x16x32_bf16 v[152:155], a[28:31], a[40:43], v[152:155]
    v_mfma_f32_16x16x32_bf16 v[156:159], a[28:31], a[44:47], v[156:159]
    s_waitcnt vmcnt(10) lgkmcnt(0)
    s_barrier
    ds_write_b128 v184, a[152:155] offset:8192
    v_mfma_f32_16x16x32_bf16 v[0:3], a[52:55], a[84:87], v[0:3]
    ds_write_b64 v184, a[156:157] offset:8456
    s_add_u32 m0, s49, 24576
    s_mov_b32 s52, 512
    buffer_load_dwordx4 v191, s[16:19], s52 offen lds
    v_mfma_f32_16x16x32_bf16 v[4:7], a[52:55], a[88:91], v[4:7]
    ds_write_b64 v184, a[158:159] offset:8448
    s_add_u32 m0, s49, 26624
    s_mov_b32 s52, 16896
    buffer_load_dwordx4 v191, s[16:19], s52 offen lds
    v_mfma_f32_16x16x32_bf16 v[8:11], a[52:55], a[92:95], v[8:11]
    ds_write_b128 v185, a[160:163] offset:8192
    s_add_u32 m0, s49, 28672
    s_mov_b32 s52, 33280
    buffer_load_dwordx4 v191, s[16:19], s52 offen lds
    v_mfma_f32_16x16x32_bf16 v[12:15], a[52:55], a[96:99], v[12:15]
    ds_write_b64 v185, a[164:165] offset:8456
    s_add_u32 m0, s49, 30720
    s_mov_b32 s52, 49664
    buffer_load_dwordx4 v191, s[16:19], s52 offen lds
    v_mfma_f32_16x16x32_bf16 v[160:163], a[52:55], a[100:103], v[160:163]
    ds_write_b64 v185, a[166:167] offset:8448
    s_add_u32 m0, s49, 32768
    s_mov_b32 s52, 66048
    buffer_load_dwordx4 v191, s[16:19], s52 offen lds
    v_mfma_f32_16x16x32_bf16 v[16:19], a[56:59], a[84:87], v[16:19]
    ds_read_b128 a[32:35], v186 offset:18432
    s_add_u32 m0, s49, 34816
    s_mov_b32 s52, 82432
    buffer_load_dwordx4 v191, s[16:19], s52 offen lds
    v_mfma_f32_16x16x32_bf16 v[20:23], a[56:59], a[88:91], v[20:23]
    ds_read_b128 a[36:39], v186 offset:20480
    s_add_u32 m0, s49, 36864
    s_mov_b32 s52, 98816
    buffer_load_dwordx4 v191, s[16:19], s52 offen lds
    v_mfma_f32_16x16x32_bf16 v[24:27], a[56:59], a[92:95], v[24:27]
    ds_read_b128 a[40:43], v186 offset:22528
    s_add_u32 m0, s49, 38912
    s_mov_b32 s52, 115200
    buffer_load_dwordx4 v191, s[16:19], s52 offen lds
    v_mfma_f32_16x16x32_bf16 v[28:31], a[56:59], a[96:99], v[28:31]
    ds_read_b128 a[44:47], v186 offset:24576
    s_add_u32 m0, s49, 40960
    s_mov_b32 s52, 131584
    buffer_load_dwordx4 v191, s[16:19], s52 offen lds
    v_mfma_f32_16x16x32_bf16 v[164:167], a[56:59], a[100:103], v[164:167]
    ds_read_b128 a[48:51], v188 offset:18432
    s_add_u32 s51, s48, 2621440
    buffer_load_dwordx4 a[136:139], v190, s[20:23], s51 offen
    v_mfma_f32_16x16x32_bf16 v[32:35], a[60:63], a[84:87], v[32:35]
    ds_read_b64_tr_b16 a[0:1], v176
    s_add_u32 s51, s48, 2629632
    buffer_load_dwordx4 a[140:143], v190, s[20:23], s51 offen
    v_mfma_f32_16x16x32_bf16 v[36:39], a[60:63], a[88:91], v[36:39]
    ds_read_b64_tr_b16 a[2:3], v176 offset:1024
    s_add_u32 s51, s48, 2686976
    buffer_load_dwordx4 a[144:147], v190, s[20:23], s51 offen
    v_mfma_f32_16x16x32_bf16 v[40:43], a[60:63], a[92:95], v[40:43]
    ds_read_b64_tr_b16 a[4:5], v177
    s_add_u32 s51, s48, 2695168
    buffer_load_dwordx4 a[148:151], v190, s[20:23], s51 offen
    v_mfma_f32_16x16x32_bf16 v[44:47], a[60:63], a[96:99], v[44:47]
    ds_read_b64_tr_b16 a[6:7], v177 offset:1024
    buffer_load_dwordx4 a[176:179], v118, s[28:31], s58 offen nt
    s_add_u32 s58, s58, 2048
    v_mfma_f32_16x16x32_bf16 v[168:171], a[60:63], a[100:103], v[168:171]
    ds_read_b64_tr_b16 a[8:9], v178
    buffer_load_dwordx4 a[180:183], v118, s[28:31], s58 offen nt
    s_add_u32 s58, s58, 2048
    v_mfma_f32_16x16x32_bf16 v[48:51], a[64:67], a[84:87], v[48:51]
    ds_read_b64_tr_b16 a[10:11], v178 offset:1024
    v_mfma_f32_16x16x32_bf16 v[52:55], a[64:67], a[88:91], v[52:55]
    ds_read_b64_tr_b16 a[12:13], v179
    v_mfma_f32_16x16x32_bf16 v[56:59], a[64:67], a[92:95], v[56:59]
    ds_read_b64_tr_b16 a[14:15], v179 offset:1024
    v_mfma_f32_16x16x32_bf16 v[60:63], a[64:67], a[96:99], v[60:63]
    ds_read_b64_tr_b16 a[16:17], v180
    v_mfma_f32_16x16x32_bf16 v[172:175], a[64:67], a[100:103], v[172:175]
    ds_read_b64_tr_b16 a[18:19], v180 offset:1024
    v_mfma_f32_16x16x32_bf16 v[64:67], a[68:71], a[84:87], v[64:67]
    ds_read_b64_tr_b16 a[20:21], v181
    v_mfma_f32_16x16x32_bf16 v[68:71], a[68:71], a[88:91], v[68:71]
    ds_read_b64_tr_b16 a[22:23], v181 offset:1024
    v_mfma_f32_16x16x32_bf16 v[72:75], a[68:71], a[92:95], v[72:75]
    ds_read_b64_tr_b16 a[24:25], v182
    v_mfma_f32_16x16x32_bf16 v[76:79], a[68:71], a[96:99], v[76:79]
    ds_read_b64_tr_b16 a[26:27], v182 offset:1024
    v_mfma_f32_16x16x32_bf16 v[80:83], a[72:75], a[84:87], v[80:83]
    ds_read_b64_tr_b16 a[28:29], v183
    v_mfma_f32_16x16x32_bf16 v[84:87], a[72:75], a[88:91], v[84:87]
    ds_read_b64_tr_b16 a[30:31], v183 offset:1024
    v_mfma_f32_16x16x32_bf16 v[88:91], a[72:75], a[92:95], v[88:91]
    v_mfma_f32_16x16x32_bf16 v[92:95], a[72:75], a[96:99], v[92:95]
    v_mfma_f32_16x16x32_bf16 v[96:99], a[76:79], a[84:87], v[96:99]
    v_mfma_f32_16x16x32_bf16 v[100:103], a[76:79], a[88:91], v[100:103]
    v_mfma_f32_16x16x32_bf16 v[104:107], a[76:79], a[92:95], v[104:107]
    v_mfma_f32_16x16x32_bf16 v[108:111], a[76:79], a[96:99], v[108:111]
    v_mfma_f32_16x16x32_bf16 v[144:147], a[80:83], a[84:87], v[144:147]
    v_mfma_f32_16x16x32_bf16 v[148:151], a[80:83], a[88:91], v[148:151]
    v_mfma_f32_16x16x32_bf16 v[152:155], a[80:83], a[92:95], v[152:155]
    v_mfma_f32_16x16x32_bf16 v[156:159], a[80:83], a[96:99], v[156:159]
    s_waitcnt lgkmcnt(0)
    s_barrier
    s_waitcnt vmcnt(24)
    ds_write_b128 v184, a[104:107] offset:16384
    v_mfma_f32_16x16x32_bf16 v[0:3], a[0:3], a[32:35], v[0:3]
    s_waitcnt vmcnt(23)
    ds_write_b64 v184, a[108:109] offset:16648
    v_mfma_f32_16x16x32_bf16 v[4:7], a[0:3], a[36:39], v[4:7]
    ds_write_b64 v184, a[110:111] offset:16640
    v_mfma_f32_16x16x32_bf16 v[8:11], a[0:3], a[40:43], v[8:11]
    s_waitcnt vmcnt(22)
    ds_write_b128 v185, a[112:115] offset:16384
    v_mfma_f32_16x16x32_bf16 v[12:15], a[0:3], a[44:47], v[12:15]
    s_waitcnt vmcnt(21)
    ds_write_b64 v185, a[116:117] offset:16648
    v_mfma_f32_16x16x32_bf16 v[160:163], a[0:3], a[48:51], v[160:163]
    ds_write_b64 v185, a[118:119] offset:16640
    v_mfma_f32_16x16x32_bf16 v[16:19], a[4:7], a[32:35], v[16:19]
    ds_read_b128 a[84:87], v187 offset:18432
    v_mfma_f32_16x16x32_bf16 v[20:23], a[4:7], a[36:39], v[20:23]
    ds_read_b128 a[88:91], v187 offset:20480
    v_mfma_f32_16x16x32_bf16 v[24:27], a[4:7], a[40:43], v[24:27]
    ds_read_b128 a[92:95], v187 offset:22528
    v_mfma_f32_16x16x32_bf16 v[28:31], a[4:7], a[44:47], v[28:31]
    ds_read_b128 a[96:99], v187 offset:24576
    v_mfma_f32_16x16x32_bf16 v[164:167], a[4:7], a[48:51], v[164:167]
    ds_read_b128 a[100:103], v189 offset:18432
    s_add_u32 s51, s48, 2883584
    buffer_load_dwordx4 a[152:155], v190, s[20:23], s51 offen
    v_mfma_f32_16x16x32_bf16 v[32:35], a[8:11], a[32:35], v[32:35]
    ds_read_b64_tr_b16 a[52:53], v176 offset:8192
    s_add_u32 s51, s48, 2891776
    buffer_load_dwordx4 a[156:159], v190, s[20:23], s51 offen
    v_mfma_f32_16x16x32_bf16 v[36:39], a[8:11], a[36:39], v[36:39]
    ds_read_b64_tr_b16 a[54:55], v176 offset:9216
    s_add_u32 s51, s48, 2949120
    buffer_load_dwordx4 a[160:163], v190, s[20:23], s51 offen
    v_mfma_f32_16x16x32_bf16 v[40:43], a[8:11], a[40:43], v[40:43]
    ds_read_b64_tr_b16 a[56:57], v177 offset:8192
    s_add_u32 s51, s48, 2957312
    buffer_load_dwordx4 a[164:167], v190, s[20:23], s51 offen
    v_mfma_f32_16x16x32_bf16 v[44:47], a[8:11], a[44:47], v[44:47]
    ds_read_b64_tr_b16 a[58:59], v177 offset:9216
    buffer_load_dwordx4 a[184:187], v118, s[28:31], s58 offen nt
    s_add_u32 s58, s58, 2048
    v_mfma_f32_16x16x32_bf16 v[168:171], a[8:11], a[48:51], v[168:171]
    ds_read_b64_tr_b16 a[60:61], v178 offset:8192
    buffer_load_dwordx4 a[188:191], v118, s[28:31], s58 offen nt
    s_add_u32 s58, s58, 2048
    v_mfma_f32_16x16x32_bf16 v[48:51], a[12:15], a[32:35], v[48:51]
    ds_read_b64_tr_b16 a[62:63], v178 offset:9216
    v_mfma_f32_16x16x32_bf16 v[52:55], a[12:15], a[36:39], v[52:55]
    ds_read_b64_tr_b16 a[64:65], v179 offset:8192
    v_mfma_f32_16x16x32_bf16 v[56:59], a[12:15], a[40:43], v[56:59]
    ds_read_b64_tr_b16 a[66:67], v179 offset:9216
    v_mfma_f32_16x16x32_bf16 v[60:63], a[12:15], a[44:47], v[60:63]
    ds_read_b64_tr_b16 a[68:69], v180 offset:8192
    v_mfma_f32_16x16x32_bf16 v[172:175], a[12:15], a[48:51], v[172:175]
    ds_read_b64_tr_b16 a[70:71], v180 offset:9216
    v_mfma_f32_16x16x32_bf16 v[64:67], a[16:19], a[32:35], v[64:67]
    ds_read_b64_tr_b16 a[72:73], v181 offset:8192
    v_mfma_f32_16x16x32_bf16 v[68:71], a[16:19], a[36:39], v[68:71]
    ds_read_b64_tr_b16 a[74:75], v181 offset:9216
    v_mfma_f32_16x16x32_bf16 v[72:75], a[16:19], a[40:43], v[72:75]
    ds_read_b64_tr_b16 a[76:77], v182 offset:8192
    v_mfma_f32_16x16x32_bf16 v[76:79], a[16:19], a[44:47], v[76:79]
    ds_read_b64_tr_b16 a[78:79], v182 offset:9216
    v_mfma_f32_16x16x32_bf16 v[80:83], a[20:23], a[32:35], v[80:83]
    ds_read_b64_tr_b16 a[80:81], v183 offset:8192
    v_mfma_f32_16x16x32_bf16 v[84:87], a[20:23], a[36:39], v[84:87]
    ds_read_b64_tr_b16 a[82:83], v183 offset:9216
    v_mfma_f32_16x16x32_bf16 v[88:91], a[20:23], a[40:43], v[88:91]
    v_mfma_f32_16x16x32_bf16 v[92:95], a[20:23], a[44:47], v[92:95]
    v_mfma_f32_16x16x32_bf16 v[96:99], a[24:27], a[32:35], v[96:99]
    v_mfma_f32_16x16x32_bf16 v[100:103], a[24:27], a[36:39], v[100:103]
    v_mfma_f32_16x16x32_bf16 v[104:107], a[24:27], a[40:43], v[104:107]
    v_mfma_f32_16x16x32_bf16 v[108:111], a[24:27], a[44:47], v[108:111]
    v_mfma_f32_16x16x32_bf16 v[144:147], a[28:31], a[32:35], v[144:147]
    v_mfma_f32_16x16x32_bf16 v[148:151], a[28:31], a[36:39], v[148:151]
    v_mfma_f32_16x16x32_bf16 v[152:155], a[28:31], a[40:43], v[152:155]
    v_mfma_f32_16x16x32_bf16 v[156:159], a[28:31], a[44:47], v[156:159]
    s_waitcnt vmcnt(12) lgkmcnt(0)
    s_barrier
    ds_write_b128 v184, a[120:123]
    v_mfma_f32_16x16x32_bf16 v[0:3], a[52:55], a[84:87], v[0:3]
    ds_write_b64 v184, a[124:125] offset:264
    s_add_u32 m0, s49, 43008
    s_mov_b32 s52, 640
    buffer_load_dwordx4 v191, s[16:19], s52 offen lds
    v_mfma_f32_16x16x32_bf16 v[4:7], a[52:55], a[88:91], v[4:7]
    ds_write_b64 v184, a[126:127] offset:256
    s_add_u32 m0, s49, 45056
    s_mov_b32 s52, 17024
    buffer_load_dwordx4 v191, s[16:19], s52 offen lds
    v_mfma_f32_16x16x32_bf16 v[8:11], a[52:55], a[92:95], v[8:11]
    ds_write_b128 v185, a[128:131]
    s_add_u32 m0, s49, 47104
    s_mov_b32 s52, 33408
    buffer_load_dwordx4 v191, s[16:19], s52 offen lds
    v_mfma_f32_16x16x32_bf16 v[12:15], a[52:55], a[96:99], v[12:15]
    ds_write_b64 v185, a[132:133] offset:264
    s_add_u32 m0, s49, 49152
    s_mov_b32 s52, 49792
    buffer_load_dwordx4 v191, s[16:19], s52 offen lds
    v_mfma_f32_16x16x32_bf16 v[160:163], a[52:55], a[100:103], v[160:163]
    ds_write_b64 v185, a[134:135] offset:256
    s_add_u32 m0, s49, 51200
    s_mov_b32 s52, 66176
    buffer_load_dwordx4 v191, s[16:19], s52 offen lds
    v_mfma_f32_16x16x32_bf16 v[16:19], a[56:59], a[84:87], v[16:19]
    ds_read_b128 a[32:35], v186
    s_add_u32 m0, s49, 53248
    s_mov_b32 s52, 82560
    buffer_load_dwordx4 v191, s[16:19], s52 offen lds
    v_mfma_f32_16x16x32_bf16 v[20:23], a[56:59], a[88:91], v[20:23]
    ds_read_b128 a[36:39], v186 offset:2048
    s_add_u32 m0, s49, 55296
    s_mov_b32 s52, 98944
    buffer_load_dwordx4 v191, s[16:19], s52 offen lds
    v_mfma_f32_16x16x32_bf16 v[24:27], a[56:59], a[92:95], v[24:27]
    ds_read_b128 a[40:43], v186 offset:4096
    s_add_u32 m0, s49, 57344
    s_mov_b32 s52, 115328
    buffer_load_dwordx4 v191, s[16:19], s52 offen lds
    v_mfma_f32_16x16x32_bf16 v[28:31], a[56:59], a[96:99], v[28:31]
    ds_read_b128 a[44:47], v186 offset:6144
    s_add_u32 m0, s49, 59392
    s_mov_b32 s52, 131712
    buffer_load_dwordx4 v191, s[16:19], s52 offen lds
    v_mfma_f32_16x16x32_bf16 v[164:167], a[56:59], a[100:103], v[164:167]
    ds_read_b128 a[48:51], v188
    s_add_u32 s51, s48, 3145728
    buffer_load_dwordx4 a[104:107], v190, s[20:23], s51 offen
    v_mfma_f32_16x16x32_bf16 v[32:35], a[60:63], a[84:87], v[32:35]
    ds_read_b64_tr_b16 a[0:1], v176 offset:16384
    s_add_u32 s51, s48, 3153920
    buffer_load_dwordx4 a[108:111], v190, s[20:23], s51 offen
    v_mfma_f32_16x16x32_bf16 v[36:39], a[60:63], a[88:91], v[36:39]
    ds_read_b64_tr_b16 a[2:3], v176 offset:17408
    s_add_u32 s51, s48, 3211264
    buffer_load_dwordx4 a[112:115], v190, s[20:23], s51 offen
    v_mfma_f32_16x16x32_bf16 v[40:43], a[60:63], a[92:95], v[40:43]
    ds_read_b64_tr_b16 a[4:5], v177 offset:16384
    s_add_u32 s51, s48, 3219456
    buffer_load_dwordx4 a[116:119], v190, s[20:23], s51 offen
    v_mfma_f32_16x16x32_bf16 v[44:47], a[60:63], a[96:99], v[44:47]
    ds_read_b64_tr_b16 a[6:7], v177 offset:17408
    buffer_load_dwordx4 a[192:195], v118, s[28:31], s58 offen nt
    s_add_u32 s58, s58, 2048
    v_mfma_f32_16x16x32_bf16 v[168:171], a[60:63], a[100:103], v[168:171]
    ds_read_b64_tr_b16 a[8:9], v178 offset:16384
    buffer_load_dwordx4 a[196:199], v118, s[28:31], s58 offen nt
    s_add_u32 s58, s58, 2048
    v_mfma_f32_16x16x32_bf16 v[48:51], a[64:67], a[84:87], v[48:51]
    ds_read_b64_tr_b16 a[10:11], v178 offset:17408
    v_mfma_f32_16x16x32_bf16 v[52:55], a[64:67], a[88:91], v[52:55]
    ds_read_b64_tr_b16 a[12:13], v179 offset:16384
    v_mfma_f32_16x16x32_bf16 v[56:59], a[64:67], a[92:95], v[56:59]
    ds_read_b64_tr_b16 a[14:15], v179 offset:17408
    v_mfma_f32_16x16x32_bf16 v[60:63], a[64:67], a[96:99], v[60:63]
    ds_read_b64_tr_b16 a[16:17], v180 offset:16384
    v_mfma_f32_16x16x32_bf16 v[172:175], a[64:67], a[100:103], v[172:175]
    ds_read_b64_tr_b16 a[18:19], v180 offset:17408
    v_mfma_f32_16x16x32_bf16 v[64:67], a[68:71], a[84:87], v[64:67]
    ds_read_b64_tr_b16 a[20:21], v181 offset:16384
    v_mfma_f32_16x16x32_bf16 v[68:71], a[68:71], a[88:91], v[68:71]
    ds_read_b64_tr_b16 a[22:23], v181 offset:17408
    v_mfma_f32_16x16x32_bf16 v[72:75], a[68:71], a[92:95], v[72:75]
    ds_read_b64_tr_b16 a[24:25], v182 offset:16384
    v_mfma_f32_16x16x32_bf16 v[76:79], a[68:71], a[96:99], v[76:79]
    ds_read_b64_tr_b16 a[26:27], v182 offset:17408
    v_mfma_f32_16x16x32_bf16 v[80:83], a[72:75], a[84:87], v[80:83]
    ds_read_b64_tr_b16 a[28:29], v183 offset:16384
    v_mfma_f32_16x16x32_bf16 v[84:87], a[72:75], a[88:91], v[84:87]
    ds_read_b64_tr_b16 a[30:31], v183 offset:17408
    v_mfma_f32_16x16x32_bf16 v[88:91], a[72:75], a[92:95], v[88:91]
    v_mfma_f32_16x16x32_bf16 v[92:95], a[72:75], a[96:99], v[92:95]
    v_mfma_f32_16x16x32_bf16 v[96:99], a[76:79], a[84:87], v[96:99]
    v_mfma_f32_16x16x32_bf16 v[100:103], a[76:79], a[88:91], v[100:103]
    v_mfma_f32_16x16x32_bf16 v[104:107], a[76:79], a[92:95], v[104:107]
    v_mfma_f32_16x16x32_bf16 v[108:111], a[76:79], a[96:99], v[108:111]
    v_mfma_f32_16x16x32_bf16 v[144:147], a[80:83], a[84:87], v[144:147]
    v_mfma_f32_16x16x32_bf16 v[148:151], a[80:83], a[88:91], v[148:151]
    v_mfma_f32_16x16x32_bf16 v[152:155], a[80:83], a[92:95], v[152:155]
    v_mfma_f32_16x16x32_bf16 v[156:159], a[80:83], a[96:99], v[156:159]
    s_waitcnt lgkmcnt(0)
    s_barrier
    s_waitcnt vmcnt(26)
    ds_write_b128 v184, a[136:139] offset:8192
    v_mfma_f32_16x16x32_bf16 v[0:3], a[0:3], a[32:35], v[0:3]
    s_waitcnt vmcnt(25)
    ds_write_b64 v184, a[140:141] offset:8456
    v_mfma_f32_16x16x32_bf16 v[4:7], a[0:3], a[36:39], v[4:7]
    ds_write_b64 v184, a[142:143] offset:8448
    v_mfma_f32_16x16x32_bf16 v[8:11], a[0:3], a[40:43], v[8:11]
    s_waitcnt vmcnt(24)
    ds_write_b128 v185, a[144:147] offset:8192
    v_mfma_f32_16x16x32_bf16 v[12:15], a[0:3], a[44:47], v[12:15]
    s_waitcnt vmcnt(23)
    ds_write_b64 v185, a[148:149] offset:8456
    v_mfma_f32_16x16x32_bf16 v[160:163], a[0:3], a[48:51], v[160:163]
    ds_write_b64 v185, a[150:151] offset:8448
    v_mfma_f32_16x16x32_bf16 v[16:19], a[4:7], a[32:35], v[16:19]
    ds_read_b128 a[84:87], v187
    v_mfma_f32_16x16x32_bf16 v[20:23], a[4:7], a[36:39], v[20:23]
    ds_read_b128 a[88:91], v187 offset:2048
    v_mfma_f32_16x16x32_bf16 v[24:27], a[4:7], a[40:43], v[24:27]
    ds_read_b128 a[92:95], v187 offset:4096
    v_mfma_f32_16x16x32_bf16 v[28:31], a[4:7], a[44:47], v[28:31]
    ds_read_b128 a[96:99], v187 offset:6144
    v_mfma_f32_16x16x32_bf16 v[164:167], a[4:7], a[48:51], v[164:167]
    ds_read_b128 a[100:103], v189
    s_add_u32 s51, s48, 3407872
    buffer_load_dwordx4 a[120:123], v190, s[20:23], s51 offen
    v_mfma_f32_16x16x32_bf16 v[32:35], a[8:11], a[32:35], v[32:35]
    ds_read_b64_tr_b16 a[52:53], v176
    s_add_u32 s51, s48, 3416064
    buffer_load_dwordx4 a[124:127], v190, s[20:23], s51 offen
    v_mfma_f32_16x16x32_bf16 v[36:39], a[8:11], a[36:39], v[36:39]
    ds_read_b64_tr_b16 a[54:55], v176 offset:1024
    s_add_u32 s51, s48, 3473408
    buffer_load_dwordx4 a[128:131], v190, s[20:23], s51 offen
    v_mfma_f32_16x16x32_bf16 v[40:43], a[8:11], a[40:43], v[40:43]
    ds_read_b64_tr_b16 a[56:57], v177
    s_add_u32 s51, s48, 3481600
    buffer_load_dwordx4 a[132:135], v190, s[20:23], s51 offen
    v_mfma_f32_16x16x32_bf16 v[44:47], a[8:11], a[44:47], v[44:47]
    ds_read_b64_tr_b16 a[58:59], v177 offset:1024
    buffer_load_dwordx4 a[200:203], v116, s[24:27], s57 offen nt
    v_mfma_f32_16x16x32_bf16 v[168:171], a[8:11], a[48:51], v[168:171]
    ds_read_b64_tr_b16 a[60:61], v178
    buffer_load_dwordx4 a[204:207], v117, s[24:27], s57 offen nt
    s_add_u32 s57, s57, 4096
    v_mfma_f32_16x16x32_bf16 v[48:51], a[12:15], a[32:35], v[48:51]
    ds_read_b64_tr_b16 a[62:63], v178 offset:1024
    v_mfma_f32_16x16x32_bf16 v[52:55], a[12:15], a[36:39], v[52:55]
    ds_read_b64_tr_b16 a[64:65], v179
    v_mfma_f32_16x16x32_bf16 v[56:59], a[12:15], a[40:43], v[56:59]
    ds_read_b64_tr_b16 a[66:67], v179 offset:1024
    v_mfma_f32_16x16x32_bf16 v[60:63], a[12:15], a[44:47], v[60:63]
    ds_read_b64_tr_b16 a[68:69], v180
    v_mfma_f32_16x16x32_bf16 v[172:175], a[12:15], a[48:51], v[172:175]
    ds_read_b64_tr_b16 a[70:71], v180 offset:1024
    v_mfma_f32_16x16x32_bf16 v[64:67], a[16:19], a[32:35], v[64:67]
    ds_read_b64_tr_b16 a[72:73], v181
    v_mfma_f32_16x16x32_bf16 v[68:71], a[16:19], a[36:39], v[68:71]
    ds_read_b64_tr_b16 a[74:75], v181 offset:1024
    v_mfma_f32_16x16x32_bf16 v[72:75], a[16:19], a[40:43], v[72:75]
    ds_read_b64_tr_b16 a[76:77], v182
    v_mfma_f32_16x16x32_bf16 v[76:79], a[16:19], a[44:47], v[76:79]
    ds_read_b64_tr_b16 a[78:79], v182 offset:1024
    v_mfma_f32_16x16x32_bf16 v[80:83], a[20:23], a[32:35], v[80:83]
    ds_read_b64_tr_b16 a[80:81], v183
    v_mfma_f32_16x16x32_bf16 v[84:87], a[20:23], a[36:39], v[84:87]
    ds_read_b64_tr_b16 a[82:83], v183 offset:1024
    v_mfma_f32_16x16x32_bf16 v[88:91], a[20:23], a[40:43], v[88:91]
    v_mfma_f32_16x16x32_bf16 v[92:95], a[20:23], a[44:47], v[92:95]
    v_mfma_f32_16x16x32_bf16 v[96:99], a[24:27], a[32:35], v[96:99]
    v_mfma_f32_16x16x32_bf16 v[100:103], a[24:27], a[36:39], v[100:103]
    v_mfma_f32_16x16x32_bf16 v[104:107], a[24:27], a[40:43], v[104:107]
    v_mfma_f32_16x16x32_bf16 v[108:111], a[24:27], a[44:47], v[108:111]
    v_mfma_f32_16x16x32_bf16 v[144:147], a[28:31], a[32:35], v[144:147]
    v_mfma_f32_16x16x32_bf16 v[148:151], a[28:31], a[36:39], v[148:151]
    v_mfma_f32_16x16x32_bf16 v[152:155], a[28:31], a[40:43], v[152:155]
    v_mfma_f32_16x16x32_bf16 v[156:159], a[28:31], a[44:47], v[156:159]
    s_waitcnt vmcnt(12) lgkmcnt(0)
    s_barrier
    ds_write_b128 v184, a[152:155] offset:16384
    v_mfma_f32_16x16x32_bf16 v[0:3], a[52:55], a[84:87], v[0:3]
    ds_write_b64 v184, a[156:157] offset:16648
    s_add_u32 m0, s49, 24576
    s_mov_b32 s52, 768
    buffer_load_dwordx4 v191, s[16:19], s52 offen lds
    v_mfma_f32_16x16x32_bf16 v[4:7], a[52:55], a[88:91], v[4:7]
    ds_write_b64 v184, a[158:159] offset:16640
    s_add_u32 m0, s49, 26624
    s_mov_b32 s52, 17152
    buffer_load_dwordx4 v191, s[16:19], s52 offen lds
    v_mfma_f32_16x16x32_bf16 v[8:11], a[52:55], a[92:95], v[8:11]
    ds_write_b128 v185, a[160:163] offset:16384
    s_add_u32 m0, s49, 28672
    s_mov_b32 s52, 33536
    buffer_load_dwordx4 v191, s[16:19], s52 offen lds
    v_mfma_f32_16x16x32_bf16 v[12:15], a[52:55], a[96:99], v[12:15]
    ds_write_b64 v185, a[164:165] offset:16648
    s_add_u32 m0, s49, 30720
    s_mov_b32 s52, 49920
    buffer_load_dwordx4 v191, s[16:19], s52 offen lds
    v_mfma_f32_16x16x32_bf16 v[160:163], a[52:55], a[100:103], v[160:163]
    ds_write_b64 v185, a[166:167] offset:16640
    s_add_u32 m0, s49, 32768
    s_mov_b32 s52, 66304
    buffer_load_dwordx4 v191, s[16:19], s52 offen lds
    v_mfma_f32_16x16x32_bf16 v[16:19], a[56:59], a[84:87], v[16:19]
    ds_read_b128 a[32:35], v186 offset:18432
    s_add_u32 m0, s49, 34816
    s_mov_b32 s52, 82688
    buffer_load_dwordx4 v191, s[16:19], s52 offen lds
    v_mfma_f32_16x16x32_bf16 v[20:23], a[56:59], a[88:91], v[20:23]
    ds_read_b128 a[36:39], v186 offset:20480
    s_add_u32 m0, s49, 36864
    s_mov_b32 s52, 99072
    buffer_load_dwordx4 v191, s[16:19], s52 offen lds
    v_mfma_f32_16x16x32_bf16 v[24:27], a[56:59], a[92:95], v[24:27]
    ds_read_b128 a[40:43], v186 offset:22528
    s_add_u32 m0, s49, 38912
    s_mov_b32 s52, 115456
    buffer_load_dwordx4 v191, s[16:19], s52 offen lds
    v_mfma_f32_16x16x32_bf16 v[28:31], a[56:59], a[96:99], v[28:31]
    ds_read_b128 a[44:47], v186 offset:24576
    s_add_u32 m0, s49, 40960
    s_mov_b32 s52, 131840
    buffer_load_dwordx4 v191, s[16:19], s52 offen lds
    v_mfma_f32_16x16x32_bf16 v[164:167], a[56:59], a[100:103], v[164:167]
    ds_read_b128 a[48:51], v188 offset:18432
    s_add_u32 s51, s48, 3670016
    buffer_load_dwordx4 a[136:139], v190, s[20:23], s51 offen
    v_mfma_f32_16x16x32_bf16 v[32:35], a[60:63], a[84:87], v[32:35]
    ds_read_b64_tr_b16 a[0:1], v176 offset:8192
    s_add_u32 s51, s48, 3678208
    buffer_load_dwordx4 a[140:143], v190, s[20:23], s51 offen
    v_mfma_f32_16x16x32_bf16 v[36:39], a[60:63], a[88:91], v[36:39]
    ds_read_b64_tr_b16 a[2:3], v176 offset:9216
    s_add_u32 s51, s48, 3735552
    buffer_load_dwordx4 a[144:147], v190, s[20:23], s51 offen
    v_mfma_f32_16x16x32_bf16 v[40:43], a[60:63], a[92:95], v[40:43]
    ds_read_b64_tr_b16 a[4:5], v177 offset:8192
    s_add_u32 s51, s48, 3743744
    buffer_load_dwordx4 a[148:151], v190, s[20:23], s51 offen
    v_mfma_f32_16x16x32_bf16 v[44:47], a[60:63], a[96:99], v[44:47]
    ds_read_b64_tr_b16 a[6:7], v177 offset:9216
    buffer_load_dwordx4 a[208:211], v116, s[24:27], s57 offen nt
    v_mfma_f32_16x16x32_bf16 v[168:171], a[60:63], a[100:103], v[168:171]
    ds_read_b64_tr_b16 a[8:9], v178 offset:8192
    buffer_load_dwordx4 a[212:215], v117, s[24:27], s57 offen nt
    s_add_u32 s57, s57, 4096
    v_mfma_f32_16x16x32_bf16 v[48:51], a[64:67], a[84:87], v[48:51]
    ds_read_b64_tr_b16 a[10:11], v178 offset:9216
    v_mfma_f32_16x16x32_bf16 v[52:55], a[64:67], a[88:91], v[52:55]
    ds_read_b64_tr_b16 a[12:13], v179 offset:8192
    v_mfma_f32_16x16x32_bf16 v[56:59], a[64:67], a[92:95], v[56:59]
    ds_read_b64_tr_b16 a[14:15], v179 offset:9216
    v_mfma_f32_16x16x32_bf16 v[60:63], a[64:67], a[96:99], v[60:63]
    ds_read_b64_tr_b16 a[16:17], v180 offset:8192
    v_mfma_f32_16x16x32_bf16 v[172:175], a[64:67], a[100:103], v[172:175]
    ds_read_b64_tr_b16 a[18:19], v180 offset:9216
    v_mfma_f32_16x16x32_bf16 v[64:67], a[68:71], a[84:87], v[64:67]
    ds_read_b64_tr_b16 a[20:21], v181 offset:8192
    v_mfma_f32_16x16x32_bf16 v[68:71], a[68:71], a[88:91], v[68:71]
    ds_read_b64_tr_b16 a[22:23], v181 offset:9216
    v_mfma_f32_16x16x32_bf16 v[72:75], a[68:71], a[92:95], v[72:75]
    ds_read_b64_tr_b16 a[24:25], v182 offset:8192
    v_mfma_f32_16x16x32_bf16 v[76:79], a[68:71], a[96:99], v[76:79]
    ds_read_b64_tr_b16 a[26:27], v182 offset:9216
    v_mfma_f32_16x16x32_bf16 v[80:83], a[72:75], a[84:87], v[80:83]
    ds_read_b64_tr_b16 a[28:29], v183 offset:8192
    v_mfma_f32_16x16x32_bf16 v[84:87], a[72:75], a[88:91], v[84:87]
    ds_read_b64_tr_b16 a[30:31], v183 offset:9216
    v_mfma_f32_16x16x32_bf16 v[88:91], a[72:75], a[92:95], v[88:91]
    v_mfma_f32_16x16x32_bf16 v[92:95], a[72:75], a[96:99], v[92:95]
    v_mfma_f32_16x16x32_bf16 v[96:99], a[76:79], a[84:87], v[96:99]
    v_mfma_f32_16x16x32_bf16 v[100:103], a[76:79], a[88:91], v[100:103]
    v_mfma_f32_16x16x32_bf16 v[104:107], a[76:79], a[92:95], v[104:107]
    v_mfma_f32_16x16x32_bf16 v[108:111], a[76:79], a[96:99], v[108:111]
    v_mfma_f32_16x16x32_bf16 v[144:147], a[80:83], a[84:87], v[144:147]
    v_mfma_f32_16x16x32_bf16 v[148:151], a[80:83], a[88:91], v[148:151]
    v_mfma_f32_16x16x32_bf16 v[152:155], a[80:83], a[92:95], v[152:155]
    v_mfma_f32_16x16x32_bf16 v[156:159], a[80:83], a[96:99], v[156:159]
    s_waitcnt lgkmcnt(0)
    s_barrier
    s_waitcnt vmcnt(26)
    ds_write_b128 v184, a[104:107]
    v_mfma_f32_16x16x32_bf16 v[0:3], a[0:3], a[32:35], v[0:3]
    s_waitcnt vmcnt(25)
    ds_write_b64 v184, a[108:109] offset:264
    v_mfma_f32_16x16x32_bf16 v[4:7], a[0:3], a[36:39], v[4:7]
    ds_write_b64 v184, a[110:111] offset:256
    v_mfma_f32_16x16x32_bf16 v[8:11], a[0:3], a[40:43], v[8:11]
    s_waitcnt vmcnt(24)
    ds_write_b128 v185, a[112:115]
    v_mfma_f32_16x16x32_bf16 v[12:15], a[0:3], a[44:47], v[12:15]
    s_waitcnt vmcnt(23)
    ds_write_b64 v185, a[116:117] offset:264
    v_mfma_f32_16x16x32_bf16 v[160:163], a[0:3], a[48:51], v[160:163]
    ds_write_b64 v185, a[118:119] offset:256
    v_mfma_f32_16x16x32_bf16 v[16:19], a[4:7], a[32:35], v[16:19]
    ds_read_b128 a[84:87], v187 offset:18432
    v_mfma_f32_16x16x32_bf16 v[20:23], a[4:7], a[36:39], v[20:23]
    ds_read_b128 a[88:91], v187 offset:20480
    v_mfma_f32_16x16x32_bf16 v[24:27], a[4:7], a[40:43], v[24:27]
    ds_read_b128 a[92:95], v187 offset:22528
    v_mfma_f32_16x16x32_bf16 v[28:31], a[4:7], a[44:47], v[28:31]
    ds_read_b128 a[96:99], v187 offset:24576
    v_mfma_f32_16x16x32_bf16 v[164:167], a[4:7], a[48:51], v[164:167]
    ds_read_b128 a[100:103], v189 offset:18432
    s_add_u32 s51, s48, 3932160
    buffer_load_dwordx4 a[152:155], v190, s[20:23], s51 offen
    v_mfma_f32_16x16x32_bf16 v[32:35], a[8:11], a[32:35], v[32:35]
    ds_read_b64_tr_b16 a[52:53], v176 offset:16384
    s_add_u32 s51, s48, 3940352
    buffer_load_dwordx4 a[156:159], v190, s[20:23], s51 offen
    v_mfma_f32_16x16x32_bf16 v[36:39], a[8:11], a[36:39], v[36:39]
    ds_read_b64_tr_b16 a[54:55], v176 offset:17408
    s_add_u32 s51, s48, 3997696
    buffer_load_dwordx4 a[160:163], v190, s[20:23], s51 offen
    v_mfma_f32_16x16x32_bf16 v[40:43], a[8:11], a[40:43], v[40:43]
    ds_read_b64_tr_b16 a[56:57], v177 offset:16384
    s_add_u32 s51, s48, 4005888
    buffer_load_dwordx4 a[164:167], v190, s[20:23], s51 offen
    v_mfma_f32_16x16x32_bf16 v[44:47], a[8:11], a[44:47], v[44:47]
    ds_read_b64_tr_b16 a[58:59], v177 offset:17408
    buffer_load_dwordx4 a[216:219], v116, s[24:27], s57 offen nt
    v_mfma_f32_16x16x32_bf16 v[168:171], a[8:11], a[48:51], v[168:171]
    ds_read_b64_tr_b16 a[60:61], v178 offset:16384
    buffer_load_dwordx4 a[220:223], v117, s[24:27], s57 offen nt
    s_add_u32 s57, s57, 4096
    v_mfma_f32_16x16x32_bf16 v[48:51], a[12:15], a[32:35], v[48:51]
    ds_read_b64_tr_b16 a[62:63], v178 offset:17408
    v_mfma_f32_16x16x32_bf16 v[52:55], a[12:15], a[36:39], v[52:55]
    ds_read_b64_tr_b16 a[64:65], v179 offset:16384
    v_mfma_f32_16x16x32_bf16 v[56:59], a[12:15], a[40:43], v[56:59]
    ds_read_b64_tr_b16 a[66:67], v179 offset:17408
    v_mfma_f32_16x16x32_bf16 v[60:63], a[12:15], a[44:47], v[60:63]
    ds_read_b64_tr_b16 a[68:69], v180 offset:16384
    v_mfma_f32_16x16x32_bf16 v[172:175], a[12:15], a[48:51], v[172:175]
    ds_read_b64_tr_b16 a[70:71], v180 offset:17408
    v_mfma_f32_16x16x32_bf16 v[64:67], a[16:19], a[32:35], v[64:67]
    ds_read_b64_tr_b16 a[72:73], v181 offset:16384
    v_mfma_f32_16x16x32_bf16 v[68:71], a[16:19], a[36:39], v[68:71]
    ds_read_b64_tr_b16 a[74:75], v181 offset:17408
    v_mfma_f32_16x16x32_bf16 v[72:75], a[16:19], a[40:43], v[72:75]
    ds_read_b64_tr_b16 a[76:77], v182 offset:16384
    v_mfma_f32_16x16x32_bf16 v[76:79], a[16:19], a[44:47], v[76:79]
    ds_read_b64_tr_b16 a[78:79], v182 offset:17408
    v_mfma_f32_16x16x32_bf16 v[80:83], a[20:23], a[32:35], v[80:83]
    ds_read_b64_tr_b16 a[80:81], v183 offset:16384
    v_mfma_f32_16x16x32_bf16 v[84:87], a[20:23], a[36:39], v[84:87]
    ds_read_b64_tr_b16 a[82:83], v183 offset:17408
    v_mfma_f32_16x16x32_bf16 v[88:91], a[20:23], a[40:43], v[88:91]
    v_mfma_f32_16x16x32_bf16 v[92:95], a[20:23], a[44:47], v[92:95]
    v_mfma_f32_16x16x32_bf16 v[96:99], a[24:27], a[32:35], v[96:99]
    v_mfma_f32_16x16x32_bf16 v[100:103], a[24:27], a[36:39], v[100:103]
    v_mfma_f32_16x16x32_bf16 v[104:107], a[24:27], a[40:43], v[104:107]
    v_mfma_f32_16x16x32_bf16 v[108:111], a[24:27], a[44:47], v[108:111]
    v_mfma_f32_16x16x32_bf16 v[144:147], a[28:31], a[32:35], v[144:147]
    v_mfma_f32_16x16x32_bf16 v[148:151], a[28:31], a[36:39], v[148:151]
    v_mfma_f32_16x16x32_bf16 v[152:155], a[28:31], a[40:43], v[152:155]
    v_mfma_f32_16x16x32_bf16 v[156:159], a[28:31], a[44:47], v[156:159]
    s_waitcnt vmcnt(12) lgkmcnt(0)
    s_barrier
    ds_write_b128 v184, a[120:123] offset:8192
    v_mfma_f32_16x16x32_bf16 v[0:3], a[52:55], a[84:87], v[0:3]
    ds_write_b64 v184, a[124:125] offset:8456
    s_add_u32 m0, s49, 43008
    s_mov_b32 s52, 896
    buffer_load_dwordx4 v191, s[16:19], s52 offen lds
    v_mfma_f32_16x16x32_bf16 v[4:7], a[52:55], a[88:91], v[4:7]
    ds_write_b64 v184, a[126:127] offset:8448
    s_add_u32 m0, s49, 45056
    s_mov_b32 s52, 17280
    buffer_load_dwordx4 v191, s[16:19], s52 offen lds
    v_mfma_f32_16x16x32_bf16 v[8:11], a[52:55], a[92:95], v[8:11]
    ds_write_b128 v185, a[128:131] offset:8192
    s_add_u32 m0, s49, 47104
    s_mov_b32 s52, 33664
    buffer_load_dwordx4 v191, s[16:19], s52 offen lds
    v_mfma_f32_16x16x32_bf16 v[12:15], a[52:55], a[96:99], v[12:15]
    ds_write_b64 v185, a[132:133] offset:8456
    s_add_u32 m0, s49, 49152
    s_mov_b32 s52, 50048
    buffer_load_dwordx4 v191, s[16:19], s52 offen lds
    v_mfma_f32_16x16x32_bf16 v[160:163], a[52:55], a[100:103], v[160:163]
    ds_write_b64 v185, a[134:135] offset:8448
    s_add_u32 m0, s49, 51200
    s_mov_b32 s52, 66432
    buffer_load_dwordx4 v191, s[16:19], s52 offen lds
    v_mfma_f32_16x16x32_bf16 v[16:19], a[56:59], a[84:87], v[16:19]
    ds_read_b128 a[32:35], v186
    s_add_u32 m0, s49, 53248
    s_mov_b32 s52, 82816
    buffer_load_dwordx4 v191, s[16:19], s52 offen lds
    v_mfma_f32_16x16x32_bf16 v[20:23], a[56:59], a[88:91], v[20:23]
    ds_read_b128 a[36:39], v186 offset:2048
    s_add_u32 m0, s49, 55296
    s_mov_b32 s52, 99200
    buffer_load_dwordx4 v191, s[16:19], s52 offen lds
    v_mfma_f32_16x16x32_bf16 v[24:27], a[56:59], a[92:95], v[24:27]
    ds_read_b128 a[40:43], v186 offset:4096
    s_add_u32 m0, s49, 57344
    s_mov_b32 s52, 115584
    buffer_load_dwordx4 v191, s[16:19], s52 offen lds
    v_mfma_f32_16x16x32_bf16 v[28:31], a[56:59], a[96:99], v[28:31]
    ds_read_b128 a[44:47], v186 offset:6144
    s_add_u32 m0, s49, 59392
    s_mov_b32 s52, 131968
    buffer_load_dwordx4 v191, s[16:19], s52 offen lds
    v_mfma_f32_16x16x32_bf16 v[164:167], a[56:59], a[100:103], v[164:167]
    ds_read_b128 a[48:51], v188
    buffer_load_dwordx4 a[224:227], v116, s[24:27], s57 offen nt
    v_mfma_f32_16x16x32_bf16 v[32:35], a[60:63], a[84:87], v[32:35]
    ds_read_b64_tr_b16 a[0:1], v176
    buffer_load_dwordx4 a[228:231], v117, s[24:27], s57 offen nt
    s_add_u32 s57, s57, 4096
    v_mfma_f32_16x16x32_bf16 v[36:39], a[60:63], a[88:91], v[36:39]
    ds_read_b64_tr_b16 a[2:3], v176 offset:1024
    v_mfma_f32_16x16x32_bf16 v[40:43], a[60:63], a[92:95], v[40:43]
    ds_read_b64_tr_b16 a[4:5], v177
    v_mfma_f32_16x16x32_bf16 v[44:47], a[60:63], a[96:99], v[44:47]
    ds_read_b64_tr_b16 a[6:7], v177 offset:1024
    v_mfma_f32_16x16x32_bf16 v[168:171], a[60:63], a[100:103], v[168:171]
    ds_read_b64_tr_b16 a[8:9], v178
    v_mfma_f32_16x16x32_bf16 v[48:51], a[64:67], a[84:87], v[48:51]
    ds_read_b64_tr_b16 a[10:11], v178 offset:1024
    v_mfma_f32_16x16x32_bf16 v[52:55], a[64:67], a[88:91], v[52:55]
    ds_read_b64_tr_b16 a[12:13], v179
    v_mfma_f32_16x16x32_bf16 v[56:59], a[64:67], a[92:95], v[56:59]
    ds_read_b64_tr_b16 a[14:15], v179 offset:1024
    v_mfma_f32_16x16x32_bf16 v[60:63], a[64:67], a[96:99], v[60:63]
    ds_read_b64_tr_b16 a[16:17], v180
    v_mfma_f32_16x16x32_bf16 v[172:175], a[64:67], a[100:103], v[172:175]
    ds_read_b64_tr_b16 a[18:19], v180 offset:1024
    v_mfma_f32_16x16x32_bf16 v[64:67], a[68:71], a[84:87], v[64:67]
    ds_read_b64_tr_b16 a[20:21], v181
    v_mfma_f32_16x16x32_bf16 v[68:71], a[68:71], a[88:91], v[68:71]
    ds_read_b64_tr_b16 a[22:23], v181 offset:1024
    v_mfma_f32_16x16x32_bf16 v[72:75], a[68:71], a[92:95], v[72:75]
    ds_read_b64_tr_b16 a[24:25], v182
    v_mfma_f32_16x16x32_bf16 v[76:79], a[68:71], a[96:99], v[76:79]
    ds_read_b64_tr_b16 a[26:27], v182 offset:1024
    v_mfma_f32_16x16x32_bf16 v[80:83], a[72:75], a[84:87], v[80:83]
    ds_read_b64_tr_b16 a[28:29], v183
    v_mfma_f32_16x16x32_bf16 v[84:87], a[72:75], a[88:91], v[84:87]
    ds_read_b64_tr_b16 a[30:31], v183 offset:1024
    v_mfma_f32_16x16x32_bf16 v[88:91], a[72:75], a[92:95], v[88:91]
    v_mfma_f32_16x16x32_bf16 v[92:95], a[72:75], a[96:99], v[92:95]
    v_mfma_f32_16x16x32_bf16 v[96:99], a[76:79], a[84:87], v[96:99]
    v_mfma_f32_16x16x32_bf16 v[100:103], a[76:79], a[88:91], v[100:103]
    v_mfma_f32_16x16x32_bf16 v[104:107], a[76:79], a[92:95], v[104:107]
    v_mfma_f32_16x16x32_bf16 v[108:111], a[76:79], a[96:99], v[108:111]
    v_mfma_f32_16x16x32_bf16 v[144:147], a[80:83], a[84:87], v[144:147]
    v_mfma_f32_16x16x32_bf16 v[148:151], a[80:83], a[88:91], v[148:151]
    v_mfma_f32_16x16x32_bf16 v[152:155], a[80:83], a[92:95], v[152:155]
    v_mfma_f32_16x16x32_bf16 v[156:159], a[80:83], a[96:99], v[156:159]
    s_waitcnt lgkmcnt(0)
    s_barrier
    s_waitcnt vmcnt(22)
    ds_write_b128 v184, a[136:139] offset:16384
    v_mfma_f32_16x16x32_bf16 v[0:3], a[0:3], a[32:35], v[0:3]
    s_waitcnt vmcnt(21)
    ds_write_b64 v184, a[140:141] offset:16648
    v_mfma_f32_16x16x32_bf16 v[4:7], a[0:3], a[36:39], v[4:7]
    ds_write_b64 v184, a[142:143] offset:16640
    v_mfma_f32_16x16x32_bf16 v[8:11], a[0:3], a[40:43], v[8:11]
    s_waitcnt vmcnt(20)
    ds_write_b128 v185, a[144:147] offset:16384
    v_mfma_f32_16x16x32_bf16 v[12:15], a[0:3], a[44:47], v[12:15]
    s_waitcnt vmcnt(19)
    ds_write_b64 v185, a[148:149] offset:16648
    v_mfma_f32_16x16x32_bf16 v[160:163], a[0:3], a[48:51], v[160:163]
    ds_write_b64 v185, a[150:151] offset:16640
    v_mfma_f32_16x16x32_bf16 v[16:19], a[4:7], a[32:35], v[16:19]
    ds_read_b128 a[84:87], v187
    v_mfma_f32_16x16x32_bf16 v[20:23], a[4:7], a[36:39], v[20:23]
    ds_read_b128 a[88:91], v187 offset:2048
    v_mfma_f32_16x16x32_bf16 v[24:27], a[4:7], a[40:43], v[24:27]
    ds_read_b128 a[92:95], v187 offset:4096
    v_mfma_f32_16x16x32_bf16 v[28:31], a[4:7], a[44:47], v[28:31]
    ds_read_b128 a[96:99], v187 offset:6144
    v_mfma_f32_16x16x32_bf16 v[164:167], a[4:7], a[48:51], v[164:167]
    ds_read_b128 a[100:103], v189
    buffer_load_dwordx4 a[232:235], v118, s[28:31], s58 offen nt
    s_add_u32 s58, s58, 2048
    v_mfma_f32_16x16x32_bf16 v[32:35], a[8:11], a[32:35], v[32:35]
    ds_read_b64_tr_b16 a[52:53], v176 offset:8192
    buffer_load_dwordx4 a[236:239], v118, s[28:31], s58 offen nt
    s_add_u32 s58, s58, 2048
    v_mfma_f32_16x16x32_bf16 v[36:39], a[8:11], a[36:39], v[36:39]
    ds_read_b64_tr_b16 a[54:55], v176 offset:9216
    v_mfma_f32_16x16x32_bf16 v[40:43], a[8:11], a[40:43], v[40:43]
    ds_read_b64_tr_b16 a[56:57], v177 offset:8192
    v_mfma_f32_16x16x32_bf16 v[44:47], a[8:11], a[44:47], v[44:47]
    ds_read_b64_tr_b16 a[58:59], v177 offset:9216
    v_mfma_f32_16x16x32_bf16 v[168:171], a[8:11], a[48:51], v[168:171]
    ds_read_b64_tr_b16 a[60:61], v178 offset:8192
    v_mfma_f32_16x16x32_bf16 v[48:51], a[12:15], a[32:35], v[48:51]
    ds_read_b64_tr_b16 a[62:63], v178 offset:9216
    v_mfma_f32_16x16x32_bf16 v[52:55], a[12:15], a[36:39], v[52:55]
    ds_read_b64_tr_b16 a[64:65], v179 offset:8192
    v_mfma_f32_16x16x32_bf16 v[56:59], a[12:15], a[40:43], v[56:59]
    ds_read_b64_tr_b16 a[66:67], v179 offset:9216
    v_mfma_f32_16x16x32_bf16 v[60:63], a[12:15], a[44:47], v[60:63]
    ds_read_b64_tr_b16 a[68:69], v180 offset:8192
    v_mfma_f32_16x16x32_bf16 v[172:175], a[12:15], a[48:51], v[172:175]
    ds_read_b64_tr_b16 a[70:71], v180 offset:9216
    v_mfma_f32_16x16x32_bf16 v[64:67], a[16:19], a[32:35], v[64:67]
    ds_read_b64_tr_b16 a[72:73], v181 offset:8192
    v_mfma_f32_16x16x32_bf16 v[68:71], a[16:19], a[36:39], v[68:71]
    ds_read_b64_tr_b16 a[74:75], v181 offset:9216
    v_mfma_f32_16x16x32_bf16 v[72:75], a[16:19], a[40:43], v[72:75]
    ds_read_b64_tr_b16 a[76:77], v182 offset:8192
    v_mfma_f32_16x16x32_bf16 v[76:79], a[16:19], a[44:47], v[76:79]
    ds_read_b64_tr_b16 a[78:79], v182 offset:9216
    v_mfma_f32_16x16x32_bf16 v[80:83], a[20:23], a[32:35], v[80:83]
    ds_read_b64_tr_b16 a[80:81], v183 offset:8192
    v_mfma_f32_16x16x32_bf16 v[84:87], a[20:23], a[36:39], v[84:87]
    ds_read_b64_tr_b16 a[82:83], v183 offset:9216
    v_mfma_f32_16x16x32_bf16 v[88:91], a[20:23], a[40:43], v[88:91]
    v_mfma_f32_16x16x32_bf16 v[92:95], a[20:23], a[44:47], v[92:95]
    v_mfma_f32_16x16x32_bf16 v[96:99], a[24:27], a[32:35], v[96:99]
    v_mfma_f32_16x16x32_bf16 v[100:103], a[24:27], a[36:39], v[100:103]
    v_mfma_f32_16x16x32_bf16 v[104:107], a[24:27], a[40:43], v[104:107]
    v_mfma_f32_16x16x32_bf16 v[108:111], a[24:27], a[44:47], v[108:111]
    v_mfma_f32_16x16x32_bf16 v[144:147], a[28:31], a[32:35], v[144:147]
    v_mfma_f32_16x16x32_bf16 v[148:151], a[28:31], a[36:39], v[148:151]
    v_mfma_f32_16x16x32_bf16 v[152:155], a[28:31], a[40:43], v[152:155]
    v_mfma_f32_16x16x32_bf16 v[156:159], a[28:31], a[44:47], v[156:159]
    s_waitcnt vmcnt(4) lgkmcnt(0)
    s_barrier
    ds_write_b128 v184, a[152:155]
    v_mfma_f32_16x16x32_bf16 v[0:3], a[52:55], a[84:87], v[0:3]
    ds_write_b64 v184, a[156:157] offset:264
    v_mfma_f32_16x16x32_bf16 v[4:7], a[52:55], a[88:91], v[4:7]
    ds_write_b64 v184, a[158:159] offset:256
    v_mfma_f32_16x16x32_bf16 v[8:11], a[52:55], a[92:95], v[8:11]
    ds_write_b128 v185, a[160:163]
    v_mfma_f32_16x16x32_bf16 v[12:15], a[52:55], a[96:99], v[12:15]
    ds_write_b64 v185, a[164:165] offset:264
    v_mfma_f32_16x16x32_bf16 v[160:163], a[52:55], a[100:103], v[160:163]
    ds_write_b64 v185, a[166:167] offset:256
    v_mfma_f32_16x16x32_bf16 v[16:19], a[56:59], a[84:87], v[16:19]
    ds_read_b128 a[32:35], v186 offset:18432
    v_mfma_f32_16x16x32_bf16 v[20:23], a[56:59], a[88:91], v[20:23]
    ds_read_b128 a[36:39], v186 offset:20480
    v_mfma_f32_16x16x32_bf16 v[24:27], a[56:59], a[92:95], v[24:27]
    ds_read_b128 a[40:43], v186 offset:22528
    v_mfma_f32_16x16x32_bf16 v[28:31], a[56:59], a[96:99], v[28:31]
    ds_read_b128 a[44:47], v186 offset:24576
    v_mfma_f32_16x16x32_bf16 v[164:167], a[56:59], a[100:103], v[164:167]
    ds_read_b128 a[48:51], v188 offset:18432
    buffer_load_dwordx4 a[240:243], v118, s[28:31], s58 offen nt
    s_add_u32 s58, s58, 2048
    v_mfma_f32_16x16x32_bf16 v[32:35], a[60:63], a[84:87], v[32:35]
    ds_read_b64_tr_b16 a[0:1], v176 offset:16384
    buffer_load_dwordx4 a[244:247], v118, s[28:31], s58 offen nt
    s_add_u32 s58, s58, 2048
    v_mfma_f32_16x16x32_bf16 v[36:39], a[60:63], a[88:91], v[36:39]
    ds_read_b64_tr_b16 a[2:3], v176 offset:17408
    v_mfma_f32_16x16x32_bf16 v[40:43], a[60:63], a[92:95], v[40:43]
    ds_read_b64_tr_b16 a[4:5], v177 offset:16384
    v_mfma_f32_16x16x32_bf16 v[44:47], a[60:63], a[96:99], v[44:47]
    ds_read_b64_tr_b16 a[6:7], v177 offset:17408
    v_mfma_f32_16x16x32_bf16 v[168:171], a[60:63], a[100:103], v[168:171]
    ds_read_b64_tr_b16 a[8:9], v178 offset:16384
    v_mfma_f32_16x16x32_bf16 v[48:51], a[64:67], a[84:87], v[48:51]
    ds_read_b64_tr_b16 a[10:11], v178 offset:17408
    v_mfma_f32_16x16x32_bf16 v[52:55], a[64:67], a[88:91], v[52:55]
    ds_read_b64_tr_b16 a[12:13], v179 offset:16384
    v_mfma_f32_16x16x32_bf16 v[56:59], a[64:67], a[92:95], v[56:59]
    ds_read_b64_tr_b16 a[14:15], v179 offset:17408
    v_mfma_f32_16x16x32_bf16 v[60:63], a[64:67], a[96:99], v[60:63]
    ds_read_b64_tr_b16 a[16:17], v180 offset:16384
    v_mfma_f32_16x16x32_bf16 v[172:175], a[64:67], a[100:103], v[172:175]
    ds_read_b64_tr_b16 a[18:19], v180 offset:17408
    v_mfma_f32_16x16x32_bf16 v[64:67], a[68:71], a[84:87], v[64:67]
    ds_read_b64_tr_b16 a[20:21], v181 offset:16384
    v_mfma_f32_16x16x32_bf16 v[68:71], a[68:71], a[88:91], v[68:71]
    ds_read_b64_tr_b16 a[22:23], v181 offset:17408
    v_mfma_f32_16x16x32_bf16 v[72:75], a[68:71], a[92:95], v[72:75]
    ds_read_b64_tr_b16 a[24:25], v182 offset:16384
    v_mfma_f32_16x16x32_bf16 v[76:79], a[68:71], a[96:99], v[76:79]
    ds_read_b64_tr_b16 a[26:27], v182 offset:17408
    v_mfma_f32_16x16x32_bf16 v[80:83], a[72:75], a[84:87], v[80:83]
    ds_read_b64_tr_b16 a[28:29], v183 offset:16384
    v_mfma_f32_16x16x32_bf16 v[84:87], a[72:75], a[88:91], v[84:87]
    ds_read_b64_tr_b16 a[30:31], v183 offset:17408
    v_mfma_f32_16x16x32_bf16 v[88:91], a[72:75], a[92:95], v[88:91]
    v_mfma_f32_16x16x32_bf16 v[92:95], a[72:75], a[96:99], v[92:95]
    v_mfma_f32_16x16x32_bf16 v[96:99], a[76:79], a[84:87], v[96:99]
    v_mfma_f32_16x16x32_bf16 v[100:103], a[76:79], a[88:91], v[100:103]
    v_mfma_f32_16x16x32_bf16 v[104:107], a[76:79], a[92:95], v[104:107]
    v_mfma_f32_16x16x32_bf16 v[108:111], a[76:79], a[96:99], v[108:111]
    v_mfma_f32_16x16x32_bf16 v[144:147], a[80:83], a[84:87], v[144:147]
    v_mfma_f32_16x16x32_bf16 v[148:151], a[80:83], a[88:91], v[148:151]
    v_mfma_f32_16x16x32_bf16 v[152:155], a[80:83], a[92:95], v[152:155]
    v_mfma_f32_16x16x32_bf16 v[156:159], a[80:83], a[96:99], v[156:159]
    s_waitcnt lgkmcnt(0)
    s_barrier
    v_mfma_f32_16x16x32_bf16 v[0:3], a[0:3], a[32:35], v[0:3]
    v_mfma_f32_16x16x32_bf16 v[4:7], a[0:3], a[36:39], v[4:7]
    v_mfma_f32_16x16x32_bf16 v[8:11], a[0:3], a[40:43], v[8:11]
    v_mfma_f32_16x16x32_bf16 v[12:15], a[0:3], a[44:47], v[12:15]
    v_mfma_f32_16x16x32_bf16 v[160:163], a[0:3], a[48:51], v[160:163]
    v_mfma_f32_16x16x32_bf16 v[16:19], a[4:7], a[32:35], v[16:19]
    ds_read_b128 a[84:87], v187 offset:18432
    v_mfma_f32_16x16x32_bf16 v[20:23], a[4:7], a[36:39], v[20:23]
    ds_read_b128 a[88:91], v187 offset:20480
    v_mfma_f32_16x16x32_bf16 v[24:27], a[4:7], a[40:43], v[24:27]
    ds_read_b128 a[92:95], v187 offset:22528
    v_mfma_f32_16x16x32_bf16 v[28:31], a[4:7], a[44:47], v[28:31]
    ds_read_b128 a[96:99], v187 offset:24576
    v_mfma_f32_16x16x32_bf16 v[164:167], a[4:7], a[48:51], v[164:167]
    ds_read_b128 a[100:103], v189 offset:18432
    buffer_load_dwordx4 a[248:251], v118, s[28:31], s58 offen nt
    s_add_u32 s58, s58, 2048
    v_mfma_f32_16x16x32_bf16 v[32:35], a[8:11], a[32:35], v[32:35]
    ds_read_b64_tr_b16 a[52:53], v176
    buffer_load_dwordx4 a[252:255], v118, s[28:31], s58 offen nt
    s_add_u32 s58, s58, 2048
    v_mfma_f32_16x16x32_bf16 v[36:39], a[8:11], a[36:39], v[36:39]
    ds_read_b64_tr_b16 a[54:55], v176 offset:1024
    v_mfma_f32_16x16x32_bf16 v[40:43], a[8:11], a[40:43], v[40:43]
    ds_read_b64_tr_b16 a[56:57], v177
    v_mfma_f32_16x16x32_bf16 v[44:47], a[8:11], a[44:47], v[44:47]
    ds_read_b64_tr_b16 a[58:59], v177 offset:1024
    v_mfma_f32_16x16x32_bf16 v[168:171], a[8:11], a[48:51], v[168:171]
    ds_read_b64_tr_b16 a[60:61], v178
    v_mfma_f32_16x16x32_bf16 v[48:51], a[12:15], a[32:35], v[48:51]
    ds_read_b64_tr_b16 a[62:63], v178 offset:1024
    v_mfma_f32_16x16x32_bf16 v[52:55], a[12:15], a[36:39], v[52:55]
    ds_read_b64_tr_b16 a[64:65], v179
    v_mfma_f32_16x16x32_bf16 v[56:59], a[12:15], a[40:43], v[56:59]
    ds_read_b64_tr_b16 a[66:67], v179 offset:1024
    v_mfma_f32_16x16x32_bf16 v[60:63], a[12:15], a[44:47], v[60:63]
    ds_read_b64_tr_b16 a[68:69], v180
    v_mfma_f32_16x16x32_bf16 v[172:175], a[12:15], a[48:51], v[172:175]
    ds_read_b64_tr_b16 a[70:71], v180 offset:1024
    v_mfma_f32_16x16x32_bf16 v[64:67], a[16:19], a[32:35], v[64:67]
    ds_read_b64_tr_b16 a[72:73], v181
    v_mfma_f32_16x16x32_bf16 v[68:71], a[16:19], a[36:39], v[68:71]
    ds_read_b64_tr_b16 a[74:75], v181 offset:1024
    v_mfma_f32_16x16x32_bf16 v[72:75], a[16:19], a[40:43], v[72:75]
    ds_read_b64_tr_b16 a[76:77], v182
    v_mfma_f32_16x16x32_bf16 v[76:79], a[16:19], a[44:47], v[76:79]
    ds_read_b64_tr_b16 a[78:79], v182 offset:1024
    v_mfma_f32_16x16x32_bf16 v[80:83], a[20:23], a[32:35], v[80:83]
    ds_read_b64_tr_b16 a[80:81], v183
    v_mfma_f32_16x16x32_bf16 v[84:87], a[20:23], a[36:39], v[84:87]
    ds_read_b64_tr_b16 a[82:83], v183 offset:1024
    v_mfma_f32_16x16x32_bf16 v[88:91], a[20:23], a[40:43], v[88:91]
    v_mfma_f32_16x16x32_bf16 v[92:95], a[20:23], a[44:47], v[92:95]
    v_mfma_f32_16x16x32_bf16 v[96:99], a[24:27], a[32:35], v[96:99]
    v_mfma_f32_16x16x32_bf16 v[100:103], a[24:27], a[36:39], v[100:103]
    v_mfma_f32_16x16x32_bf16 v[104:107], a[24:27], a[40:43], v[104:107]
    v_mfma_f32_16x16x32_bf16 v[108:111], a[24:27], a[44:47], v[108:111]
    v_mfma_f32_16x16x32_bf16 v[144:147], a[28:31], a[32:35], v[144:147]
    v_mfma_f32_16x16x32_bf16 v[148:151], a[28:31], a[36:39], v[148:151]
    v_mfma_f32_16x16x32_bf16 v[152:155], a[28:31], a[40:43], v[152:155]
    v_mfma_f32_16x16x32_bf16 v[156:159], a[28:31], a[44:47], v[156:159]
    s_waitcnt lgkmcnt(0)
    s_barrier
    v_mfma_f32_16x16x32_bf16 v[0:3], a[52:55], a[84:87], v[0:3]
    v_mfma_f32_16x16x32_bf16 v[4:7], a[52:55], a[88:91], v[4:7]
    v_mfma_f32_16x16x32_bf16 v[8:11], a[52:55], a[92:95], v[8:11]
    v_mfma_f32_16x16x32_bf16 v[12:15], a[52:55], a[96:99], v[12:15]
    v_mfma_f32_16x16x32_bf16 v[160:163], a[52:55], a[100:103], v[160:163]
    v_mfma_f32_16x16x32_bf16 v[16:19], a[56:59], a[84:87], v[16:19]
    v_mfma_f32_16x16x32_bf16 v[20:23], a[56:59], a[88:91], v[20:23]
    v_mfma_f32_16x16x32_bf16 v[24:27], a[56:59], a[92:95], v[24:27]
    v_mfma_f32_16x16x32_bf16 v[28:31], a[56:59], a[96:99], v[28:31]
    v_mfma_f32_16x16x32_bf16 v[164:167], a[56:59], a[100:103], v[164:167]
    buffer_load_dwordx4 v[232:235], v118, s[28:31], s58 offen nt
    s_add_u32 s58, s58, 2048
    v_mfma_f32_16x16x32_bf16 v[32:35], a[60:63], a[84:87], v[32:35]
    buffer_load_dwordx4 v[236:239], v118, s[28:31], s58 offen nt
    s_add_u32 s58, s58, 2048
    v_mfma_f32_16x16x32_bf16 v[36:39], a[60:63], a[88:91], v[36:39]
    v_mfma_f32_16x16x32_bf16 v[40:43], a[60:63], a[92:95], v[40:43]
    v_mfma_f32_16x16x32_bf16 v[44:47], a[60:63], a[96:99], v[44:47]
    v_mfma_f32_16x16x32_bf16 v[168:171], a[60:63], a[100:103], v[168:171]
    v_mfma_f32_16x16x32_bf16 v[48:51], a[64:67], a[84:87], v[48:51]
    v_mfma_f32_16x16x32_bf16 v[52:55], a[64:67], a[88:91], v[52:55]
    v_mfma_f32_16x16x32_bf16 v[56:59], a[64:67], a[92:95], v[56:59]
    v_mfma_f32_16x16x32_bf16 v[60:63], a[64:67], a[96:99], v[60:63]
    v_mfma_f32_16x16x32_bf16 v[172:175], a[64:67], a[100:103], v[172:175]
    v_mfma_f32_16x16x32_bf16 v[64:67], a[68:71], a[84:87], v[64:67]
    v_mfma_f32_16x16x32_bf16 v[68:71], a[68:71], a[88:91], v[68:71]
    v_mfma_f32_16x16x32_bf16 v[72:75], a[68:71], a[92:95], v[72:75]
    v_mfma_f32_16x16x32_bf16 v[76:79], a[68:71], a[96:99], v[76:79]
    v_mfma_f32_16x16x32_bf16 v[80:83], a[72:75], a[84:87], v[80:83]
    v_mfma_f32_16x16x32_bf16 v[84:87], a[72:75], a[88:91], v[84:87]
    v_mfma_f32_16x16x32_bf16 v[88:91], a[72:75], a[92:95], v[88:91]
    v_mfma_f32_16x16x32_bf16 v[92:95], a[72:75], a[96:99], v[92:95]
    v_mfma_f32_16x16x32_bf16 v[96:99], a[76:79], a[84:87], v[96:99]
    v_mfma_f32_16x16x32_bf16 v[100:103], a[76:79], a[88:91], v[100:103]
    v_mfma_f32_16x16x32_bf16 v[104:107], a[76:79], a[92:95], v[104:107]
    v_mfma_f32_16x16x32_bf16 v[108:111], a[76:79], a[96:99], v[108:111]
    v_mfma_f32_16x16x32_bf16 v[144:147], a[80:83], a[84:87], v[144:147]
    v_mfma_f32_16x16x32_bf16 v[148:151], a[80:83], a[88:91], v[148:151]
    v_mfma_f32_16x16x32_bf16 v[152:155], a[80:83], a[92:95], v[152:155]
    v_mfma_f32_16x16x32_bf16 v[156:159], a[80:83], a[96:99], v[156:159]
    s_waitcnt lgkmcnt(0)
    s_barrier
    v_mbcnt_lo_u32_b32 v240, -1, 0
    v_mbcnt_hi_u32_b32 v240, -1, v240
    v_lshlrev_b32 v240, 4, v240
    v_add_u32 v240, s49, v240
    ds_write_b128 v240, a[168:171] offset:16384
    ds_write_b128 v240, a[172:175] offset:18432
    ds_write_b128 v240, a[176:179] offset:20480
    ds_write_b128 v240, a[180:183] offset:22528
    ds_write_b128 v240, a[184:187] offset:24576
    ds_write_b128 v240, a[188:191] offset:26624
    ds_write_b128 v240, a[192:195] offset:28672
    ds_write_b128 v240, a[196:199] offset:30720
    ds_write_b128 v240, a[200:203] offset:32768
    ds_write_b128 v240, a[204:207] offset:34816
    ds_write_b128 v240, a[208:211] offset:36864
    ds_write_b128 v240, a[212:215] offset:38912
    ds_write_b128 v240, a[216:219] offset:40960
    ds_write_b128 v240, a[220:223] offset:43008
    s_waitcnt vmcnt(9)
    ds_write_b128 v240, a[224:227] offset:45056
    s_waitcnt vmcnt(8)
    ds_write_b128 v240, a[228:231] offset:47104
    s_waitcnt vmcnt(7)
    ds_write_b128 v240, a[232:235] offset:49152
    s_waitcnt vmcnt(6)
    ds_write_b128 v240, a[236:239] offset:51200
    s_waitcnt vmcnt(5)
    ds_write_b128 v240, a[240:243] offset:53248
    s_waitcnt vmcnt(4)
    ds_write_b128 v240, a[244:247] offset:55296
    s_waitcnt vmcnt(3)
    ds_write_b128 v240, a[248:251] offset:57344
    s_waitcnt vmcnt(2)
    ds_write_b128 v240, a[252:255] offset:59392
    s_waitcnt vmcnt(1)
    ds_write_b128 v240, v[232:235] offset:61440
    s_waitcnt vmcnt(0)
    ds_write_b128 v240, v[236:239] offset:63488
    v_mul_f32 v0, s37, v0
    v_mul_f32 v1, s37, v1
    v_cvt_pk_bf16_f32 v192, v0, v1
    v_mul_f32 v2, s37, v2
    v_mul_f32 v3, s37, v3
    v_cvt_pk_bf16_f32 v193, v2, v3
    v_mul_f32 v16, s37, v16
    v_mul_f32 v17, s37, v17
    v_cvt_pk_bf16_f32 v194, v16, v17
    v_mul_f32 v18, s37, v18
    v_mul_f32 v19, s37, v19
    v_cvt_pk_bf16_f32 v195, v18, v19
    v_accvgpr_write_b32 a160, v192
    v_accvgpr_write_b32 a161, v193
    v_accvgpr_write_b32 a162, v194
    v_accvgpr_write_b32 a163, v195
    v_mul_f32 v32, s37, v32
    v_mul_f32 v33, s37, v33
    v_cvt_pk_bf16_f32 v192, v32, v33
    v_mul_f32 v34, s37, v34
    v_mul_f32 v35, s37, v35
    v_cvt_pk_bf16_f32 v193, v34, v35
    v_mul_f32 v48, s37, v48
    v_mul_f32 v49, s37, v49
    v_cvt_pk_bf16_f32 v194, v48, v49
    v_mul_f32 v50, s37, v50
    v_mul_f32 v51, s37, v51
    v_cvt_pk_bf16_f32 v195, v50, v51
    v_accvgpr_write_b32 a164, v192
    v_accvgpr_write_b32 a165, v193
    v_accvgpr_write_b32 a166, v194
    v_accvgpr_write_b32 a167, v195
    v_mul_f32 v64, s37, v64
    v_mul_f32 v65, s37, v65
    v_cvt_pk_bf16_f32 v192, v64, v65
    v_mul_f32 v66, s37, v66
    v_mul_f32 v67, s37, v67
    v_cvt_pk_bf16_f32 v193, v66, v67
    v_mul_f32 v80, s37, v80
    v_mul_f32 v81, s37, v81
    v_cvt_pk_bf16_f32 v194, v80, v81
    v_mul_f32 v82, s37, v82
    v_mul_f32 v83, s37, v83
    v_cvt_pk_bf16_f32 v195, v82, v83
    v_accvgpr_write_b32 a168, v192
    v_accvgpr_write_b32 a169, v193
    v_accvgpr_write_b32 a170, v194
    v_accvgpr_write_b32 a171, v195
    v_mul_f32 v96, s37, v96
    v_mul_f32 v97, s37, v97
    v_cvt_pk_bf16_f32 v192, v96, v97
    v_mul_f32 v98, s37, v98
    v_mul_f32 v99, s37, v99
    v_cvt_pk_bf16_f32 v193, v98, v99
    v_mul_f32 v144, s37, v144
    v_mul_f32 v145, s37, v145
    v_cvt_pk_bf16_f32 v194, v144, v145
    v_mul_f32 v146, s37, v146
    v_mul_f32 v147, s37, v147
    v_cvt_pk_bf16_f32 v195, v146, v147
    v_accvgpr_write_b32 a172, v192
    v_accvgpr_write_b32 a173, v193
    v_accvgpr_write_b32 a174, v194
    v_accvgpr_write_b32 a175, v195
    v_mul_f32 v4, s37, v4
    v_mul_f32 v5, s37, v5
    v_cvt_pk_bf16_f32 v192, v4, v5
    v_mul_f32 v6, s37, v6
    v_mul_f32 v7, s37, v7
    v_cvt_pk_bf16_f32 v193, v6, v7
    v_mul_f32 v20, s37, v20
    v_mul_f32 v21, s37, v21
    v_cvt_pk_bf16_f32 v194, v20, v21
    v_mul_f32 v22, s37, v22
    v_mul_f32 v23, s37, v23
    v_cvt_pk_bf16_f32 v195, v22, v23
    v_accvgpr_write_b32 a176, v192
    v_accvgpr_write_b32 a177, v193
    v_accvgpr_write_b32 a178, v194
    v_accvgpr_write_b32 a179, v195
    v_mul_f32 v36, s37, v36
    v_mul_f32 v37, s37, v37
    v_cvt_pk_bf16_f32 v192, v36, v37
    v_mul_f32 v38, s37, v38
    v_mul_f32 v39, s37, v39
    v_cvt_pk_bf16_f32 v193, v38, v39
    v_mul_f32 v52, s37, v52
    v_mul_f32 v53, s37, v53
    v_cvt_pk_bf16_f32 v194, v52, v53
    v_mul_f32 v54, s37, v54
    v_mul_f32 v55, s37, v55
    v_cvt_pk_bf16_f32 v195, v54, v55
    v_accvgpr_write_b32 a180, v192
    v_accvgpr_write_b32 a181, v193
    v_accvgpr_write_b32 a182, v194
    v_accvgpr_write_b32 a183, v195
    v_mul_f32 v68, s37, v68
    v_mul_f32 v69, s37, v69
    v_cvt_pk_bf16_f32 v192, v68, v69
    v_mul_f32 v70, s37, v70
    v_mul_f32 v71, s37, v71
    v_cvt_pk_bf16_f32 v193, v70, v71
    v_mul_f32 v84, s37, v84
    v_mul_f32 v85, s37, v85
    v_cvt_pk_bf16_f32 v194, v84, v85
    v_mul_f32 v86, s37, v86
    v_mul_f32 v87, s37, v87
    v_cvt_pk_bf16_f32 v195, v86, v87
    v_accvgpr_write_b32 a184, v192
    v_accvgpr_write_b32 a185, v193
    v_accvgpr_write_b32 a186, v194
    v_accvgpr_write_b32 a187, v195
    v_mul_f32 v100, s37, v100
    v_mul_f32 v101, s37, v101
    v_cvt_pk_bf16_f32 v192, v100, v101
    v_mul_f32 v102, s37, v102
    v_mul_f32 v103, s37, v103
    v_cvt_pk_bf16_f32 v193, v102, v103
    v_mul_f32 v148, s37, v148
    v_mul_f32 v149, s37, v149
    v_cvt_pk_bf16_f32 v194, v148, v149
    v_mul_f32 v150, s37, v150
    v_mul_f32 v151, s37, v151
    v_cvt_pk_bf16_f32 v195, v150, v151
    v_accvgpr_write_b32 a188, v192
    v_accvgpr_write_b32 a189, v193
    v_accvgpr_write_b32 a190, v194
    v_accvgpr_write_b32 a191, v195
    v_mul_f32 v8, s37, v8
    v_mul_f32 v9, s37, v9
    v_cvt_pk_bf16_f32 v192, v8, v9
    v_mul_f32 v10, s37, v10
    v_mul_f32 v11, s37, v11
    v_cvt_pk_bf16_f32 v193, v10, v11
    v_mul_f32 v24, s37, v24
    v_mul_f32 v25, s37, v25
    v_cvt_pk_bf16_f32 v194, v24, v25
    v_mul_f32 v26, s37, v26
    v_mul_f32 v27, s37, v27
    v_cvt_pk_bf16_f32 v195, v26, v27
    v_accvgpr_write_b32 a192, v192
    v_accvgpr_write_b32 a193, v193
    v_accvgpr_write_b32 a194, v194
    v_accvgpr_write_b32 a195, v195
    v_mul_f32 v40, s37, v40
    v_mul_f32 v41, s37, v41
    v_cvt_pk_bf16_f32 v192, v40, v41
    v_mul_f32 v42, s37, v42
    v_mul_f32 v43, s37, v43
    v_cvt_pk_bf16_f32 v193, v42, v43
    v_mul_f32 v56, s37, v56
    v_mul_f32 v57, s37, v57
    v_cvt_pk_bf16_f32 v194, v56, v57
    v_mul_f32 v58, s37, v58
    v_mul_f32 v59, s37, v59
    v_cvt_pk_bf16_f32 v195, v58, v59
    v_accvgpr_write_b32 a196, v192
    v_accvgpr_write_b32 a197, v193
    v_accvgpr_write_b32 a198, v194
    v_accvgpr_write_b32 a199, v195
    v_mul_f32 v72, s37, v72
    v_mul_f32 v73, s37, v73
    v_cvt_pk_bf16_f32 v192, v72, v73
    v_mul_f32 v74, s37, v74
    v_mul_f32 v75, s37, v75
    v_cvt_pk_bf16_f32 v193, v74, v75
    v_mul_f32 v88, s37, v88
    v_mul_f32 v89, s37, v89
    v_cvt_pk_bf16_f32 v194, v88, v89
    v_mul_f32 v90, s37, v90
    v_mul_f32 v91, s37, v91
    v_cvt_pk_bf16_f32 v195, v90, v91
    v_accvgpr_write_b32 a200, v192
    v_accvgpr_write_b32 a201, v193
    v_accvgpr_write_b32 a202, v194
    v_accvgpr_write_b32 a203, v195
    v_mul_f32 v104, s37, v104
    v_mul_f32 v105, s37, v105
    v_cvt_pk_bf16_f32 v192, v104, v105
    v_mul_f32 v106, s37, v106
    v_mul_f32 v107, s37, v107
    v_cvt_pk_bf16_f32 v193, v106, v107
    v_mul_f32 v152, s37, v152
    v_mul_f32 v153, s37, v153
    v_cvt_pk_bf16_f32 v194, v152, v153
    v_mul_f32 v154, s37, v154
    v_mul_f32 v155, s37, v155
    v_cvt_pk_bf16_f32 v195, v154, v155
    v_accvgpr_write_b32 a204, v192
    v_accvgpr_write_b32 a205, v193
    v_accvgpr_write_b32 a206, v194
    v_accvgpr_write_b32 a207, v195
    v_mul_f32 v12, s37, v12
    v_mul_f32 v13, s37, v13
    v_cvt_pk_bf16_f32 v192, v12, v13
    v_mul_f32 v14, s37, v14
    v_mul_f32 v15, s37, v15
    v_cvt_pk_bf16_f32 v193, v14, v15
    v_mul_f32 v28, s37, v28
    v_mul_f32 v29, s37, v29
    v_cvt_pk_bf16_f32 v194, v28, v29
    v_mul_f32 v30, s37, v30
    v_mul_f32 v31, s37, v31
    v_cvt_pk_bf16_f32 v195, v30, v31
    v_accvgpr_write_b32 a208, v192
    v_accvgpr_write_b32 a209, v193
    v_accvgpr_write_b32 a210, v194
    v_accvgpr_write_b32 a211, v195
    v_mul_f32 v44, s37, v44
    v_mul_f32 v45, s37, v45
    v_cvt_pk_bf16_f32 v192, v44, v45
    v_mul_f32 v46, s37, v46
    v_mul_f32 v47, s37, v47
    v_cvt_pk_bf16_f32 v193, v46, v47
    v_mul_f32 v60, s37, v60
    v_mul_f32 v61, s37, v61
    v_cvt_pk_bf16_f32 v194, v60, v61
    v_mul_f32 v62, s37, v62
    v_mul_f32 v63, s37, v63
    v_cvt_pk_bf16_f32 v195, v62, v63
    v_accvgpr_write_b32 a212, v192
    v_accvgpr_write_b32 a213, v193
    v_accvgpr_write_b32 a214, v194
    v_accvgpr_write_b32 a215, v195
    v_mul_f32 v76, s37, v76
    v_mul_f32 v77, s37, v77
    v_cvt_pk_bf16_f32 v192, v76, v77
    v_mul_f32 v78, s37, v78
    v_mul_f32 v79, s37, v79
    v_cvt_pk_bf16_f32 v193, v78, v79
    v_mul_f32 v92, s37, v92
    v_mul_f32 v93, s37, v93
    v_cvt_pk_bf16_f32 v194, v92, v93
    v_mul_f32 v94, s37, v94
    v_mul_f32 v95, s37, v95
    v_cvt_pk_bf16_f32 v195, v94, v95
    v_accvgpr_write_b32 a216, v192
    v_accvgpr_write_b32 a217, v193
    v_accvgpr_write_b32 a218, v194
    v_accvgpr_write_b32 a219, v195
    v_mul_f32 v108, s37, v108
    v_mul_f32 v109, s37, v109
    v_cvt_pk_bf16_f32 v192, v108, v109
    v_mul_f32 v110, s37, v110
    v_mul_f32 v111, s37, v111
    v_cvt_pk_bf16_f32 v193, v110, v111
    v_mul_f32 v156, s37, v156
    v_mul_f32 v157, s37, v157
    v_cvt_pk_bf16_f32 v194, v156, v157
    v_mul_f32 v158, s37, v158
    v_mul_f32 v159, s37, v159
    v_cvt_pk_bf16_f32 v195, v158, v159
    v_accvgpr_write_b32 a220, v192
    v_accvgpr_write_b32 a221, v193
    v_accvgpr_write_b32 a222, v194
    v_accvgpr_write_b32 a223, v195
    v_mbcnt_lo_u32_b32 v200, -1, 0
    v_mbcnt_hi_u32_b32 v200, -1, v200
    v_lshlrev_b32 v201, 4, v200
    v_mul_f32 v160, s37, v160
    v_mul_f32 v161, s37, v161
    v_cvt_pk_bf16_f32 v192, v160, v161
    v_mul_f32 v162, s37, v162
    v_mul_f32 v163, s37, v163
    v_cvt_pk_bf16_f32 v193, v162, v163
    v_mul_f32 v164, s37, v164
    v_mul_f32 v165, s37, v165
    v_cvt_pk_bf16_f32 v194, v164, v165
    v_mul_f32 v166, s37, v166
    v_mul_f32 v167, s37, v167
    v_cvt_pk_bf16_f32 v195, v166, v167
    s_lshl_b32 s51, s36, 11
    v_add_u32 v202, s51, v201
    v_subrev_u32 v200, s51, v201
    ds_write_b128 v202, v[192:195]
    v_mul_f32 v168, s37, v168
    v_mul_f32 v169, s37, v169
    v_cvt_pk_bf16_f32 v196, v168, v169
    v_mul_f32 v170, s37, v170
    v_mul_f32 v171, s37, v171
    v_cvt_pk_bf16_f32 v197, v170, v171
    v_mul_f32 v172, s37, v172
    v_mul_f32 v173, s37, v173
    v_cvt_pk_bf16_f32 v198, v172, v173
    v_mul_f32 v174, s37, v174
    v_mul_f32 v175, s37, v175
    v_cvt_pk_bf16_f32 v199, v174, v175
    ds_write_b128 v202, v[196:199] offset:1024
    s_waitcnt lgkmcnt(0)
    s_barrier
    ds_read_b128 a[224:227], v202
    ds_read_b128 a[228:231], v202 offset:1024
    ds_read_b128 a[232:235], v200 offset:2048
    ds_read_b128 a[236:239], v200 offset:3072
    v_mov_b32 v202, 0
    v_accvgpr_write_b32 a0, v202
    v_accvgpr_write_b32 a1, v202
    v_accvgpr_write_b32 a2, v202
    v_accvgpr_write_b32 a3, v202
    v_accvgpr_write_b32 a4, v202
    v_accvgpr_write_b32 a5, v202
    v_accvgpr_write_b32 a6, v202
    v_accvgpr_write_b32 a7, v202
    v_accvgpr_write_b32 a8, v202
    v_accvgpr_write_b32 a9, v202
    v_accvgpr_write_b32 a10, v202
    v_accvgpr_write_b32 a11, v202
    v_accvgpr_write_b32 a12, v202
    v_accvgpr_write_b32 a13, v202
    v_accvgpr_write_b32 a14, v202
    v_accvgpr_write_b32 a15, v202
    v_accvgpr_write_b32 a16, v202
    v_accvgpr_write_b32 a17, v202
    v_accvgpr_write_b32 a18, v202
    v_accvgpr_write_b32 a19, v202
    v_accvgpr_write_b32 a20, v202
    v_accvgpr_write_b32 a21, v202
    v_accvgpr_write_b32 a22, v202
    v_accvgpr_write_b32 a23, v202
    v_accvgpr_write_b32 a24, v202
    v_accvgpr_write_b32 a25, v202
    v_accvgpr_write_b32 a26, v202
    v_accvgpr_write_b32 a27, v202
    v_accvgpr_write_b32 a28, v202
    v_accvgpr_write_b32 a29, v202
    v_accvgpr_write_b32 a30, v202
    v_accvgpr_write_b32 a31, v202
    v_accvgpr_write_b32 a32, v202
    v_accvgpr_write_b32 a33, v202
    v_accvgpr_write_b32 a34, v202
    v_accvgpr_write_b32 a35, v202
    v_accvgpr_write_b32 a36, v202
    v_accvgpr_write_b32 a37, v202
    v_accvgpr_write_b32 a38, v202
    v_accvgpr_write_b32 a39, v202
    v_accvgpr_write_b32 a40, v202
    v_accvgpr_write_b32 a41, v202
    v_accvgpr_write_b32 a42, v202
    v_accvgpr_write_b32 a43, v202
    v_accvgpr_write_b32 a44, v202
    v_accvgpr_write_b32 a45, v202
    v_accvgpr_write_b32 a46, v202
    v_accvgpr_write_b32 a47, v202
    v_accvgpr_write_b32 a48, v202
    v_accvgpr_write_b32 a49, v202
    v_accvgpr_write_b32 a50, v202
    v_accvgpr_write_b32 a51, v202
    v_accvgpr_write_b32 a52, v202
    v_accvgpr_write_b32 a53, v202
    v_accvgpr_write_b32 a54, v202
    v_accvgpr_write_b32 a55, v202
    v_accvgpr_write_b32 a56, v202
    v_accvgpr_write_b32 a57, v202
    v_accvgpr_write_b32 a58, v202
    v_accvgpr_write_b32 a59, v202
    v_accvgpr_write_b32 a60, v202
    v_accvgpr_write_b32 a61, v202
    v_accvgpr_write_b32 a62, v202
    v_accvgpr_write_b32 a63, v202
    v_accvgpr_write_b32 a64, v202
    v_accvgpr_write_b32 a65, v202
    v_accvgpr_write_b32 a66, v202
    v_accvgpr_write_b32 a67, v202
    v_accvgpr_write_b32 a68, v202
    v_accvgpr_write_b32 a69, v202
    v_accvgpr_write_b32 a70, v202
    v_accvgpr_write_b32 a71, v202
    v_accvgpr_write_b32 a72, v202
    v_accvgpr_write_b32 a73, v202
    v_accvgpr_write_b32 a74, v202
    v_accvgpr_write_b32 a75, v202
    v_accvgpr_write_b32 a76, v202
    v_accvgpr_write_b32 a77, v202
    v_accvgpr_write_b32 a78, v202
    v_accvgpr_write_b32 a79, v202
    v_accvgpr_write_b32 a80, v202
    v_accvgpr_write_b32 a81, v202
    v_accvgpr_write_b32 a82, v202
    v_accvgpr_write_b32 a83, v202
    v_accvgpr_write_b32 a84, v202
    v_accvgpr_write_b32 a85, v202
    v_accvgpr_write_b32 a86, v202
    v_accvgpr_write_b32 a87, v202
    v_accvgpr_write_b32 a88, v202
    v_accvgpr_write_b32 a89, v202
    v_accvgpr_write_b32 a90, v202
    v_accvgpr_write_b32 a91, v202
    v_accvgpr_write_b32 a92, v202
    v_accvgpr_write_b32 a93, v202
    v_accvgpr_write_b32 a94, v202
    v_accvgpr_write_b32 a95, v202
    v_accvgpr_write_b32 a96, v202
    v_accvgpr_write_b32 a97, v202
    v_accvgpr_write_b32 a98, v202
    v_accvgpr_write_b32 a99, v202
    v_accvgpr_write_b32 a100, v202
    v_accvgpr_write_b32 a101, v202
    v_accvgpr_write_b32 a102, v202
    v_accvgpr_write_b32 a103, v202
    v_accvgpr_write_b32 a104, v202
    v_accvgpr_write_b32 a105, v202
    v_accvgpr_write_b32 a106, v202
    v_accvgpr_write_b32 a107, v202
    v_accvgpr_write_b32 a108, v202
    v_accvgpr_write_b32 a109, v202
    v_accvgpr_write_b32 a110, v202
    v_accvgpr_write_b32 a111, v202
    v_accvgpr_write_b32 a112, v202
    v_accvgpr_write_b32 a113, v202
    v_accvgpr_write_b32 a114, v202
    v_accvgpr_write_b32 a115, v202
    v_accvgpr_write_b32 a116, v202
    v_accvgpr_write_b32 a117, v202
    v_accvgpr_write_b32 a118, v202
    v_accvgpr_write_b32 a119, v202
    v_accvgpr_write_b32 a120, v202
    v_accvgpr_write_b32 a121, v202
    v_accvgpr_write_b32 a122, v202
    v_accvgpr_write_b32 a123, v202
    v_accvgpr_write_b32 a124, v202
    v_accvgpr_write_b32 a125, v202
    v_accvgpr_write_b32 a126, v202
    v_accvgpr_write_b32 a127, v202
    v_accvgpr_write_b32 a128, v202
    v_accvgpr_write_b32 a129, v202
    v_accvgpr_write_b32 a130, v202
    v_accvgpr_write_b32 a131, v202
    v_accvgpr_write_b32 a132, v202
    v_accvgpr_write_b32 a133, v202
    v_accvgpr_write_b32 a134, v202
    v_accvgpr_write_b32 a135, v202
    v_accvgpr_write_b32 a136, v202
    v_accvgpr_write_b32 a137, v202
    v_accvgpr_write_b32 a138, v202
    v_accvgpr_write_b32 a139, v202
    v_accvgpr_write_b32 a140, v202
    v_accvgpr_write_b32 a141, v202
    v_accvgpr_write_b32 a142, v202
    v_accvgpr_write_b32 a143, v202
    v_accvgpr_write_b32 a144, v202
    v_accvgpr_write_b32 a145, v202
    v_accvgpr_write_b32 a146, v202
    v_accvgpr_write_b32 a147, v202
    v_accvgpr_write_b32 a148, v202
    v_accvgpr_write_b32 a149, v202
    v_accvgpr_write_b32 a150, v202
    v_accvgpr_write_b32 a151, v202
    v_accvgpr_write_b32 a152, v202
    v_accvgpr_write_b32 a153, v202
    v_accvgpr_write_b32 a154, v202
    v_accvgpr_write_b32 a155, v202
    v_accvgpr_write_b32 a156, v202
    v_accvgpr_write_b32 a157, v202
    v_accvgpr_write_b32 a158, v202
    v_accvgpr_write_b32 a159, v202
    v_mov_b32 v72, 0
    v_mov_b32 v73, 0
    v_mov_b32 v74, 0
    v_mov_b32 v75, 0
    v_mov_b32 v76, 0
    v_mov_b32 v77, 0
    v_mov_b32 v78, 0
    v_mov_b32 v79, 0
    v_mov_b32 v80, 0
    v_mov_b32 v81, 0
    v_mov_b32 v82, 0
    v_mov_b32 v83, 0
    v_mov_b32 v84, 0
    v_mov_b32 v85, 0
    v_mov_b32 v86, 0
    v_mov_b32 v87, 0
    v_mov_b32 v88, 0
    v_mov_b32 v89, 0
    v_mov_b32 v90, 0
    v_mov_b32 v91, 0
    v_mov_b32 v92, 0
    v_mov_b32 v93, 0
    v_mov_b32 v94, 0
    v_mov_b32 v95, 0
    v_mov_b32 v96, 0
    v_mov_b32 v97, 0
    v_mov_b32 v98, 0
    v_mov_b32 v99, 0
    v_mov_b32 v100, 0
    v_mov_b32 v101, 0
    v_mov_b32 v102, 0
    v_mov_b32 v103, 0
    v_mov_b32 v104, 0
    v_mov_b32 v105, 0
    v_mov_b32 v106, 0
    v_mov_b32 v107, 0
    v_mov_b32 v108, 0
    v_mov_b32 v109, 0
    v_mov_b32 v110, 0
    v_mov_b32 v111, 0
    v_mov_b32 v112, 0x3f803f80
    v_mov_b32 v113, 0x3f803f80
    v_mov_b32 v114, 0x3f803f80
    v_mov_b32 v115, 0x3f803f80
    s_mov_b32 s59, 0x41000000
    s_waitcnt vmcnt(0) lgkmcnt(0)
    s_barrier
    ds_read_b128 v[144:147], v208 offset:49152
    ds_read_b128 v[148:151], v209 offset:49152
    s_waitcnt lgkmcnt(1)
    v_mfma_f32_16x16x32_bf16 v[0:3], v[144:147], a[160:163], v[72:75]
    ds_read_b128 v[152:155], v210 offset:49152
    v_mfma_f32_16x16x32_bf16 v[16:19], v[144:147], a[176:179], v[76:79]
    ds_read_b128 v[156:159], v211 offset:49152
    v_mfma_f32_16x16x32_bf16 v[32:35], v[144:147], a[192:195], v[80:83]
    ds_read_b128 v[160:163], v208 offset:53248
    v_mfma_f32_16x16x32_bf16 v[48:51], v[144:147], a[208:211], v[84:87]
    ds_read_b128 v[164:167], v209 offset:53248
    v_mfma_f32_16x16x32_bf16 v[64:67], v[144:147], a[224:227], v[88:91]
    ds_read_b128 v[168:171], v210 offset:53248
    s_waitcnt lgkmcnt(5)
    v_mfma_f32_16x16x32_bf16 v[0:3], v[148:151], a[164:167], v[0:3]
    ds_read_b128 v[172:175], v211 offset:53248
    v_mfma_f32_16x16x32_bf16 v[16:19], v[148:151], a[180:183], v[16:19]
    ds_read_b128 v[176:179], v212 offset:57344
    v_mfma_f32_16x16x32_bf16 v[32:35], v[148:151], a[196:199], v[32:35]
    ds_read_b128 v[180:183], v213 offset:57344
    v_mfma_f32_16x16x32_bf16 v[48:51], v[148:151], a[212:215], v[48:51]
    ds_read_b128 v[184:187], v214 offset:57344
    v_mfma_f32_16x16x32_bf16 v[64:67], v[148:151], a[228:231], v[64:67]
    ds_read_b128 v[188:191], v215 offset:57344
    s_waitcnt lgkmcnt(9)
    v_mfma_f32_16x16x32_bf16 v[0:3], v[152:155], a[168:171], v[0:3]
    ds_read_b128 v[192:195], v212 offset:61440
    v_mfma_f32_16x16x32_bf16 v[16:19], v[152:155], a[184:187], v[16:19]
    ds_read_b128 v[196:199], v213 offset:61440
    v_mfma_f32_16x16x32_bf16 v[32:35], v[152:155], a[200:203], v[32:35]
    ds_read_b128 v[200:203], v214 offset:61440
    v_mfma_f32_16x16x32_bf16 v[48:51], v[152:155], a[216:219], v[48:51]
    ds_read_b128 v[204:207], v215 offset:61440
    v_mfma_f32_16x16x32_bf16 v[64:67], v[152:155], a[232:235], v[64:67]
    s_waitcnt lgkmcnt(12)
    v_mfma_f32_16x16x32_bf16 v[0:3], v[156:159], a[172:175], v[0:3]
    v_mfma_f32_16x16x32_bf16 v[16:19], v[156:159], a[188:191], v[16:19]
    v_mfma_f32_16x16x32_bf16 v[32:35], v[156:159], a[204:207], v[32:35]
    v_mfma_f32_16x16x32_bf16 v[48:51], v[156:159], a[220:223], v[48:51]
    v_mfma_f32_16x16x32_bf16 v[64:67], v[156:159], a[236:239], v[64:67]
    s_waitcnt lgkmcnt(11)
    v_mfma_f32_16x16x32_bf16 v[4:7], v[160:163], a[160:163], v[72:75]
    v_mfma_f32_16x16x32_bf16 v[20:23], v[160:163], a[176:179], v[76:79]
    v_mfma_f32_16x16x32_bf16 v[36:39], v[160:163], a[192:195], v[80:83]
    v_mfma_f32_16x16x32_bf16 v[52:55], v[160:163], a[208:211], v[84:87]
    v_mfma_f32_16x16x32_bf16 v[68:71], v[160:163], a[224:227], v[88:91]
    s_waitcnt lgkmcnt(10)
    v_mfma_f32_16x16x32_bf16 v[4:7], v[164:167], a[164:167], v[4:7]
    v_mfma_f32_16x16x32_bf16 v[20:23], v[164:167], a[180:183], v[20:23]
    v_mfma_f32_16x16x32_bf16 v[36:39], v[164:167], a[196:199], v[36:39]
    v_mfma_f32_16x16x32_bf16 v[52:55], v[164:167], a[212:215], v[52:55]
    v_mfma_f32_16x16x32_bf16 v[68:71], v[164:167], a[228:231], v[68:71]
    s_waitcnt lgkmcnt(9)
    v_mfma_f32_16x16x32_bf16 v[4:7], v[168:171], a[168:171], v[4:7]
    v_mfma_f32_16x16x32_bf16 v[20:23], v[168:171], a[184:187], v[20:23]
    v_mfma_f32_16x16x32_bf16 v[36:39], v[168:171], a[200:203], v[36:39]
    v_mfma_f32_16x16x32_bf16 v[52:55], v[168:171], a[216:219], v[52:55]
    v_mfma_f32_16x16x32_bf16 v[68:71], v[168:171], a[232:235], v[68:71]
    s_waitcnt lgkmcnt(8)
    v_mfma_f32_16x16x32_bf16 v[4:7], v[172:175], a[172:175], v[4:7]
    v_mfma_f32_16x16x32_bf16 v[20:23], v[172:175], a[188:191], v[20:23]
    v_mfma_f32_16x16x32_bf16 v[36:39], v[172:175], a[204:207], v[36:39]
    v_mfma_f32_16x16x32_bf16 v[52:55], v[172:175], a[220:223], v[52:55]
    v_mfma_f32_16x16x32_bf16 v[68:71], v[172:175], a[236:239], v[68:71]
    v_max3_f32 v120, v0, v1, v2
    v_max3_f32 v121, v16, v17, v18
    v_max3_f32 v122, v32, v33, v34
    v_max3_f32 v123, v48, v49, v50
    v_max3_f32 v124, v64, v65, v66
    v_max3_f32 v120, v120, v3, v4
    v_max3_f32 v121, v121, v19, v20
    v_max3_f32 v122, v122, v35, v36
    v_max3_f32 v123, v123, v51, v52
    v_max3_f32 v124, v124, v67, v68
    v_max3_f32 v120, v120, v5, v6
    v_max3_f32 v121, v121, v21, v22
    v_max3_f32 v122, v122, v37, v38
    v_max3_f32 v123, v123, v53, v54
    v_max3_f32 v124, v124, v69, v70
    v_max_f32 v120, v120, v7
    v_max_f32 v121, v121, v23
    v_max_f32 v122, v122, v39
    v_max_f32 v123, v123, v55
    v_max_f32 v124, v124, v71
    v_mov_b32 v126, v120
    v_mov_b32 v127, v121
    v_mov_b32 v128, v122
    v_mov_b32 v129, v123
    v_mov_b32 v130, v124
    v_permlane16_swap_b32 v120, v126
    v_permlane16_swap_b32 v121, v127
    v_permlane16_swap_b32 v122, v128
    v_permlane16_swap_b32 v123, v129
    v_permlane16_swap_b32 v124, v130
    v_max_f32 v120, v120, v126
    v_max_f32 v121, v121, v127
    v_max_f32 v122, v122, v128
    v_max_f32 v123, v123, v129
    v_max_f32 v124, v124, v130
    v_mov_b32 v126, v120
    v_mov_b32 v127, v121
    v_mov_b32 v128, v122
    v_mov_b32 v129, v123
    v_mov_b32 v130, v124
    v_permlane32_swap_b32 v120, v126
    v_permlane32_swap_b32 v121, v127
    v_permlane32_swap_b32 v122, v128
    v_permlane32_swap_b32 v123, v129
    v_permlane32_swap_b32 v124, v130
    v_max_f32 v120, v120, v126
    v_max_f32 v121, v121, v127
    v_max_f32 v122, v122, v128
    v_max_f32 v123, v123, v129
    v_max_f32 v124, v124, v130
    v_sub_f32 v0, v0, v120
    v_sub_f32 v1, v1, v120
    v_sub_f32 v2, v2, v120
    v_sub_f32 v3, v3, v120
    v_sub_f32 v4, v4, v120
    v_sub_f32 v5, v5, v120
    v_sub_f32 v6, v6, v120
    v_sub_f32 v7, v7, v120
    v_sub_f32 v72, v72, v120
    v_sub_f32 v73, v73, v120
    v_sub_f32 v74, v74, v120
    v_sub_f32 v75, v75, v120
    v_sub_f32 v16, v16, v121
    v_sub_f32 v17, v17, v121
    v_sub_f32 v18, v18, v121
    v_sub_f32 v19, v19, v121
    v_sub_f32 v20, v20, v121
    v_sub_f32 v21, v21, v121
    v_sub_f32 v22, v22, v121
    v_sub_f32 v23, v23, v121
    v_sub_f32 v76, v76, v121
    v_sub_f32 v77, v77, v121
    v_sub_f32 v78, v78, v121
    v_sub_f32 v79, v79, v121
    v_sub_f32 v32, v32, v122
    v_sub_f32 v33, v33, v122
    v_sub_f32 v34, v34, v122
    v_sub_f32 v35, v35, v122
    v_sub_f32 v36, v36, v122
    v_sub_f32 v37, v37, v122
    v_sub_f32 v38, v38, v122
    v_sub_f32 v39, v39, v122
    v_sub_f32 v80, v80, v122
    v_sub_f32 v81, v81, v122
    v_sub_f32 v82, v82, v122
    v_sub_f32 v83, v83, v122
    v_sub_f32 v48, v48, v123
    v_sub_f32 v49, v49, v123
    v_sub_f32 v50, v50, v123
    v_sub_f32 v51, v51, v123
    v_sub_f32 v52, v52, v123
    v_sub_f32 v53, v53, v123
    v_sub_f32 v54, v54, v123
    v_sub_f32 v55, v55, v123
    v_sub_f32 v84, v84, v123
    v_sub_f32 v85, v85, v123
    v_sub_f32 v86, v86, v123
    v_sub_f32 v87, v87, v123
    v_sub_f32 v64, v64, v124
    v_sub_f32 v65, v65, v124
    v_sub_f32 v66, v66, v124
    v_sub_f32 v67, v67, v124
    v_sub_f32 v68, v68, v124
    v_sub_f32 v69, v69, v124
    v_sub_f32 v70, v70, v124
    v_sub_f32 v71, v71, v124
    v_sub_f32 v88, v88, v124
    v_sub_f32 v89, v89, v124
    v_sub_f32 v90, v90, v124
    v_sub_f32 v91, v91, v124
    v_exp_f32 v0, v0
    v_exp_f32 v1, v1
    s_waitcnt lgkmcnt(7)
    v_mfma_f32_16x16x32_bf16 v[8:11], v[176:179], a[160:163], v[72:75]
    v_exp_f32 v2, v2
    v_exp_f32 v3, v3
    v_mfma_f32_16x16x32_bf16 v[24:27], v[176:179], a[176:179], v[76:79]
    v_exp_f32 v4, v4
    v_exp_f32 v5, v5
    v_mfma_f32_16x16x32_bf16 v[40:43], v[176:179], a[192:195], v[80:83]
    v_exp_f32 v6, v6
    v_exp_f32 v7, v7
    v_mfma_f32_16x16x32_bf16 v[56:59], v[176:179], a[208:211], v[84:87]
    v_cvt_pk_bf16_f32 v0, v0, v1
    v_cvt_pk_bf16_f32 v1, v2, v3
    s_waitcnt lgkmcnt(6)
    v_mfma_f32_16x16x32_bf16 v[8:11], v[180:183], a[164:167], v[8:11]
    v_cvt_pk_bf16_f32 v2, v4, v5
    v_cvt_pk_bf16_f32 v3, v6, v7
    v_mfma_f32_16x16x32_bf16 v[24:27], v[180:183], a[180:183], v[24:27]
    v_exp_f32 v16, v16
    v_exp_f32 v17, v17
    v_mfma_f32_16x16x32_bf16 v[40:43], v[180:183], a[196:199], v[40:43]
    v_exp_f32 v18, v18
    v_exp_f32 v19, v19
    v_mfma_f32_16x16x32_bf16 v[56:59], v[180:183], a[212:215], v[56:59]
    v_exp_f32 v20, v20
    v_exp_f32 v21, v21
    s_waitcnt lgkmcnt(5)
    v_mfma_f32_16x16x32_bf16 v[8:11], v[184:187], a[168:171], v[8:11]
    v_exp_f32 v22, v22
    v_exp_f32 v23, v23
    v_mfma_f32_16x16x32_bf16 v[24:27], v[184:187], a[184:187], v[24:27]
    v_cvt_pk_bf16_f32 v16, v16, v17
    v_cvt_pk_bf16_f32 v17, v18, v19
    v_mfma_f32_16x16x32_bf16 v[40:43], v[184:187], a[200:203], v[40:43]
    v_cvt_pk_bf16_f32 v18, v20, v21
    v_cvt_pk_bf16_f32 v19, v22, v23
    v_mfma_f32_16x16x32_bf16 v[56:59], v[184:187], a[216:219], v[56:59]
    v_exp_f32 v32, v32
    v_exp_f32 v33, v33
    s_waitcnt lgkmcnt(4)
    v_mfma_f32_16x16x32_bf16 v[8:11], v[188:191], a[172:175], v[8:11]
    v_exp_f32 v34, v34
    v_exp_f32 v35, v35
    v_mfma_f32_16x16x32_bf16 v[24:27], v[188:191], a[188:191], v[24:27]
    v_exp_f32 v36, v36
    v_exp_f32 v37, v37
    v_mfma_f32_16x16x32_bf16 v[40:43], v[188:191], a[204:207], v[40:43]
    v_exp_f32 v38, v38
    v_exp_f32 v39, v39
    v_mfma_f32_16x16x32_bf16 v[56:59], v[188:191], a[220:223], v[56:59]
    v_cvt_pk_bf16_f32 v32, v32, v33
    v_cvt_pk_bf16_f32 v33, v34, v35
    s_waitcnt lgkmcnt(3)
    v_mfma_f32_16x16x32_bf16 v[12:15], v[192:195], a[160:163], v[72:75]
    v_cvt_pk_bf16_f32 v34, v36, v37
    v_cvt_pk_bf16_f32 v35, v38, v39
    v_mfma_f32_16x16x32_bf16 v[28:31], v[192:195], a[176:179], v[76:79]
    v_exp_f32 v48, v48
    v_exp_f32 v49, v49
    v_mfma_f32_16x16x32_bf16 v[44:47], v[192:195], a[192:195], v[80:83]
    v_exp_f32 v50, v50
    v_exp_f32 v51, v51
    v_mfma_f32_16x16x32_bf16 v[60:63], v[192:195], a[208:211], v[84:87]
    v_exp_f32 v52, v52
    v_exp_f32 v53, v53
    s_waitcnt lgkmcnt(2)
    v_mfma_f32_16x16x32_bf16 v[12:15], v[196:199], a[164:167], v[12:15]
    v_exp_f32 v54, v54
    v_exp_f32 v55, v55
    v_mfma_f32_16x16x32_bf16 v[28:31], v[196:199], a[180:183], v[28:31]
    v_cvt_pk_bf16_f32 v48, v48, v49
    v_cvt_pk_bf16_f32 v49, v50, v51
    v_mfma_f32_16x16x32_bf16 v[44:47], v[196:199], a[196:199], v[44:47]
    v_cvt_pk_bf16_f32 v50, v52, v53
    v_cvt_pk_bf16_f32 v51, v54, v55
    v_mfma_f32_16x16x32_bf16 v[60:63], v[196:199], a[212:215], v[60:63]
    v_exp_f32 v64, v64
    v_exp_f32 v65, v65
    s_waitcnt lgkmcnt(1)
    v_mfma_f32_16x16x32_bf16 v[12:15], v[200:203], a[168:171], v[12:15]
    v_exp_f32 v66, v66
    v_exp_f32 v67, v67
    v_mfma_f32_16x16x32_bf16 v[28:31], v[200:203], a[184:187], v[28:31]
    v_exp_f32 v68, v68
    v_exp_f32 v69, v69
    v_mfma_f32_16x16x32_bf16 v[44:47], v[200:203], a[200:203], v[44:47]
    v_exp_f32 v70, v70
    v_exp_f32 v71, v71
    v_mfma_f32_16x16x32_bf16 v[60:63], v[200:203], a[216:219], v[60:63]
    v_cvt_pk_bf16_f32 v64, v64, v65
    v_cvt_pk_bf16_f32 v65, v66, v67
    s_waitcnt lgkmcnt(0)
    v_mfma_f32_16x16x32_bf16 v[12:15], v[204:207], a[172:175], v[12:15]
    v_cvt_pk_bf16_f32 v66, v68, v69
    v_cvt_pk_bf16_f32 v67, v70, v71
    v_mfma_f32_16x16x32_bf16 v[28:31], v[204:207], a[188:191], v[28:31]
    v_mfma_f32_16x16x32_bf16 v[44:47], v[204:207], a[204:207], v[44:47]
    v_mfma_f32_16x16x32_bf16 v[60:63], v[204:207], a[220:223], v[60:63]
    s_waitcnt vmcnt(0) lgkmcnt(0)
    s_waitcnt vmcnt(0) lgkmcnt(0)
    s_barrier
    ds_read_b64_tr_b16 v[144:145], v216
    ds_read_b64_tr_b16 v[146:147], v216 offset:4096
    v_max3_f32 v120, v8, v9, v10
    s_add_u32 m0, s49, 65536
    s_nop 0
    buffer_load_dwordx4 v116, s[24:27], s57 offen nt lds
    v_mfma_f32_16x16x32_bf16 v[92:95], v[112:115], v[0:3], v[92:95]
    ds_read_b64_tr_b16 v[148:149], v217
    ds_read_b64_tr_b16 v[150:151], v217 offset:4096
    v_max3_f32 v121, v24, v25, v26
    v_mfma_f32_16x16x32_bf16 v[96:99], v[112:115], v[16:19], v[96:99]
    ds_read_b64_tr_b16 v[152:153], v218
    ds_read_b64_tr_b16 v[154:155], v218 offset:4096
    v_max3_f32 v122, v40, v41, v42
    v_mfma_f32_16x16x32_bf16 v[100:103], v[112:115], v[32:35], v[100:103]
    ds_read_b64_tr_b16 v[156:157], v219
    ds_read_b64_tr_b16 v[158:159], v219 offset:4096
    v_max3_f32 v123, v56, v57, v58
    v_mfma_f32_16x16x32_bf16 v[104:107], v[112:115], v[48:51], v[104:107]
    ds_read_b64_tr_b16 v[160:161], v220
    ds_read_b64_tr_b16 v[162:163], v220 offset:4096
    v_max3_f32 v120, v120, v11, v12
    v_mfma_f32_16x16x32_bf16 v[108:111], v[112:115], v[64:67], v[108:111]
    ds_read_b64_tr_b16 v[164:165], v221
    ds_read_b64_tr_b16 v[166:167], v221 offset:4096
    v_max3_f32 v121, v121, v27, v28
    s_waitcnt lgkmcnt(10)
    v_mfma_f32_16x16x32_bf16 a[0:3], v[144:147], v[0:3], a[0:3]
    ds_read_b64_tr_b16 v[168:169], v222
    ds_read_b64_tr_b16 v[170:171], v222 offset:4096
    v_max3_f32 v122, v122, v43, v44
    v_mfma_f32_16x16x32_bf16 a[32:35], v[144:147], v[16:19], a[32:35]
    ds_read_b64_tr_b16 v[172:173], v223
    ds_read_b64_tr_b16 v[174:175], v223 offset:4096
    v_max3_f32 v123, v123, v59, v60
    v_mfma_f32_16x16x32_bf16 a[64:67], v[144:147], v[32:35], a[64:67]
    ds_read_b128 v[176:179], v208 offset:16384
    v_max3_f32 v120, v120, v13, v14
    v_mfma_f32_16x16x32_bf16 a[96:99], v[144:147], v[48:51], a[96:99]
    ds_read_b128 v[180:183], v209 offset:16384
    v_max3_f32 v121, v121, v29, v30
    v_mfma_f32_16x16x32_bf16 a[128:131], v[144:147], v[64:67], a[128:131]
    ds_read_b128 v[184:187], v210 offset:16384
    v_max3_f32 v122, v122, v45, v46
    s_waitcnt lgkmcnt(15)
    v_mfma_f32_16x16x32_bf16 a[4:7], v[148:151], v[0:3], a[4:7]
    ds_read_b128 v[188:191], v211 offset:16384
    v_max3_f32 v123, v123, v61, v62
    v_mfma_f32_16x16x32_bf16 a[36:39], v[148:151], v[16:19], a[36:39]
    ds_read_b128 v[192:195], v208 offset:20480
    v_max_f32 v120, v120, v15
    v_mfma_f32_16x16x32_bf16 a[68:71], v[148:151], v[32:35], a[68:71]
    ds_read_b128 v[196:199], v209 offset:20480
    v_max_f32 v121, v121, v31
    v_mfma_f32_16x16x32_bf16 a[100:103], v[148:151], v[48:51], a[100:103]
    ds_read_b128 v[200:203], v210 offset:20480
    v_max_f32 v122, v122, v47
    v_mfma_f32_16x16x32_bf16 a[132:135], v[148:151], v[64:67], a[132:135]
    ds_read_b128 v[204:207], v211 offset:20480
    v_max_f32 v123, v123, v63
    s_waitcnt lgkmcnt(15)
    v_mfma_f32_16x16x32_bf16 a[8:11], v[152:155], v[0:3], a[8:11]
    ds_read_b64_tr_b16 v[144:145], v224 offset:8192
    ds_read_b64_tr_b16 v[146:147], v224 offset:12288
    s_add_u32 m0, s49, 67584
    s_nop 0
    buffer_load_dwordx4 v117, s[24:27], s57 offen nt lds
    s_add_u32 s57, s57, 4096
    v_mfma_f32_16x16x32_bf16 a[40:43], v[152:155], v[16:19], a[40:43]
    ds_read_b64_tr_b16 v[148:149], v225 offset:8192
    ds_read_b64_tr_b16 v[150:151], v225 offset:12288
    s_add_u32 m0, s49, 69632
    s_nop 0
    buffer_load_dwordx4 v116, s[24:27], s57 offen nt lds
    v_mfma_f32_16x16x32_bf16 a[72:75], v[152:155], v[32:35], a[72:75]
    s_add_u32 m0, s49, 71680
    s_nop 0
    buffer_load_dwordx4 v117, s[24:27], s57 offen nt lds
    s_add_u32 s57, s57, 4096
    v_mfma_f32_16x16x32_bf16 a[104:107], v[152:155], v[48:51], a[104:107]
    v_mfma_f32_16x16x32_bf16 a[136:139], v[152:155], v[64:67], a[136:139]
    ds_read_b64_tr_b16 v[152:153], v226 offset:8192
    ds_read_b64_tr_b16 v[154:155], v226 offset:12288
    v_mfma_f32_16x16x32_bf16 a[12:15], v[156:159], v[0:3], a[12:15]
    v_mfma_f32_16x16x32_bf16 a[44:47], v[156:159], v[16:19], a[44:47]
    v_mfma_f32_16x16x32_bf16 a[76:79], v[156:159], v[32:35], a[76:79]
    v_mfma_f32_16x16x32_bf16 a[108:111], v[156:159], v[48:51], a[108:111]
    s_add_u32 m0, s49, 73728
    s_nop 0
    buffer_load_dwordx4 v116, s[24:27], s57 offen nt lds
    v_mfma_f32_16x16x32_bf16 a[140:143], v[156:159], v[64:67], a[140:143]
    ds_read_b64_tr_b16 v[156:157], v227 offset:8192
    ds_read_b64_tr_b16 v[158:159], v227 offset:12288
    s_waitcnt lgkmcnt(15)
    v_mfma_f32_16x16x32_bf16 a[16:19], v[160:163], v[0:3], a[16:19]
    v_mfma_f32_16x16x32_bf16 a[48:51], v[160:163], v[16:19], a[48:51]
    v_mfma_f32_16x16x32_bf16 a[80:83], v[160:163], v[32:35], a[80:83]
    v_mfma_f32_16x16x32_bf16 a[112:115], v[160:163], v[48:51], a[112:115]
    v_mfma_f32_16x16x32_bf16 a[144:147], v[160:163], v[64:67], a[144:147]
    ds_read_b64_tr_b16 v[160:161], v228 offset:8192
    ds_read_b64_tr_b16 v[162:163], v228 offset:12288
    s_add_u32 m0, s49, 75776
    s_nop 0
    buffer_load_dwordx4 v117, s[24:27], s57 offen nt lds
    s_add_u32 s57, s57, 4096
    v_mfma_f32_16x16x32_bf16 a[20:23], v[164:167], v[0:3], a[20:23]
    v_mfma_f32_16x16x32_bf16 a[52:55], v[164:167], v[16:19], a[52:55]
    v_mfma_f32_16x16x32_bf16 a[84:87], v[164:167], v[32:35], a[84:87]
    v_mfma_f32_16x16x32_bf16 a[116:119], v[164:167], v[48:51], a[116:119]
    v_mfma_f32_16x16x32_bf16 a[148:151], v[164:167], v[64:67], a[148:151]
    ds_read_b64_tr_b16 v[164:165], v229 offset:8192
    ds_read_b64_tr_b16 v[166:167], v229 offset:12288
    v_mfma_f32_16x16x32_bf16 a[24:27], v[168:171], v[0:3], a[24:27]
    s_add_u32 m0, s49, 77824
    s_nop 0
    buffer_load_dwordx4 v116, s[24:27], s57 offen nt lds
    v_mfma_f32_16x16x32_bf16 a[56:59], v[168:171], v[16:19], a[56:59]
    v_mfma_f32_16x16x32_bf16 a[88:91], v[168:171], v[32:35], a[88:91]
    v_mfma_f32_16x16x32_bf16 a[120:123], v[168:171], v[48:51], a[120:123]
    v_mfma_f32_16x16x32_bf16 a[152:155], v[168:171], v[64:67], a[152:155]
    ds_read_b64_tr_b16 v[168:169], v230 offset:8192
    ds_read_b64_tr_b16 v[170:171], v230 offset:12288
    v_mfma_f32_16x16x32_bf16 a[28:31], v[172:175], v[0:3], a[28:31]
    v_mfma_f32_16x16x32_bf16 a[60:63], v[172:175], v[16:19], a[60:63]
    s_add_u32 m0, s49, 79872
    s_nop 0
    buffer_load_dwordx4 v117, s[24:27], s57 offen nt lds
    s_add_u32 s57, s57, 4096
    v_mfma_f32_16x16x32_bf16 a[92:95], v[172:175], v[32:35], a[92:95]
    v_mfma_f32_16x16x32_bf16 a[124:127], v[172:175], v[48:51], a[124:127]
    v_mfma_f32_16x16x32_bf16 a[156:159], v[172:175], v[64:67], a[156:159]
    ds_read_b64_tr_b16 v[172:173], v231 offset:8192
    ds_read_b64_tr_b16 v[174:175], v231 offset:12288
    v_max3_f32 v125, v120, v121, v122
    v_max_f32 v125, v125, v123
    v_cmp_lt_f32 vcc, s59, v125
    s_nop 4
    s_cbranch_vccnz attn_kernel_n1
attn_kernel_n2:
    v_exp_f32 v8, v8
    v_exp_f32 v9, v9
    v_mfma_f32_16x16x32_bf16 v[0:3], v[176:179], a[160:163], v[72:75]
    v_exp_f32 v10, v10
    v_exp_f32 v11, v11
    v_mfma_f32_16x16x32_bf16 v[16:19], v[176:179], a[176:179], v[76:79]
    v_exp_f32 v12, v12
    v_exp_f32 v13, v13
    v_mfma_f32_16x16x32_bf16 v[32:35], v[176:179], a[192:195], v[80:83]
    v_exp_f32 v14, v14
    v_exp_f32 v15, v15
    v_mfma_f32_16x16x32_bf16 v[48:51], v[176:179], a[208:211], v[84:87]
    v_cvt_pk_bf16_f32 v8, v8, v9
    v_cvt_pk_bf16_f32 v9, v10, v11
    v_mfma_f32_16x16x32_bf16 v[64:67], v[176:179], a[224:227], v[88:91]
    ds_read_b128 v[176:179], v212 offset:24576
    v_cvt_pk_bf16_f32 v10, v12, v13
    s_waitcnt lgkmcnt(15)
    v_mfma_f32_16x16x32_bf16 v[0:3], v[180:183], a[164:167], v[0:3]
    v_cvt_pk_bf16_f32 v11, v14, v15
    v_exp_f32 v24, v24
    v_mfma_f32_16x16x32_bf16 v[16:19], v[180:183], a[180:183], v[16:19]
    v_exp_f32 v25, v25
    v_exp_f32 v26, v26
    v_mfma_f32_16x16x32_bf16 v[32:35], v[180:183], a[196:199], v[32:35]
    v_exp_f32 v27, v27
    v_exp_f32 v28, v28
    v_mfma_f32_16x16x32_bf16 v[48:51], v[180:183], a[212:215], v[48:51]
    v_exp_f32 v29, v29
    v_exp_f32 v30, v30
    v_mfma_f32_16x16x32_bf16 v[64:67], v[180:183], a[228:231], v[64:67]
    ds_read_b128 v[180:183], v213 offset:24576
    v_exp_f32 v31, v31
    v_mfma_f32_16x16x32_bf16 v[0:3], v[184:187], a[168:171], v[0:3]
    v_cvt_pk_bf16_f32 v24, v24, v25
    v_cvt_pk_bf16_f32 v25, v26, v27
    v_mfma_f32_16x16x32_bf16 v[16:19], v[184:187], a[184:187], v[16:19]
    v_cvt_pk_bf16_f32 v26, v28, v29
    v_cvt_pk_bf16_f32 v27, v30, v31
    v_mfma_f32_16x16x32_bf16 v[32:35], v[184:187], a[200:203], v[32:35]
    v_exp_f32 v40, v40
    v_exp_f32 v41, v41
    v_mfma_f32_16x16x32_bf16 v[48:51], v[184:187], a[216:219], v[48:51]
    v_exp_f32 v42, v42
    v_exp_f32 v43, v43
    v_mfma_f32_16x16x32_bf16 v[64:67], v[184:187], a[232:235], v[64:67]
    ds_read_b128 v[184:187], v214 offset:24576
    v_exp_f32 v44, v44
    v_mfma_f32_16x16x32_bf16 v[0:3], v[188:191], a[172:175], v[0:3]
    v_exp_f32 v45, v45
    v_exp_f32 v46, v46
    v_mfma_f32_16x16x32_bf16 v[16:19], v[188:191], a[188:191], v[16:19]
    v_exp_f32 v47, v47
    v_cvt_pk_bf16_f32 v40, v40, v41
    v_mfma_f32_16x16x32_bf16 v[32:35], v[188:191], a[204:207], v[32:35]
    v_cvt_pk_bf16_f32 v41, v42, v43
    v_cvt_pk_bf16_f32 v42, v44, v45
    v_mfma_f32_16x16x32_bf16 v[48:51], v[188:191], a[220:223], v[48:51]
    v_cvt_pk_bf16_f32 v43, v46, v47
    v_exp_f32 v56, v56
    v_mfma_f32_16x16x32_bf16 v[64:67], v[188:191], a[236:239], v[64:67]
    ds_read_b128 v[188:191], v215 offset:24576
    v_exp_f32 v57, v57
    v_mfma_f32_16x16x32_bf16 v[4:7], v[192:195], a[160:163], v[72:75]
    v_exp_f32 v58, v58
    v_exp_f32 v59, v59
    v_mfma_f32_16x16x32_bf16 v[20:23], v[192:195], a[176:179], v[76:79]
    v_exp_f32 v60, v60
    v_exp_f32 v61, v61
    v_mfma_f32_16x16x32_bf16 v[36:39], v[192:195], a[192:195], v[80:83]
    v_exp_f32 v62, v62
    v_exp_f32 v63, v63
    v_mfma_f32_16x16x32_bf16 v[52:55], v[192:195], a[208:211], v[84:87]
    v_cvt_pk_bf16_f32 v56, v56, v57
    v_cvt_pk_bf16_f32 v57, v58, v59
    v_mfma_f32_16x16x32_bf16 v[68:71], v[192:195], a[224:227], v[88:91]
    ds_read_b128 v[192:195], v212 offset:28672
    v_cvt_pk_bf16_f32 v58, v60, v61
    v_mfma_f32_16x16x32_bf16 v[4:7], v[196:199], a[164:167], v[4:7]
    v_cvt_pk_bf16_f32 v59, v62, v63
    v_mfma_f32_16x16x32_bf16 v[20:23], v[196:199], a[180:183], v[20:23]
    v_mfma_f32_16x16x32_bf16 v[36:39], v[196:199], a[196:199], v[36:39]
    v_mfma_f32_16x16x32_bf16 v[52:55], v[196:199], a[212:215], v[52:55]
    v_mfma_f32_16x16x32_bf16 v[68:71], v[196:199], a[228:231], v[68:71]
    ds_read_b128 v[196:199], v213 offset:28672
    v_mfma_f32_16x16x32_bf16 v[4:7], v[200:203], a[168:171], v[4:7]
    v_mfma_f32_16x16x32_bf16 v[20:23], v[200:203], a[184:187], v[20:23]
    v_mfma_f32_16x16x32_bf16 v[36:39], v[200:203], a[200:203], v[36:39]
    v_mfma_f32_16x16x32_bf16 v[52:55], v[200:203], a[216:219], v[52:55]
    v_mfma_f32_16x16x32_bf16 v[68:71], v[200:203], a[232:235], v[68:71]
    ds_read_b128 v[200:203], v214 offset:28672
    v_mfma_f32_16x16x32_bf16 v[4:7], v[204:207], a[172:175], v[4:7]
    v_mfma_f32_16x16x32_bf16 v[20:23], v[204:207], a[188:191], v[20:23]
    v_mfma_f32_16x16x32_bf16 v[36:39], v[204:207], a[204:207], v[36:39]
    v_mfma_f32_16x16x32_bf16 v[52:55], v[204:207], a[220:223], v[52:55]
    v_mfma_f32_16x16x32_bf16 v[68:71], v[204:207], a[236:239], v[68:71]
    ds_read_b128 v[204:207], v215 offset:28672
    v_mfma_f32_16x16x32_bf16 v[92:95], v[112:115], v[8:11], v[92:95]
    v_mfma_f32_16x16x32_bf16 v[96:99], v[112:115], v[24:27], v[96:99]
    v_mfma_f32_16x16x32_bf16 v[100:103], v[112:115], v[40:43], v[100:103]
    v_max3_f32 v120, v0, v1, v2
    v_max3_f32 v121, v16, v17, v18
    v_mfma_f32_16x16x32_bf16 v[104:107], v[112:115], v[56:59], v[104:107]
    v_max3_f32 v122, v32, v33, v34
    v_max3_f32 v123, v48, v49, v50
    v_mfma_f32_16x16x32_bf16 a[0:3], v[144:147], v[8:11], a[0:3]
    v_max3_f32 v124, v64, v65, v66
    v_max3_f32 v120, v120, v3, v4
    v_mfma_f32_16x16x32_bf16 a[32:35], v[144:147], v[24:27], a[32:35]
    v_max3_f32 v121, v121, v19, v20
    v_max3_f32 v122, v122, v35, v36
    v_mfma_f32_16x16x32_bf16 a[64:67], v[144:147], v[40:43], a[64:67]
    v_max3_f32 v123, v123, v51, v52
    v_max3_f32 v124, v124, v67, v68
    v_mfma_f32_16x16x32_bf16 a[96:99], v[144:147], v[56:59], a[96:99]
    v_max3_f32 v120, v120, v5, v6
    v_max3_f32 v121, v121, v21, v22
    s_waitcnt lgkmcnt(15)
    v_mfma_f32_16x16x32_bf16 a[4:7], v[148:151], v[8:11], a[4:7]
    v_max3_f32 v122, v122, v37, v38
    v_max3_f32 v123, v123, v53, v54
    v_mfma_f32_16x16x32_bf16 a[36:39], v[148:151], v[24:27], a[36:39]
    v_max3_f32 v124, v124, v69, v70
    v_max_f32 v120, v120, v7
    v_mfma_f32_16x16x32_bf16 a[68:71], v[148:151], v[40:43], a[68:71]
    v_max_f32 v121, v121, v23
    v_max_f32 v122, v122, v39
    v_mfma_f32_16x16x32_bf16 a[100:103], v[148:151], v[56:59], a[100:103]
    v_max_f32 v123, v123, v55
    v_max_f32 v124, v124, v71
    v_mfma_f32_16x16x32_bf16 a[8:11], v[152:155], v[8:11], a[8:11]
    v_mfma_f32_16x16x32_bf16 a[40:43], v[152:155], v[24:27], a[40:43]
    v_mfma_f32_16x16x32_bf16 a[72:75], v[152:155], v[40:43], a[72:75]
    v_mfma_f32_16x16x32_bf16 a[104:107], v[152:155], v[56:59], a[104:107]
    v_mfma_f32_16x16x32_bf16 a[12:15], v[156:159], v[8:11], a[12:15]
    v_mfma_f32_16x16x32_bf16 a[44:47], v[156:159], v[24:27], a[44:47]
    v_mfma_f32_16x16x32_bf16 a[76:79], v[156:159], v[40:43], a[76:79]
    v_mfma_f32_16x16x32_bf16 a[108:111], v[156:159], v[56:59], a[108:111]
    s_waitcnt lgkmcnt(14)
    v_mfma_f32_16x16x32_bf16 a[16:19], v[160:163], v[8:11], a[16:19]
    v_mfma_f32_16x16x32_bf16 a[48:51], v[160:163], v[24:27], a[48:51]
    v_mfma_f32_16x16x32_bf16 a[80:83], v[160:163], v[40:43], a[80:83]
    v_mfma_f32_16x16x32_bf16 a[112:115], v[160:163], v[56:59], a[112:115]
    s_waitcnt lgkmcnt(12)
    v_mfma_f32_16x16x32_bf16 a[20:23], v[164:167], v[8:11], a[20:23]
    v_mfma_f32_16x16x32_bf16 a[52:55], v[164:167], v[24:27], a[52:55]
    v_mfma_f32_16x16x32_bf16 a[84:87], v[164:167], v[40:43], a[84:87]
    v_mfma_f32_16x16x32_bf16 a[116:119], v[164:167], v[56:59], a[116:119]
    s_waitcnt lgkmcnt(10)
    v_mfma_f32_16x16x32_bf16 a[24:27], v[168:171], v[8:11], a[24:27]
    v_mfma_f32_16x16x32_bf16 a[56:59], v[168:171], v[24:27], a[56:59]
    v_mfma_f32_16x16x32_bf16 a[88:91], v[168:171], v[40:43], a[88:91]
    v_mfma_f32_16x16x32_bf16 a[120:123], v[168:171], v[56:59], a[120:123]
    s_waitcnt lgkmcnt(8)
    v_mfma_f32_16x16x32_bf16 a[28:31], v[172:175], v[8:11], a[28:31]
    v_mfma_f32_16x16x32_bf16 a[60:63], v[172:175], v[24:27], a[60:63]
    v_mfma_f32_16x16x32_bf16 a[92:95], v[172:175], v[40:43], a[92:95]
    v_mfma_f32_16x16x32_bf16 a[124:127], v[172:175], v[56:59], a[124:127]
    v_max3_f32 v125, v120, v121, v122
    v_max3_f32 v125, v125, v123, v124
    v_cmp_lt_f32 vcc, s59, v125
    s_nop 4
    s_cbranch_vccnz attn_kernel_n3
attn_kernel_n4:
    v_exp_f32 v0, v0
    v_exp_f32 v1, v1
    s_waitcnt lgkmcnt(7)
    v_mfma_f32_16x16x32_bf16 v[8:11], v[176:179], a[160:163], v[72:75]
    v_exp_f32 v2, v2
    v_exp_f32 v3, v3
    v_mfma_f32_16x16x32_bf16 v[24:27], v[176:179], a[176:179], v[76:79]
    v_exp_f32 v4, v4
    v_exp_f32 v5, v5
    v_mfma_f32_16x16x32_bf16 v[40:43], v[176:179], a[192:195], v[80:83]
    v_exp_f32 v6, v6
    v_exp_f32 v7, v7
    v_mfma_f32_16x16x32_bf16 v[56:59], v[176:179], a[208:211], v[84:87]
    v_cvt_pk_bf16_f32 v0, v0, v1
    v_cvt_pk_bf16_f32 v1, v2, v3
    s_waitcnt lgkmcnt(6)
    v_mfma_f32_16x16x32_bf16 v[8:11], v[180:183], a[164:167], v[8:11]
    v_cvt_pk_bf16_f32 v2, v4, v5
    v_cvt_pk_bf16_f32 v3, v6, v7
    v_mfma_f32_16x16x32_bf16 v[24:27], v[180:183], a[180:183], v[24:27]
    v_exp_f32 v16, v16
    v_exp_f32 v17, v17
    v_mfma_f32_16x16x32_bf16 v[40:43], v[180:183], a[196:199], v[40:43]
    v_exp_f32 v18, v18
    v_exp_f32 v19, v19
    v_mfma_f32_16x16x32_bf16 v[56:59], v[180:183], a[212:215], v[56:59]
    v_exp_f32 v20, v20
    v_exp_f32 v21, v21
    s_waitcnt lgkmcnt(5)
    v_mfma_f32_16x16x32_bf16 v[8:11], v[184:187], a[168:171], v[8:11]
    v_exp_f32 v22, v22
    v_exp_f32 v23, v23
    v_mfma_f32_16x16x32_bf16 v[24:27], v[184:187], a[184:187], v[24:27]
    v_cvt_pk_bf16_f32 v16, v16, v17
    v_cvt_pk_bf16_f32 v17, v18, v19
    v_mfma_f32_16x16x32_bf16 v[40:43], v[184:187], a[200:203], v[40:43]
    v_cvt_pk_bf16_f32 v18, v20, v21
    v_cvt_pk_bf16_f32 v19, v22, v23
    v_mfma_f32_16x16x32_bf16 v[56:59], v[184:187], a[216:219], v[56:59]
    v_exp_f32 v32, v32
    v_exp_f32 v33, v33
    s_waitcnt lgkmcnt(4)
    v_mfma_f32_16x16x32_bf16 v[8:11], v[188:191], a[172:175], v[8:11]
    v_exp_f32 v34, v34
    v_exp_f32 v35, v35
    v_mfma_f32_16x16x32_bf16 v[24:27], v[188:191], a[188:191], v[24:27]
    v_exp_f32 v36, v36
    v_exp_f32 v37, v37
    v_mfma_f32_16x16x32_bf16 v[40:43], v[188:191], a[204:207], v[40:43]
    v_exp_f32 v38, v38
    v_exp_f32 v39, v39
    v_mfma_f32_16x16x32_bf16 v[56:59], v[188:191], a[220:223], v[56:59]
    v_cvt_pk_bf16_f32 v32, v32, v33
    v_cvt_pk_bf16_f32 v33, v34, v35
    s_waitcnt lgkmcnt(3)
    v_mfma_f32_16x16x32_bf16 v[12:15], v[192:195], a[160:163], v[72:75]
    v_cvt_pk_bf16_f32 v34, v36, v37
    v_cvt_pk_bf16_f32 v35, v38, v39
    v_mfma_f32_16x16x32_bf16 v[28:31], v[192:195], a[176:179], v[76:79]
    v_exp_f32 v48, v48
    v_exp_f32 v49, v49
    v_mfma_f32_16x16x32_bf16 v[44:47], v[192:195], a[192:195], v[80:83]
    v_exp_f32 v50, v50
    v_exp_f32 v51, v51
    v_mfma_f32_16x16x32_bf16 v[60:63], v[192:195], a[208:211], v[84:87]
    v_exp_f32 v52, v52
    v_exp_f32 v53, v53
    s_waitcnt lgkmcnt(2)
    v_mfma_f32_16x16x32_bf16 v[12:15], v[196:199], a[164:167], v[12:15]
    v_exp_f32 v54, v54
    v_exp_f32 v55, v55
    v_mfma_f32_16x16x32_bf16 v[28:31], v[196:199], a[180:183], v[28:31]
    v_cvt_pk_bf16_f32 v48, v48, v49
    v_cvt_pk_bf16_f32 v49, v50, v51
    v_mfma_f32_16x16x32_bf16 v[44:47], v[196:199], a[196:199], v[44:47]
    v_cvt_pk_bf16_f32 v50, v52, v53
    v_cvt_pk_bf16_f32 v51, v54, v55
    v_mfma_f32_16x16x32_bf16 v[60:63], v[196:199], a[212:215], v[60:63]
    v_exp_f32 v64, v64
    v_exp_f32 v65, v65
    s_waitcnt lgkmcnt(1)
    v_mfma_f32_16x16x32_bf16 v[12:15], v[200:203], a[168:171], v[12:15]
    v_exp_f32 v66, v66
    v_exp_f32 v67, v67
    v_mfma_f32_16x16x32_bf16 v[28:31], v[200:203], a[184:187], v[28:31]
    v_exp_f32 v68, v68
    v_exp_f32 v69, v69
    v_mfma_f32_16x16x32_bf16 v[44:47], v[200:203], a[200:203], v[44:47]
    v_exp_f32 v70, v70
    v_exp_f32 v71, v71
    v_mfma_f32_16x16x32_bf16 v[60:63], v[200:203], a[216:219], v[60:63]
    v_cvt_pk_bf16_f32 v64, v64, v65
    v_cvt_pk_bf16_f32 v65, v66, v67
    s_waitcnt lgkmcnt(0)
    v_mfma_f32_16x16x32_bf16 v[12:15], v[204:207], a[172:175], v[12:15]
    v_cvt_pk_bf16_f32 v66, v68, v69
    v_cvt_pk_bf16_f32 v67, v70, v71
    v_mfma_f32_16x16x32_bf16 v[28:31], v[204:207], a[188:191], v[28:31]
    v_mfma_f32_16x16x32_bf16 v[44:47], v[204:207], a[204:207], v[44:47]
    v_mfma_f32_16x16x32_bf16 v[60:63], v[204:207], a[220:223], v[60:63]
    s_waitcnt vmcnt(0) lgkmcnt(0)
    s_waitcnt vmcnt(0) lgkmcnt(0)
    s_barrier
    s_mov_b32 s56, 0
    s_waitcnt lgkmcnt(0)
    s_nop 9
attn_kernel_n5:
    ds_read_b64_tr_b16 v[144:145], v216 offset:32768
    ds_read_b64_tr_b16 v[146:147], v216 offset:36864
    v_max3_f32 v120, v8, v9, v10
    s_add_u32 m0, s49, 16384
    s_nop 0
    buffer_load_dwordx4 v118, s[28:31], s58 offen nt lds
    s_add_u32 s58, s58, 2048
    v_mfma_f32_16x16x32_bf16 v[92:95], v[112:115], v[0:3], v[92:95]
    ds_read_b64_tr_b16 v[148:149], v217 offset:32768
    ds_read_b64_tr_b16 v[150:151], v217 offset:36864
    v_max3_f32 v121, v24, v25, v26
    v_mfma_f32_16x16x32_bf16 v[96:99], v[112:115], v[16:19], v[96:99]
    ds_read_b64_tr_b16 v[152:153], v218 offset:32768
    ds_read_b64_tr_b16 v[154:155], v218 offset:36864
    v_max3_f32 v122, v40, v41, v42
    v_mfma_f32_16x16x32_bf16 v[100:103], v[112:115], v[32:35], v[100:103]
    ds_read_b64_tr_b16 v[156:157], v219 offset:32768
    ds_read_b64_tr_b16 v[158:159], v219 offset:36864
    v_max3_f32 v123, v56, v57, v58
    v_mfma_f32_16x16x32_bf16 v[104:107], v[112:115], v[48:51], v[104:107]
    ds_read_b64_tr_b16 v[160:161], v220 offset:32768
    ds_read_b64_tr_b16 v[162:163], v220 offset:36864
    v_max3_f32 v120, v120, v11, v12
    v_mfma_f32_16x16x32_bf16 v[108:111], v[112:115], v[64:67], v[108:111]
    ds_read_b64_tr_b16 v[164:165], v221 offset:32768
    ds_read_b64_tr_b16 v[166:167], v221 offset:36864
    v_max3_f32 v121, v121, v27, v28
    s_waitcnt lgkmcnt(10)
    v_mfma_f32_16x16x32_bf16 a[0:3], v[144:147], v[0:3], a[0:3]
    ds_read_b64_tr_b16 v[168:169], v222 offset:32768
    ds_read_b64_tr_b16 v[170:171], v222 offset:36864
    v_max3_f32 v122, v122, v43, v44
    v_mfma_f32_16x16x32_bf16 a[32:35], v[144:147], v[16:19], a[32:35]
    ds_read_b64_tr_b16 v[172:173], v223 offset:32768
    ds_read_b64_tr_b16 v[174:175], v223 offset:36864
    v_max3_f32 v123, v123, v59, v60
    v_mfma_f32_16x16x32_bf16 a[64:67], v[144:147], v[32:35], a[64:67]
    ds_read_b128 v[176:179], v208 offset:49152
    v_max3_f32 v120, v120, v13, v14
    v_mfma_f32_16x16x32_bf16 a[96:99], v[144:147], v[48:51], a[96:99]
    ds_read_b128 v[180:183], v209 offset:49152
    v_max3_f32 v121, v121, v29, v30
    v_mfma_f32_16x16x32_bf16 a[128:131], v[144:147], v[64:67], a[128:131]
    ds_read_b128 v[184:187], v210 offset:49152
    v_max3_f32 v122, v122, v45, v46
    s_waitcnt lgkmcnt(15)
    v_mfma_f32_16x16x32_bf16 a[4:7], v[148:151], v[0:3], a[4:7]
    ds_read_b128 v[188:191], v211 offset:49152
    v_max3_f32 v123, v123, v61, v62
    v_mfma_f32_16x16x32_bf16 a[36:39], v[148:151], v[16:19], a[36:39]
    ds_read_b128 v[192:195], v208 offset:53248
    v_max_f32 v120, v120, v15
    v_mfma_f32_16x16x32_bf16 a[68:71], v[148:151], v[32:35], a[68:71]
    ds_read_b128 v[196:199], v209 offset:53248
    v_max_f32 v121, v121, v31
    v_mfma_f32_16x16x32_bf16 a[100:103], v[148:151], v[48:51], a[100:103]
    ds_read_b128 v[200:203], v210 offset:53248
    v_max_f32 v122, v122, v47
    v_mfma_f32_16x16x32_bf16 a[132:135], v[148:151], v[64:67], a[132:135]
    ds_read_b128 v[204:207], v211 offset:53248
    v_max_f32 v123, v123, v63
    s_waitcnt lgkmcnt(15)
    v_mfma_f32_16x16x32_bf16 a[8:11], v[152:155], v[0:3], a[8:11]
    ds_read_b64_tr_b16 v[144:145], v224 offset:40960
    ds_read_b64_tr_b16 v[146:147], v224 offset:45056
    s_add_u32 m0, s49, 18432
    s_nop 0
    buffer_load_dwordx4 v118, s[28:31], s58 offen nt lds
    s_add_u32 s58, s58, 2048
    v_mfma_f32_16x16x32_bf16 a[40:43], v[152:155], v[16:19], a[40:43]
    ds_read_b64_tr_b16 v[148:149], v225 offset:40960
    ds_read_b64_tr_b16 v[150:151], v225 offset:45056
    s_add_u32 m0, s49, 20480
    s_nop 0
    buffer_load_dwordx4 v118, s[28:31], s58 offen nt lds
    s_add_u32 s58, s58, 2048
    v_mfma_f32_16x16x32_bf16 a[72:75], v[152:155], v[32:35], a[72:75]
    s_add_u32 m0, s49, 22528
    s_nop 0
    buffer_load_dwordx4 v118, s[28:31], s58 offen nt lds
    s_add_u32 s58, s58, 2048
    v_mfma_f32_16x16x32_bf16 a[104:107], v[152:155], v[48:51], a[104:107]
    v_mfma_f32_16x16x32_bf16 a[136:139], v[152:155], v[64:67], a[136:139]
    ds_read_b64_tr_b16 v[152:153], v226 offset:40960
    ds_read_b64_tr_b16 v[154:155], v226 offset:45056
    v_mfma_f32_16x16x32_bf16 a[12:15], v[156:159], v[0:3], a[12:15]
    v_mfma_f32_16x16x32_bf16 a[44:47], v[156:159], v[16:19], a[44:47]
    v_mfma_f32_16x16x32_bf16 a[76:79], v[156:159], v[32:35], a[76:79]
    v_mfma_f32_16x16x32_bf16 a[108:111], v[156:159], v[48:51], a[108:111]
    s_add_u32 m0, s49, 24576
    s_nop 0
    buffer_load_dwordx4 v118, s[28:31], s58 offen nt lds
    s_add_u32 s58, s58, 2048
    v_mfma_f32_16x16x32_bf16 a[140:143], v[156:159], v[64:67], a[140:143]
    ds_read_b64_tr_b16 v[156:157], v227 offset:40960
    ds_read_b64_tr_b16 v[158:159], v227 offset:45056
    s_waitcnt lgkmcnt(15)
    v_mfma_f32_16x16x32_bf16 a[16:19], v[160:163], v[0:3], a[16:19]
    v_mfma_f32_16x16x32_bf16 a[48:51], v[160:163], v[16:19], a[48:51]
    v_mfma_f32_16x16x32_bf16 a[80:83], v[160:163], v[32:35], a[80:83]
    v_mfma_f32_16x16x32_bf16 a[112:115], v[160:163], v[48:51], a[112:115]
    v_mfma_f32_16x16x32_bf16 a[144:147], v[160:163], v[64:67], a[144:147]
    ds_read_b64_tr_b16 v[160:161], v228 offset:40960
    ds_read_b64_tr_b16 v[162:163], v228 offset:45056
    s_add_u32 m0, s49, 26624
    s_nop 0
    buffer_load_dwordx4 v118, s[28:31], s58 offen nt lds
    s_add_u32 s58, s58, 2048
    v_mfma_f32_16x16x32_bf16 a[20:23], v[164:167], v[0:3], a[20:23]
    v_mfma_f32_16x16x32_bf16 a[52:55], v[164:167], v[16:19], a[52:55]
    v_mfma_f32_16x16x32_bf16 a[84:87], v[164:167], v[32:35], a[84:87]
    v_mfma_f32_16x16x32_bf16 a[116:119], v[164:167], v[48:51], a[116:119]
    v_mfma_f32_16x16x32_bf16 a[148:151], v[164:167], v[64:67], a[148:151]
    ds_read_b64_tr_b16 v[164:165], v229 offset:40960
    ds_read_b64_tr_b16 v[166:167], v229 offset:45056
    v_mfma_f32_16x16x32_bf16 a[24:27], v[168:171], v[0:3], a[24:27]
    s_add_u32 m0, s49, 28672
    s_nop 0
    buffer_load_dwordx4 v118, s[28:31], s58 offen nt lds
    s_add_u32 s58, s58, 2048
    v_mfma_f32_16x16x32_bf16 a[56:59], v[168:171], v[16:19], a[56:59]
    v_mfma_f32_16x16x32_bf16 a[88:91], v[168:171], v[32:35], a[88:91]
    v_mfma_f32_16x16x32_bf16 a[120:123], v[168:171], v[48:51], a[120:123]
    v_mfma_f32_16x16x32_bf16 a[152:155], v[168:171], v[64:67], a[152:155]
    ds_read_b64_tr_b16 v[168:169], v230 offset:40960
    ds_read_b64_tr_b16 v[170:171], v230 offset:45056
    v_mfma_f32_16x16x32_bf16 a[28:31], v[172:175], v[0:3], a[28:31]
    v_mfma_f32_16x16x32_bf16 a[60:63], v[172:175], v[16:19], a[60:63]
    s_add_u32 m0, s49, 30720
    s_nop 0
    buffer_load_dwordx4 v118, s[28:31], s58 offen nt lds
    s_add_u32 s58, s58, 2048
    v_mfma_f32_16x16x32_bf16 a[92:95], v[172:175], v[32:35], a[92:95]
    v_mfma_f32_16x16x32_bf16 a[124:127], v[172:175], v[48:51], a[124:127]
    v_mfma_f32_16x16x32_bf16 a[156:159], v[172:175], v[64:67], a[156:159]
    ds_read_b64_tr_b16 v[172:173], v231 offset:40960
    ds_read_b64_tr_b16 v[174:175], v231 offset:45056
    v_max3_f32 v125, v120, v121, v122
    v_max_f32 v125, v125, v123
    v_cmp_lt_f32 vcc, s59, v125
    s_nop 4
    s_cbranch_vccnz attn_kernel_n6
attn_kernel_n7:
    v_exp_f32 v8, v8
    v_exp_f32 v9, v9
    v_mfma_f32_16x16x32_bf16 v[0:3], v[176:179], a[160:163], v[72:75]
    v_exp_f32 v10, v10
    s_add_u32 m0, s49, 32768
    s_nop 0
    buffer_load_dwordx4 v116, s[24:27], s57 offen nt lds
    v_mfma_f32_16x16x32_bf16 v[16:19], v[176:179], a[176:179], v[76:79]
    v_exp_f32 v11, v11
    v_exp_f32 v12, v12
    v_mfma_f32_16x16x32_bf16 v[32:35], v[176:179], a[192:195], v[80:83]
    v_exp_f32 v13, v13
    v_exp_f32 v14, v14
    v_mfma_f32_16x16x32_bf16 v[48:51], v[176:179], a[208:211], v[84:87]
    v_exp_f32 v15, v15
    v_cvt_pk_bf16_f32 v8, v8, v9
    v_mfma_f32_16x16x32_bf16 v[64:67], v[176:179], a[224:227], v[88:91]
    ds_read_b128 v[176:179], v212 offset:57344
    v_cvt_pk_bf16_f32 v9, v10, v11
    s_waitcnt lgkmcnt(15)
    v_mfma_f32_16x16x32_bf16 v[0:3], v[180:183], a[164:167], v[0:3]
    v_cvt_pk_bf16_f32 v10, v12, v13
    v_cvt_pk_bf16_f32 v11, v14, v15
    v_mfma_f32_16x16x32_bf16 v[16:19], v[180:183], a[180:183], v[16:19]
    v_exp_f32 v24, v24
    s_add_u32 m0, s49, 34816
    s_nop 0
    buffer_load_dwordx4 v117, s[24:27], s57 offen nt lds
    s_add_u32 s57, s57, 4096
    v_mfma_f32_16x16x32_bf16 v[32:35], v[180:183], a[196:199], v[32:35]
    v_exp_f32 v25, v25
    v_exp_f32 v26, v26
    v_mfma_f32_16x16x32_bf16 v[48:51], v[180:183], a[212:215], v[48:51]
    v_exp_f32 v27, v27
    v_exp_f32 v28, v28
    v_mfma_f32_16x16x32_bf16 v[64:67], v[180:183], a[228:231], v[64:67]
    ds_read_b128 v[180:183], v213 offset:57344
    v_exp_f32 v29, v29
    v_mfma_f32_16x16x32_bf16 v[0:3], v[184:187], a[168:171], v[0:3]
    v_exp_f32 v30, v30
    v_exp_f32 v31, v31
    v_mfma_f32_16x16x32_bf16 v[16:19], v[184:187], a[184:187], v[16:19]
    v_cvt_pk_bf16_f32 v24, v24, v25
    v_cvt_pk_bf16_f32 v25, v26, v27
    v_mfma_f32_16x16x32_bf16 v[32:35], v[184:187], a[200:203], v[32:35]
    v_cvt_pk_bf16_f32 v26, v28, v29
    s_add_u32 m0, s49, 36864
    s_nop 0
    buffer_load_dwordx4 v116, s[24:27], s57 offen nt lds
    v_mfma_f32_16x16x32_bf16 v[48:51], v[184:187], a[216:219], v[48:51]
    v_cvt_pk_bf16_f32 v27, v30, v31
    v_exp_f32 v40, v40
    v_mfma_f32_16x16x32_bf16 v[64:67], v[184:187], a[232:235], v[64:67]
    ds_read_b128 v[184:187], v214 offset:57344
    v_exp_f32 v41, v41
    v_mfma_f32_16x16x32_bf16 v[0:3], v[188:191], a[172:175], v[0:3]
    v_exp_f32 v42, v42
    v_exp_f32 v43, v43
    v_mfma_f32_16x16x32_bf16 v[16:19], v[188:191], a[188:191], v[16:19]
    v_exp_f32 v44, v44
    v_exp_f32 v45, v45
    v_mfma_f32_16x16x32_bf16 v[32:35], v[188:191], a[204:207], v[32:35]
    v_exp_f32 v46, v46
    v_exp_f32 v47, v47
    v_mfma_f32_16x16x32_bf16 v[48:51], v[188:191], a[220:223], v[48:51]
    v_cvt_pk_bf16_f32 v40, v40, v41
    s_add_u32 m0, s49, 38912
    s_nop 0
    buffer_load_dwordx4 v117, s[24:27], s57 offen nt lds
    s_add_u32 s57, s57, 4096
    v_mfma_f32_16x16x32_bf16 v[64:67], v[188:191], a[236:239], v[64:67]
    ds_read_b128 v[188:191], v215 offset:57344
    v_cvt_pk_bf16_f32 v41, v42, v43
    v_mfma_f32_16x16x32_bf16 v[4:7], v[192:195], a[160:163], v[72:75]
    v_cvt_pk_bf16_f32 v42, v44, v45
    v_cvt_pk_bf16_f32 v43, v46, v47
    v_mfma_f32_16x16x32_bf16 v[20:23], v[192:195], a[176:179], v[76:79]
    v_exp_f32 v56, v56
    v_exp_f32 v57, v57
    v_mfma_f32_16x16x32_bf16 v[36:39], v[192:195], a[192:195], v[80:83]
    v_exp_f32 v58, v58
    v_exp_f32 v59, v59
    v_mfma_f32_16x16x32_bf16 v[52:55], v[192:195], a[208:211], v[84:87]
    v_exp_f32 v60, v60
    v_exp_f32 v61, v61
    v_mfma_f32_16x16x32_bf16 v[68:71], v[192:195], a[224:227], v[88:91]
    ds_read_b128 v[192:195], v212 offset:61440
    v_exp_f32 v62, v62
    v_mfma_f32_16x16x32_bf16 v[4:7], v[196:199], a[164:167], v[4:7]
    v_exp_f32 v63, v63
    s_add_u32 m0, s49, 40960
    s_nop 0
    buffer_load_dwordx4 v116, s[24:27], s57 offen nt lds
    v_mfma_f32_16x16x32_bf16 v[20:23], v[196:199], a[180:183], v[20:23]
    v_cvt_pk_bf16_f32 v56, v56, v57
    v_cvt_pk_bf16_f32 v57, v58, v59
    v_mfma_f32_16x16x32_bf16 v[36:39], v[196:199], a[196:199], v[36:39]
    v_cvt_pk_bf16_f32 v58, v60, v61
    v_cvt_pk_bf16_f32 v59, v62, v63
    v_mfma_f32_16x16x32_bf16 v[52:55], v[196:199], a[212:215], v[52:55]
    v_mfma_f32_16x16x32_bf16 v[68:71], v[196:199], a[228:231], v[68:71]
    ds_read_b128 v[196:199], v213 offset:61440
    v_mfma_f32_16x16x32_bf16 v[4:7], v[200:203], a[168:171], v[4:7]
    s_add_u32 m0, s49, 43008
    s_nop 0
    buffer_load_dwordx4 v117, s[24:27], s57 offen nt lds
    s_add_u32 s57, s57, 4096
    v_mfma_f32_16x16x32_bf16 v[20:23], v[200:203], a[184:187], v[20:23]
    v_mfma_f32_16x16x32_bf16 v[36:39], v[200:203], a[200:203], v[36:39]
    v_mfma_f32_16x16x32_bf16 v[52:55], v[200:203], a[216:219], v[52:55]
    v_mfma_f32_16x16x32_bf16 v[68:71], v[200:203], a[232:235], v[68:71]
    ds_read_b128 v[200:203], v214 offset:61440
    v_mfma_f32_16x16x32_bf16 v[4:7], v[204:207], a[172:175], v[4:7]
    v_mfma_f32_16x16x32_bf16 v[20:23], v[204:207], a[188:191], v[20:23]
    s_add_u32 m0, s49, 45056
    s_nop 0
    buffer_load_dwordx4 v116, s[24:27], s57 offen nt lds
    v_mfma_f32_16x16x32_bf16 v[36:39], v[204:207], a[204:207], v[36:39]
    v_mfma_f32_16x16x32_bf16 v[52:55], v[204:207], a[220:223], v[52:55]
    v_mfma_f32_16x16x32_bf16 v[68:71], v[204:207], a[236:239], v[68:71]
    ds_read_b128 v[204:207], v215 offset:61440
    v_mfma_f32_16x16x32_bf16 v[92:95], v[112:115], v[8:11], v[92:95]
    v_mfma_f32_16x16x32_bf16 v[96:99], v[112:115], v[24:27], v[96:99]
    s_add_u32 m0, s49, 47104
    s_nop 0
    buffer_load_dwordx4 v117, s[24:27], s57 offen nt lds
    s_add_u32 s57, s57, 4096
    v_mfma_f32_16x16x32_bf16 v[100:103], v[112:115], v[40:43], v[100:103]
    v_max3_f32 v120, v0, v1, v2
    v_max3_f32 v121, v16, v17, v18
    v_mfma_f32_16x16x32_bf16 v[104:107], v[112:115], v[56:59], v[104:107]
    v_max3_f32 v122, v32, v33, v34
    v_max3_f32 v123, v48, v49, v50
    v_mfma_f32_16x16x32_bf16 a[0:3], v[144:147], v[8:11], a[0:3]
    v_max3_f32 v124, v64, v65, v66
    v_max3_f32 v120, v120, v3, v4
    v_mfma_f32_16x16x32_bf16 a[32:35], v[144:147], v[24:27], a[32:35]
    v_max3_f32 v121, v121, v19, v20
    v_max3_f32 v122, v122, v35, v36
    v_mfma_f32_16x16x32_bf16 a[64:67], v[144:147], v[40:43], a[64:67]
    v_max3_f32 v123, v123, v51, v52
    v_max3_f32 v124, v124, v67, v68
    v_mfma_f32_16x16x32_bf16 a[96:99], v[144:147], v[56:59], a[96:99]
    v_max3_f32 v120, v120, v5, v6
    v_max3_f32 v121, v121, v21, v22
    s_waitcnt lgkmcnt(15)
    v_mfma_f32_16x16x32_bf16 a[4:7], v[148:151], v[8:11], a[4:7]
    v_max3_f32 v122, v122, v37, v38
    v_max3_f32 v123, v123, v53, v54
    v_mfma_f32_16x16x32_bf16 a[36:39], v[148:151], v[24:27], a[36:39]
    v_max3_f32 v124, v124, v69, v70
    v_max_f32 v120, v120, v7
    v_mfma_f32_16x16x32_bf16 a[68:71], v[148:151], v[40:43], a[68:71]
    v_max_f32 v121, v121, v23
    v_max_f32 v122, v122, v39
    v_mfma_f32_16x16x32_bf16 a[100:103], v[148:151], v[56:59], a[100:103]
    v_max_f32 v123, v123, v55
    v_max_f32 v124, v124, v71
    v_mfma_f32_16x16x32_bf16 a[8:11], v[152:155], v[8:11], a[8:11]
    v_mfma_f32_16x16x32_bf16 a[40:43], v[152:155], v[24:27], a[40:43]
    v_mfma_f32_16x16x32_bf16 a[72:75], v[152:155], v[40:43], a[72:75]
    v_mfma_f32_16x16x32_bf16 a[104:107], v[152:155], v[56:59], a[104:107]
    v_mfma_f32_16x16x32_bf16 a[12:15], v[156:159], v[8:11], a[12:15]
    v_mfma_f32_16x16x32_bf16 a[44:47], v[156:159], v[24:27], a[44:47]
    v_mfma_f32_16x16x32_bf16 a[76:79], v[156:159], v[40:43], a[76:79]
    v_mfma_f32_16x16x32_bf16 a[108:111], v[156:159], v[56:59], a[108:111]
    s_waitcnt lgkmcnt(14)
    v_mfma_f32_16x16x32_bf16 a[16:19], v[160:163], v[8:11], a[16:19]
    v_mfma_f32_16x16x32_bf16 a[48:51], v[160:163], v[24:27], a[48:51]
    v_mfma_f32_16x16x32_bf16 a[80:83], v[160:163], v[40:43], a[80:83]
    v_mfma_f32_16x16x32_bf16 a[112:115], v[160:163], v[56:59], a[112:115]
    s_waitcnt lgkmcnt(12)
    v_mfma_f32_16x16x32_bf16 a[20:23], v[164:167], v[8:11], a[20:23]
    v_mfma_f32_16x16x32_bf16 a[52:55], v[164:167], v[24:27], a[52:55]
    v_mfma_f32_16x16x32_bf16 a[84:87], v[164:167], v[40:43], a[84:87]
    v_mfma_f32_16x16x32_bf16 a[116:119], v[164:167], v[56:59], a[116:119]
    s_waitcnt lgkmcnt(10)
    v_mfma_f32_16x16x32_bf16 a[24:27], v[168:171], v[8:11], a[24:27]
    v_mfma_f32_16x16x32_bf16 a[56:59], v[168:171], v[24:27], a[56:59]
    v_mfma_f32_16x16x32_bf16 a[88:91], v[168:171], v[40:43], a[88:91]
    v_mfma_f32_16x16x32_bf16 a[120:123], v[168:171], v[56:59], a[120:123]
    s_waitcnt lgkmcnt(8)
    v_mfma_f32_16x16x32_bf16 a[28:31], v[172:175], v[8:11], a[28:31]
    v_mfma_f32_16x16x32_bf16 a[60:63], v[172:175], v[24:27], a[60:63]
    v_mfma_f32_16x16x32_bf16 a[92:95], v[172:175], v[40:43], a[92:95]
    v_mfma_f32_16x16x32_bf16 a[124:127], v[172:175], v[56:59], a[124:127]
    v_max3_f32 v125, v120, v121, v122
    v_max3_f32 v125, v125, v123, v124
    v_cmp_lt_f32 vcc, s59, v125
    s_nop 4
    s_cbranch_vccnz attn_kernel_n8
attn_kernel_n9:
    v_exp_f32 v0, v0
    v_exp_f32 v1, v1
    s_waitcnt lgkmcnt(7)
    v_mfma_f32_16x16x32_bf16 v[8:11], v[176:179], a[160:163], v[72:75]
    v_exp_f32 v2, v2
    v_exp_f32 v3, v3
    v_mfma_f32_16x16x32_bf16 v[24:27], v[176:179], a[176:179], v[76:79]
    v_exp_f32 v4, v4
    v_exp_f32 v5, v5
    v_mfma_f32_16x16x32_bf16 v[40:43], v[176:179], a[192:195], v[80:83]
    v_exp_f32 v6, v6
    v_exp_f32 v7, v7
    v_mfma_f32_16x16x32_bf16 v[56:59], v[176:179], a[208:211], v[84:87]
    v_cvt_pk_bf16_f32 v0, v0, v1
    v_cvt_pk_bf16_f32 v1, v2, v3
    s_waitcnt lgkmcnt(6)
    v_mfma_f32_16x16x32_bf16 v[8:11], v[180:183], a[164:167], v[8:11]
    v_cvt_pk_bf16_f32 v2, v4, v5
    v_cvt_pk_bf16_f32 v3, v6, v7
    v_mfma_f32_16x16x32_bf16 v[24:27], v[180:183], a[180:183], v[24:27]
    v_exp_f32 v16, v16
    v_exp_f32 v17, v17
    v_mfma_f32_16x16x32_bf16 v[40:43], v[180:183], a[196:199], v[40:43]
    v_exp_f32 v18, v18
    v_exp_f32 v19, v19
    v_mfma_f32_16x16x32_bf16 v[56:59], v[180:183], a[212:215], v[56:59]
    v_exp_f32 v20, v20
    v_exp_f32 v21, v21
    s_waitcnt lgkmcnt(5)
    v_mfma_f32_16x16x32_bf16 v[8:11], v[184:187], a[168:171], v[8:11]
    v_exp_f32 v22, v22
    v_exp_f32 v23, v23
    v_mfma_f32_16x16x32_bf16 v[24:27], v[184:187], a[184:187], v[24:27]
    v_cvt_pk_bf16_f32 v16, v16, v17
    v_cvt_pk_bf16_f32 v17, v18, v19
    v_mfma_f32_16x16x32_bf16 v[40:43], v[184:187], a[200:203], v[40:43]
    v_cvt_pk_bf16_f32 v18, v20, v21
    v_cvt_pk_bf16_f32 v19, v22, v23
    v_mfma_f32_16x16x32_bf16 v[56:59], v[184:187], a[216:219], v[56:59]
    v_exp_f32 v32, v32
    v_exp_f32 v33, v33
    s_waitcnt lgkmcnt(4)
    v_mfma_f32_16x16x32_bf16 v[8:11], v[188:191], a[172:175], v[8:11]
    v_exp_f32 v34, v34
    v_exp_f32 v35, v35
    v_mfma_f32_16x16x32_bf16 v[24:27], v[188:191], a[188:191], v[24:27]
    v_exp_f32 v36, v36
    v_exp_f32 v37, v37
    v_mfma_f32_16x16x32_bf16 v[40:43], v[188:191], a[204:207], v[40:43]
    v_exp_f32 v38, v38
    v_exp_f32 v39, v39
    v_mfma_f32_16x16x32_bf16 v[56:59], v[188:191], a[220:223], v[56:59]
    v_cvt_pk_bf16_f32 v32, v32, v33
    v_cvt_pk_bf16_f32 v33, v34, v35
    s_waitcnt lgkmcnt(3)
    v_mfma_f32_16x16x32_bf16 v[12:15], v[192:195], a[160:163], v[72:75]
    v_cvt_pk_bf16_f32 v34, v36, v37
    v_cvt_pk_bf16_f32 v35, v38, v39
    v_mfma_f32_16x16x32_bf16 v[28:31], v[192:195], a[176:179], v[76:79]
    v_exp_f32 v48, v48
    v_exp_f32 v49, v49
    v_mfma_f32_16x16x32_bf16 v[44:47], v[192:195], a[192:195], v[80:83]
    v_exp_f32 v50, v50
    v_exp_f32 v51, v51
    v_mfma_f32_16x16x32_bf16 v[60:63], v[192:195], a[208:211], v[84:87]
    v_exp_f32 v52, v52
    v_exp_f32 v53, v53
    s_waitcnt lgkmcnt(2)
    v_mfma_f32_16x16x32_bf16 v[12:15], v[196:199], a[164:167], v[12:15]
    v_exp_f32 v54, v54
    v_exp_f32 v55, v55
    v_mfma_f32_16x16x32_bf16 v[28:31], v[196:199], a[180:183], v[28:31]
    v_cvt_pk_bf16_f32 v48, v48, v49
    v_cvt_pk_bf16_f32 v49, v50, v51
    v_mfma_f32_16x16x32_bf16 v[44:47], v[196:199], a[196:199], v[44:47]
    v_cvt_pk_bf16_f32 v50, v52, v53
    v_cvt_pk_bf16_f32 v51, v54, v55
    v_mfma_f32_16x16x32_bf16 v[60:63], v[196:199], a[212:215], v[60:63]
    v_exp_f32 v64, v64
    v_exp_f32 v65, v65
    s_waitcnt lgkmcnt(1)
    v_mfma_f32_16x16x32_bf16 v[12:15], v[200:203], a[168:171], v[12:15]
    v_exp_f32 v66, v66
    v_exp_f32 v67, v67
    v_mfma_f32_16x16x32_bf16 v[28:31], v[200:203], a[184:187], v[28:31]
    v_exp_f32 v68, v68
    v_exp_f32 v69, v69
    v_mfma_f32_16x16x32_bf16 v[44:47], v[200:203], a[200:203], v[44:47]
    v_exp_f32 v70, v70
    v_exp_f32 v71, v71
    v_mfma_f32_16x16x32_bf16 v[60:63], v[200:203], a[216:219], v[60:63]
    v_cvt_pk_bf16_f32 v64, v64, v65
    v_cvt_pk_bf16_f32 v65, v66, v67
    s_waitcnt lgkmcnt(0)
    v_mfma_f32_16x16x32_bf16 v[12:15], v[204:207], a[172:175], v[12:15]
    v_cvt_pk_bf16_f32 v66, v68, v69
    v_cvt_pk_bf16_f32 v67, v70, v71
    v_mfma_f32_16x16x32_bf16 v[28:31], v[204:207], a[188:191], v[28:31]
    v_mfma_f32_16x16x32_bf16 v[44:47], v[204:207], a[204:207], v[44:47]
    v_mfma_f32_16x16x32_bf16 v[60:63], v[204:207], a[220:223], v[60:63]
    s_waitcnt vmcnt(0) lgkmcnt(0)
    s_waitcnt vmcnt(0) lgkmcnt(0)
    s_barrier
    ds_read_b64_tr_b16 v[144:145], v216
    ds_read_b64_tr_b16 v[146:147], v216 offset:4096
    v_max3_f32 v120, v8, v9, v10
    s_add_u32 m0, s49, 49152
    s_nop 0
    buffer_load_dwordx4 v118, s[28:31], s58 offen nt lds
    s_add_u32 s58, s58, 2048
    v_mfma_f32_16x16x32_bf16 v[92:95], v[112:115], v[0:3], v[92:95]
    ds_read_b64_tr_b16 v[148:149], v217
    ds_read_b64_tr_b16 v[150:151], v217 offset:4096
    v_max3_f32 v121, v24, v25, v26
    v_mfma_f32_16x16x32_bf16 v[96:99], v[112:115], v[16:19], v[96:99]
    ds_read_b64_tr_b16 v[152:153], v218
    ds_read_b64_tr_b16 v[154:155], v218 offset:4096
    v_max3_f32 v122, v40, v41, v42
    v_mfma_f32_16x16x32_bf16 v[100:103], v[112:115], v[32:35], v[100:103]
    ds_read_b64_tr_b16 v[156:157], v219
    ds_read_b64_tr_b16 v[158:159], v219 offset:4096
    v_max3_f32 v123, v56, v57, v58
    v_mfma_f32_16x16x32_bf16 v[104:107], v[112:115], v[48:51], v[104:107]
    ds_read_b64_tr_b16 v[160:161], v220
    ds_read_b64_tr_b16 v[162:163], v220 offset:4096
    v_max3_f32 v120, v120, v11, v12
    v_mfma_f32_16x16x32_bf16 v[108:111], v[112:115], v[64:67], v[108:111]
    ds_read_b64_tr_b16 v[164:165], v221
    ds_read_b64_tr_b16 v[166:167], v221 offset:4096
    v_max3_f32 v121, v121, v27, v28
    s_waitcnt lgkmcnt(10)
    v_mfma_f32_16x16x32_bf16 a[0:3], v[144:147], v[0:3], a[0:3]
    ds_read_b64_tr_b16 v[168:169], v222
    ds_read_b64_tr_b16 v[170:171], v222 offset:4096
    v_max3_f32 v122, v122, v43, v44
    v_mfma_f32_16x16x32_bf16 a[32:35], v[144:147], v[16:19], a[32:35]
    ds_read_b64_tr_b16 v[172:173], v223
    ds_read_b64_tr_b16 v[174:175], v223 offset:4096
    v_max3_f32 v123, v123, v59, v60
    v_mfma_f32_16x16x32_bf16 a[64:67], v[144:147], v[32:35], a[64:67]
    ds_read_b128 v[176:179], v208 offset:16384
    v_max3_f32 v120, v120, v13, v14
    v_mfma_f32_16x16x32_bf16 a[96:99], v[144:147], v[48:51], a[96:99]
    ds_read_b128 v[180:183], v209 offset:16384
    v_max3_f32 v121, v121, v29, v30
    v_mfma_f32_16x16x32_bf16 a[128:131], v[144:147], v[64:67], a[128:131]
    ds_read_b128 v[184:187], v210 offset:16384
    v_max3_f32 v122, v122, v45, v46
    s_waitcnt lgkmcnt(15)
    v_mfma_f32_16x16x32_bf16 a[4:7], v[148:151], v[0:3], a[4:7]
    ds_read_b128 v[188:191], v211 offset:16384
    v_max3_f32 v123, v123, v61, v62
    v_mfma_f32_16x16x32_bf16 a[36:39], v[148:151], v[16:19], a[36:39]
    ds_read_b128 v[192:195], v208 offset:20480
    v_max_f32 v120, v120, v15
    v_mfma_f32_16x16x32_bf16 a[68:71], v[148:151], v[32:35], a[68:71]
    ds_read_b128 v[196:199], v209 offset:20480
    v_max_f32 v121, v121, v31
    v_mfma_f32_16x16x32_bf16 a[100:103], v[148:151], v[48:51], a[100:103]
    ds_read_b128 v[200:203], v210 offset:20480
    v_max_f32 v122, v122, v47
    v_mfma_f32_16x16x32_bf16 a[132:135], v[148:151], v[64:67], a[132:135]
    ds_read_b128 v[204:207], v211 offset:20480
    v_max_f32 v123, v123, v63
    s_waitcnt lgkmcnt(15)
    v_mfma_f32_16x16x32_bf16 a[8:11], v[152:155], v[0:3], a[8:11]
    ds_read_b64_tr_b16 v[144:145], v224 offset:8192
    ds_read_b64_tr_b16 v[146:147], v224 offset:12288
    s_add_u32 m0, s49, 51200
    s_nop 0
    buffer_load_dwordx4 v118, s[28:31], s58 offen nt lds
    s_add_u32 s58, s58, 2048
    v_mfma_f32_16x16x32_bf16 a[40:43], v[152:155], v[16:19], a[40:43]
    ds_read_b64_tr_b16 v[148:149], v225 offset:8192
    ds_read_b64_tr_b16 v[150:151], v225 offset:12288
    s_add_u32 m0, s49, 53248
    s_nop 0
    buffer_load_dwordx4 v118, s[28:31], s58 offen nt lds
    s_add_u32 s58, s58, 2048
    v_mfma_f32_16x16x32_bf16 a[72:75], v[152:155], v[32:35], a[72:75]
    s_add_u32 m0, s49, 55296
    s_nop 0
    buffer_load_dwordx4 v118, s[28:31], s58 offen nt lds
    s_add_u32 s58, s58, 2048
    v_mfma_f32_16x16x32_bf16 a[104:107], v[152:155], v[48:51], a[104:107]
    v_mfma_f32_16x16x32_bf16 a[136:139], v[152:155], v[64:67], a[136:139]
    ds_read_b64_tr_b16 v[152:153], v226 offset:8192
    ds_read_b64_tr_b16 v[154:155], v226 offset:12288
    v_mfma_f32_16x16x32_bf16 a[12:15], v[156:159], v[0:3], a[12:15]
    v_mfma_f32_16x16x32_bf16 a[44:47], v[156:159], v[16:19], a[44:47]
    v_mfma_f32_16x16x32_bf16 a[76:79], v[156:159], v[32:35], a[76:79]
    v_mfma_f32_16x16x32_bf16 a[108:111], v[156:159], v[48:51], a[108:111]
    s_add_u32 m0, s49, 57344
    s_nop 0
    buffer_load_dwordx4 v118, s[28:31], s58 offen nt lds
    s_add_u32 s58, s58, 2048
    v_mfma_f32_16x16x32_bf16 a[140:143], v[156:159], v[64:67], a[140:143]
    ds_read_b64_tr_b16 v[156:157], v227 offset:8192
    ds_read_b64_tr_b16 v[158:159], v227 offset:12288
    s_waitcnt lgkmcnt(15)
    v_mfma_f32_16x16x32_bf16 a[16:19], v[160:163], v[0:3], a[16:19]
    v_mfma_f32_16x16x32_bf16 a[48:51], v[160:163], v[16:19], a[48:51]
    v_mfma_f32_16x16x32_bf16 a[80:83], v[160:163], v[32:35], a[80:83]
    v_mfma_f32_16x16x32_bf16 a[112:115], v[160:163], v[48:51], a[112:115]
    v_mfma_f32_16x16x32_bf16 a[144:147], v[160:163], v[64:67], a[144:147]
    ds_read_b64_tr_b16 v[160:161], v228 offset:8192
    ds_read_b64_tr_b16 v[162:163], v228 offset:12288
    s_add_u32 m0, s49, 59392
    s_nop 0
    buffer_load_dwordx4 v118, s[28:31], s58 offen nt lds
    s_add_u32 s58, s58, 2048
    v_mfma_f32_16x16x32_bf16 a[20:23], v[164:167], v[0:3], a[20:23]
    v_mfma_f32_16x16x32_bf16 a[52:55], v[164:167], v[16:19], a[52:55]
    v_mfma_f32_16x16x32_bf16 a[84:87], v[164:167], v[32:35], a[84:87]
    v_mfma_f32_16x16x32_bf16 a[116:119], v[164:167], v[48:51], a[116:119]
    v_mfma_f32_16x16x32_bf16 a[148:151], v[164:167], v[64:67], a[148:151]
    ds_read_b64_tr_b16 v[164:165], v229 offset:8192
    ds_read_b64_tr_b16 v[166:167], v229 offset:12288
    v_mfma_f32_16x16x32_bf16 a[24:27], v[168:171], v[0:3], a[24:27]
    s_add_u32 m0, s49, 61440
    s_nop 0
    buffer_load_dwordx4 v118, s[28:31], s58 offen nt lds
    s_add_u32 s58, s58, 2048
    v_mfma_f32_16x16x32_bf16 a[56:59], v[168:171], v[16:19], a[56:59]
    v_mfma_f32_16x16x32_bf16 a[88:91], v[168:171], v[32:35], a[88:91]
    v_mfma_f32_16x16x32_bf16 a[120:123], v[168:171], v[48:51], a[120:123]
    v_mfma_f32_16x16x32_bf16 a[152:155], v[168:171], v[64:67], a[152:155]
    ds_read_b64_tr_b16 v[168:169], v230 offset:8192
    ds_read_b64_tr_b16 v[170:171], v230 offset:12288
    v_mfma_f32_16x16x32_bf16 a[28:31], v[172:175], v[0:3], a[28:31]
    v_mfma_f32_16x16x32_bf16 a[60:63], v[172:175], v[16:19], a[60:63]
    s_add_u32 m0, s49, 63488
    s_nop 0
    buffer_load_dwordx4 v118, s[28:31], s58 offen nt lds
    s_add_u32 s58, s58, 2048
    v_mfma_f32_16x16x32_bf16 a[92:95], v[172:175], v[32:35], a[92:95]
    v_mfma_f32_16x16x32_bf16 a[124:127], v[172:175], v[48:51], a[124:127]
    v_mfma_f32_16x16x32_bf16 a[156:159], v[172:175], v[64:67], a[156:159]
    ds_read_b64_tr_b16 v[172:173], v231 offset:8192
    ds_read_b64_tr_b16 v[174:175], v231 offset:12288
    v_max3_f32 v125, v120, v121, v122
    v_max_f32 v125, v125, v123
    v_cmp_lt_f32 vcc, s59, v125
    s_nop 4
    s_cbranch_vccnz attn_kernel_n10
attn_kernel_n11:
    v_exp_f32 v8, v8
    v_exp_f32 v9, v9
    v_mfma_f32_16x16x32_bf16 v[0:3], v[176:179], a[160:163], v[72:75]
    v_exp_f32 v10, v10
    s_add_u32 m0, s49, 65536
    s_nop 0
    buffer_load_dwordx4 v116, s[24:27], s57 offen nt lds
    v_mfma_f32_16x16x32_bf16 v[16:19], v[176:179], a[176:179], v[76:79]
    v_exp_f32 v11, v11
    v_exp_f32 v12, v12
    v_mfma_f32_16x16x32_bf16 v[32:35], v[176:179], a[192:195], v[80:83]
    v_exp_f32 v13, v13
    v_exp_f32 v14, v14
    v_mfma_f32_16x16x32_bf16 v[48:51], v[176:179], a[208:211], v[84:87]
    v_exp_f32 v15, v15
    v_cvt_pk_bf16_f32 v8, v8, v9
    v_mfma_f32_16x16x32_bf16 v[64:67], v[176:179], a[224:227], v[88:91]
    ds_read_b128 v[176:179], v212 offset:24576
    v_cvt_pk_bf16_f32 v9, v10, v11
    s_waitcnt lgkmcnt(15)
    v_mfma_f32_16x16x32_bf16 v[0:3], v[180:183], a[164:167], v[0:3]
    v_cvt_pk_bf16_f32 v10, v12, v13
    v_cvt_pk_bf16_f32 v11, v14, v15
    v_mfma_f32_16x16x32_bf16 v[16:19], v[180:183], a[180:183], v[16:19]
    v_exp_f32 v24, v24
    s_add_u32 m0, s49, 67584
    s_nop 0
    buffer_load_dwordx4 v117, s[24:27], s57 offen nt lds
    s_add_u32 s57, s57, 4096
    v_mfma_f32_16x16x32_bf16 v[32:35], v[180:183], a[196:199], v[32:35]
    v_exp_f32 v25, v25
    v_exp_f32 v26, v26
    v_mfma_f32_16x16x32_bf16 v[48:51], v[180:183], a[212:215], v[48:51]
    v_exp_f32 v27, v27
    v_exp_f32 v28, v28
    v_mfma_f32_16x16x32_bf16 v[64:67], v[180:183], a[228:231], v[64:67]
    ds_read_b128 v[180:183], v213 offset:24576
    v_exp_f32 v29, v29
    v_mfma_f32_16x16x32_bf16 v[0:3], v[184:187], a[168:171], v[0:3]
    v_exp_f32 v30, v30
    v_exp_f32 v31, v31
    v_mfma_f32_16x16x32_bf16 v[16:19], v[184:187], a[184:187], v[16:19]
    v_cvt_pk_bf16_f32 v24, v24, v25
    v_cvt_pk_bf16_f32 v25, v26, v27
    v_mfma_f32_16x16x32_bf16 v[32:35], v[184:187], a[200:203], v[32:35]
    v_cvt_pk_bf16_f32 v26, v28, v29
    s_add_u32 m0, s49, 69632
    s_nop 0
    buffer_load_dwordx4 v116, s[24:27], s57 offen nt lds
    v_mfma_f32_16x16x32_bf16 v[48:51], v[184:187], a[216:219], v[48:51]
    v_cvt_pk_bf16_f32 v27, v30, v31
    v_exp_f32 v40, v40
    v_mfma_f32_16x16x32_bf16 v[64:67], v[184:187], a[232:235], v[64:67]
    ds_read_b128 v[184:187], v214 offset:24576
    v_exp_f32 v41, v41
    v_mfma_f32_16x16x32_bf16 v[0:3], v[188:191], a[172:175], v[0:3]
    v_exp_f32 v42, v42
    v_exp_f32 v43, v43
    v_mfma_f32_16x16x32_bf16 v[16:19], v[188:191], a[188:191], v[16:19]
    v_exp_f32 v44, v44
    v_exp_f32 v45, v45
    v_mfma_f32_16x16x32_bf16 v[32:35], v[188:191], a[204:207], v[32:35]
    v_exp_f32 v46, v46
    v_exp_f32 v47, v47
    v_mfma_f32_16x16x32_bf16 v[48:51], v[188:191], a[220:223], v[48:51]
    v_cvt_pk_bf16_f32 v40, v40, v41
    s_add_u32 m0, s49, 71680
    s_nop 0
    buffer_load_dwordx4 v117, s[24:27], s57 offen nt lds
    s_add_u32 s57, s57, 4096
    v_mfma_f32_16x16x32_bf16 v[64:67], v[188:191], a[236:239], v[64:67]
    ds_read_b128 v[188:191], v215 offset:24576
    v_cvt_pk_bf16_f32 v41, v42, v43
    v_mfma_f32_16x16x32_bf16 v[4:7], v[192:195], a[160:163], v[72:75]
    v_cvt_pk_bf16_f32 v42, v44, v45
    v_cvt_pk_bf16_f32 v43, v46, v47
    v_mfma_f32_16x16x32_bf16 v[20:23], v[192:195], a[176:179], v[76:79]
    v_exp_f32 v56, v56
    v_exp_f32 v57, v57
    v_mfma_f32_16x16x32_bf16 v[36:39], v[192:195], a[192:195], v[80:83]
    v_exp_f32 v58, v58
    v_exp_f32 v59, v59
    v_mfma_f32_16x16x32_bf16 v[52:55], v[192:195], a[208:211], v[84:87]
    v_exp_f32 v60, v60
    v_exp_f32 v61, v61
    v_mfma_f32_16x16x32_bf16 v[68:71], v[192:195], a[224:227], v[88:91]
    ds_read_b128 v[192:195], v212 offset:28672
    v_exp_f32 v62, v62
    v_mfma_f32_16x16x32_bf16 v[4:7], v[196:199], a[164:167], v[4:7]
    v_exp_f32 v63, v63
    s_add_u32 m0, s49, 73728
    s_nop 0
    buffer_load_dwordx4 v116, s[24:27], s57 offen nt lds
    v_mfma_f32_16x16x32_bf16 v[20:23], v[196:199], a[180:183], v[20:23]
    v_cvt_pk_bf16_f32 v56, v56, v57
    v_cvt_pk_bf16_f32 v57, v58, v59
    v_mfma_f32_16x16x32_bf16 v[36:39], v[196:199], a[196:199], v[36:39]
    v_cvt_pk_bf16_f32 v58, v60, v61
    v_cvt_pk_bf16_f32 v59, v62, v63
    v_mfma_f32_16x16x32_bf16 v[52:55], v[196:199], a[212:215], v[52:55]
    v_mfma_f32_16x16x32_bf16 v[68:71], v[196:199], a[228:231], v[68:71]
    ds_read_b128 v[196:199], v213 offset:28672
    v_mfma_f32_16x16x32_bf16 v[4:7], v[200:203], a[168:171], v[4:7]
    s_add_u32 m0, s49, 75776
    s_nop 0
    buffer_load_dwordx4 v117, s[24:27], s57 offen nt lds
    s_add_u32 s57, s57, 4096
    v_mfma_f32_16x16x32_bf16 v[20:23], v[200:203], a[184:187], v[20:23]
    v_mfma_f32_16x16x32_bf16 v[36:39], v[200:203], a[200:203], v[36:39]
    v_mfma_f32_16x16x32_bf16 v[52:55], v[200:203], a[216:219], v[52:55]
    v_mfma_f32_16x16x32_bf16 v[68:71], v[200:203], a[232:235], v[68:71]
    ds_read_b128 v[200:203], v214 offset:28672
    v_mfma_f32_16x16x32_bf16 v[4:7], v[204:207], a[172:175], v[4:7]
    v_mfma_f32_16x16x32_bf16 v[20:23], v[204:207], a[188:191], v[20:23]
    s_add_u32 m0, s49, 77824
    s_nop 0
    buffer_load_dwordx4 v116, s[24:27], s57 offen nt lds
    v_mfma_f32_16x16x32_bf16 v[36:39], v[204:207], a[204:207], v[36:39]
    v_mfma_f32_16x16x32_bf16 v[52:55], v[204:207], a[220:223], v[52:55]
    v_mfma_f32_16x16x32_bf16 v[68:71], v[204:207], a[236:239], v[68:71]
    ds_read_b128 v[204:207], v215 offset:28672
    v_mfma_f32_16x16x32_bf16 v[92:95], v[112:115], v[8:11], v[92:95]
    v_mfma_f32_16x16x32_bf16 v[96:99], v[112:115], v[24:27], v[96:99]
    s_add_u32 m0, s49, 79872
    s_nop 0
    buffer_load_dwordx4 v117, s[24:27], s57 offen nt lds
    s_add_u32 s57, s57, 4096
    v_mfma_f32_16x16x32_bf16 v[100:103], v[112:115], v[40:43], v[100:103]
    v_max3_f32 v120, v0, v1, v2
    v_max3_f32 v121, v16, v17, v18
    v_mfma_f32_16x16x32_bf16 v[104:107], v[112:115], v[56:59], v[104:107]
    v_max3_f32 v122, v32, v33, v34
    v_max3_f32 v123, v48, v49, v50
    v_mfma_f32_16x16x32_bf16 a[0:3], v[144:147], v[8:11], a[0:3]
    v_max3_f32 v124, v64, v65, v66
    v_max3_f32 v120, v120, v3, v4
    v_mfma_f32_16x16x32_bf16 a[32:35], v[144:147], v[24:27], a[32:35]
    v_max3_f32 v121, v121, v19, v20
    v_max3_f32 v122, v122, v35, v36
    v_mfma_f32_16x16x32_bf16 a[64:67], v[144:147], v[40:43], a[64:67]
    v_max3_f32 v123, v123, v51, v52
    v_max3_f32 v124, v124, v67, v68
    v_mfma_f32_16x16x32_bf16 a[96:99], v[144:147], v[56:59], a[96:99]
    v_max3_f32 v120, v120, v5, v6
    v_max3_f32 v121, v121, v21, v22
    s_waitcnt lgkmcnt(15)
    v_mfma_f32_16x16x32_bf16 a[4:7], v[148:151], v[8:11], a[4:7]
    v_max3_f32 v122, v122, v37, v38
    v_max3_f32 v123, v123, v53, v54
    v_mfma_f32_16x16x32_bf16 a[36:39], v[148:151], v[24:27], a[36:39]
    v_max3_f32 v124, v124, v69, v70
    v_max_f32 v120, v120, v7
    v_mfma_f32_16x16x32_bf16 a[68:71], v[148:151], v[40:43], a[68:71]
    v_max_f32 v121, v121, v23
    v_max_f32 v122, v122, v39
    v_mfma_f32_16x16x32_bf16 a[100:103], v[148:151], v[56:59], a[100:103]
    v_max_f32 v123, v123, v55
    v_max_f32 v124, v124, v71
    v_mfma_f32_16x16x32_bf16 a[8:11], v[152:155], v[8:11], a[8:11]
    v_mfma_f32_16x16x32_bf16 a[40:43], v[152:155], v[24:27], a[40:43]
    v_mfma_f32_16x16x32_bf16 a[72:75], v[152:155], v[40:43], a[72:75]
    v_mfma_f32_16x16x32_bf16 a[104:107], v[152:155], v[56:59], a[104:107]
    v_mfma_f32_16x16x32_bf16 a[12:15], v[156:159], v[8:11], a[12:15]
    v_mfma_f32_16x16x32_bf16 a[44:47], v[156:159], v[24:27], a[44:47]
    v_mfma_f32_16x16x32_bf16 a[76:79], v[156:159], v[40:43], a[76:79]
    v_mfma_f32_16x16x32_bf16 a[108:111], v[156:159], v[56:59], a[108:111]
    s_waitcnt lgkmcnt(14)
    v_mfma_f32_16x16x32_bf16 a[16:19], v[160:163], v[8:11], a[16:19]
    v_mfma_f32_16x16x32_bf16 a[48:51], v[160:163], v[24:27], a[48:51]
    v_mfma_f32_16x16x32_bf16 a[80:83], v[160:163], v[40:43], a[80:83]
    v_mfma_f32_16x16x32_bf16 a[112:115], v[160:163], v[56:59], a[112:115]
    s_waitcnt lgkmcnt(12)
    v_mfma_f32_16x16x32_bf16 a[20:23], v[164:167], v[8:11], a[20:23]
    v_mfma_f32_16x16x32_bf16 a[52:55], v[164:167], v[24:27], a[52:55]
    v_mfma_f32_16x16x32_bf16 a[84:87], v[164:167], v[40:43], a[84:87]
    v_mfma_f32_16x16x32_bf16 a[116:119], v[164:167], v[56:59], a[116:119]
    s_waitcnt lgkmcnt(10)
    v_mfma_f32_16x16x32_bf16 a[24:27], v[168:171], v[8:11], a[24:27]
    v_mfma_f32_16x16x32_bf16 a[56:59], v[168:171], v[24:27], a[56:59]
    v_mfma_f32_16x16x32_bf16 a[88:91], v[168:171], v[40:43], a[88:91]
    v_mfma_f32_16x16x32_bf16 a[120:123], v[168:171], v[56:59], a[120:123]
    s_waitcnt lgkmcnt(8)
    v_mfma_f32_16x16x32_bf16 a[28:31], v[172:175], v[8:11], a[28:31]
    v_mfma_f32_16x16x32_bf16 a[60:63], v[172:175], v[24:27], a[60:63]
    v_mfma_f32_16x16x32_bf16 a[92:95], v[172:175], v[40:43], a[92:95]
    v_mfma_f32_16x16x32_bf16 a[124:127], v[172:175], v[56:59], a[124:127]
    v_max3_f32 v125, v120, v121, v122
    v_max3_f32 v125, v125, v123, v124
    v_cmp_lt_f32 vcc, s59, v125
    s_nop 4
    s_cbranch_vccnz attn_kernel_n12
attn_kernel_n13:
    v_exp_f32 v0, v0
    v_exp_f32 v1, v1
    s_waitcnt lgkmcnt(7)
    v_mfma_f32_16x16x32_bf16 v[8:11], v[176:179], a[160:163], v[72:75]
    v_exp_f32 v2, v2
    v_exp_f32 v3, v3
    v_mfma_f32_16x16x32_bf16 v[24:27], v[176:179], a[176:179], v[76:79]
    v_exp_f32 v4, v4
    v_exp_f32 v5, v5
    v_mfma_f32_16x16x32_bf16 v[40:43], v[176:179], a[192:195], v[80:83]
    v_exp_f32 v6, v6
    v_exp_f32 v7, v7
    v_mfma_f32_16x16x32_bf16 v[56:59], v[176:179], a[208:211], v[84:87]
    v_cvt_pk_bf16_f32 v0, v0, v1
    v_cvt_pk_bf16_f32 v1, v2, v3
    s_waitcnt lgkmcnt(6)
    v_mfma_f32_16x16x32_bf16 v[8:11], v[180:183], a[164:167], v[8:11]
    v_cvt_pk_bf16_f32 v2, v4, v5
    v_cvt_pk_bf16_f32 v3, v6, v7
    v_mfma_f32_16x16x32_bf16 v[24:27], v[180:183], a[180:183], v[24:27]
    v_exp_f32 v16, v16
    v_exp_f32 v17, v17
    v_mfma_f32_16x16x32_bf16 v[40:43], v[180:183], a[196:199], v[40:43]
    v_exp_f32 v18, v18
    v_exp_f32 v19, v19
    v_mfma_f32_16x16x32_bf16 v[56:59], v[180:183], a[212:215], v[56:59]
    v_exp_f32 v20, v20
    v_exp_f32 v21, v21
    s_waitcnt lgkmcnt(5)
    v_mfma_f32_16x16x32_bf16 v[8:11], v[184:187], a[168:171], v[8:11]
    v_exp_f32 v22, v22
    v_exp_f32 v23, v23
    v_mfma_f32_16x16x32_bf16 v[24:27], v[184:187], a[184:187], v[24:27]
    v_cvt_pk_bf16_f32 v16, v16, v17
    v_cvt_pk_bf16_f32 v17, v18, v19
    v_mfma_f32_16x16x32_bf16 v[40:43], v[184:187], a[200:203], v[40:43]
    v_cvt_pk_bf16_f32 v18, v20, v21
    v_cvt_pk_bf16_f32 v19, v22, v23
    v_mfma_f32_16x16x32_bf16 v[56:59], v[184:187], a[216:219], v[56:59]
    v_exp_f32 v32, v32
    v_exp_f32 v33, v33
    s_waitcnt lgkmcnt(4)
    v_mfma_f32_16x16x32_bf16 v[8:11], v[188:191], a[172:175], v[8:11]
    v_exp_f32 v34, v34
    v_exp_f32 v35, v35
    v_mfma_f32_16x16x32_bf16 v[24:27], v[188:191], a[188:191], v[24:27]
    v_exp_f32 v36, v36
    v_exp_f32 v37, v37
    v_mfma_f32_16x16x32_bf16 v[40:43], v[188:191], a[204:207], v[40:43]
    v_exp_f32 v38, v38
    v_exp_f32 v39, v39
    v_mfma_f32_16x16x32_bf16 v[56:59], v[188:191], a[220:223], v[56:59]
    v_cvt_pk_bf16_f32 v32, v32, v33
    v_cvt_pk_bf16_f32 v33, v34, v35
    s_waitcnt lgkmcnt(3)
    v_mfma_f32_16x16x32_bf16 v[12:15], v[192:195], a[160:163], v[72:75]
    v_cvt_pk_bf16_f32 v34, v36, v37
    v_cvt_pk_bf16_f32 v35, v38, v39
    v_mfma_f32_16x16x32_bf16 v[28:31], v[192:195], a[176:179], v[76:79]
    v_exp_f32 v48, v48
    v_exp_f32 v49, v49
    v_mfma_f32_16x16x32_bf16 v[44:47], v[192:195], a[192:195], v[80:83]
    v_exp_f32 v50, v50
    v_exp_f32 v51, v51
    v_mfma_f32_16x16x32_bf16 v[60:63], v[192:195], a[208:211], v[84:87]
    v_exp_f32 v52, v52
    v_exp_f32 v53, v53
    s_waitcnt lgkmcnt(2)
    v_mfma_f32_16x16x32_bf16 v[12:15], v[196:199], a[164:167], v[12:15]
    v_exp_f32 v54, v54
    v_exp_f32 v55, v55
    v_mfma_f32_16x16x32_bf16 v[28:31], v[196:199], a[180:183], v[28:31]
    v_cvt_pk_bf16_f32 v48, v48, v49
    v_cvt_pk_bf16_f32 v49, v50, v51
    v_mfma_f32_16x16x32_bf16 v[44:47], v[196:199], a[196:199], v[44:47]
    v_cvt_pk_bf16_f32 v50, v52, v53
    v_cvt_pk_bf16_f32 v51, v54, v55
    v_mfma_f32_16x16x32_bf16 v[60:63], v[196:199], a[212:215], v[60:63]
    v_exp_f32 v64, v64
    v_exp_f32 v65, v65
    s_waitcnt lgkmcnt(1)
    v_mfma_f32_16x16x32_bf16 v[12:15], v[200:203], a[168:171], v[12:15]
    v_exp_f32 v66, v66
    v_exp_f32 v67, v67
    v_mfma_f32_16x16x32_bf16 v[28:31], v[200:203], a[184:187], v[28:31]
    v_exp_f32 v68, v68
    v_exp_f32 v69, v69
    v_mfma_f32_16x16x32_bf16 v[44:47], v[200:203], a[200:203], v[44:47]
    v_exp_f32 v70, v70
    v_exp_f32 v71, v71
    v_mfma_f32_16x16x32_bf16 v[60:63], v[200:203], a[216:219], v[60:63]
    v_cvt_pk_bf16_f32 v64, v64, v65
    v_cvt_pk_bf16_f32 v65, v66, v67
    s_waitcnt lgkmcnt(0)
    v_mfma_f32_16x16x32_bf16 v[12:15], v[204:207], a[172:175], v[12:15]
    v_cvt_pk_bf16_f32 v66, v68, v69
    v_cvt_pk_bf16_f32 v67, v70, v71
    v_mfma_f32_16x16x32_bf16 v[28:31], v[204:207], a[188:191], v[28:31]
    v_mfma_f32_16x16x32_bf16 v[44:47], v[204:207], a[204:207], v[44:47]
    v_mfma_f32_16x16x32_bf16 v[60:63], v[204:207], a[220:223], v[60:63]
    s_waitcnt vmcnt(0) lgkmcnt(0)
    s_waitcnt vmcnt(0) lgkmcnt(0)
    s_barrier
    s_add_u32 s56, s56, 1
    s_cmp_lt_u32 s56, 3
    s_nop 7
    s_cbranch_scc1 attn_kernel_n5
    ds_read_b64_tr_b16 v[144:145], v216 offset:32768
    ds_read_b64_tr_b16 v[146:147], v216 offset:36864
    v_max3_f32 v120, v8, v9, v10
    v_max3_f32 v121, v24, v25, v26
    v_mfma_f32_16x16x32_bf16 v[92:95], v[112:115], v[0:3], v[92:95]
    ds_read_b64_tr_b16 v[148:149], v217 offset:32768
    ds_read_b64_tr_b16 v[150:151], v217 offset:36864
    v_max3_f32 v122, v40, v41, v42
    v_mfma_f32_16x16x32_bf16 v[96:99], v[112:115], v[16:19], v[96:99]
    ds_read_b64_tr_b16 v[152:153], v218 offset:32768
    ds_read_b64_tr_b16 v[154:155], v218 offset:36864
    v_max3_f32 v123, v56, v57, v58
    v_mfma_f32_16x16x32_bf16 v[100:103], v[112:115], v[32:35], v[100:103]
    ds_read_b64_tr_b16 v[156:157], v219 offset:32768
    ds_read_b64_tr_b16 v[158:159], v219 offset:36864
    v_max3_f32 v120, v120, v11, v12
    v_mfma_f32_16x16x32_bf16 v[104:107], v[112:115], v[48:51], v[104:107]
    ds_read_b64_tr_b16 v[160:161], v220 offset:32768
    ds_read_b64_tr_b16 v[162:163], v220 offset:36864
    v_max3_f32 v121, v121, v27, v28
    v_mfma_f32_16x16x32_bf16 v[108:111], v[112:115], v[64:67], v[108:111]
    ds_read_b64_tr_b16 v[164:165], v221 offset:32768
    ds_read_b64_tr_b16 v[166:167], v221 offset:36864
    v_max3_f32 v122, v122, v43, v44
    s_waitcnt lgkmcnt(10)
    v_mfma_f32_16x16x32_bf16 a[0:3], v[144:147], v[0:3], a[0:3]
    ds_read_b64_tr_b16 v[168:169], v222 offset:32768
    ds_read_b64_tr_b16 v[170:171], v222 offset:36864
    v_max3_f32 v123, v123, v59, v60
    v_mfma_f32_16x16x32_bf16 a[32:35], v[144:147], v[16:19], a[32:35]
    ds_read_b64_tr_b16 v[172:173], v223 offset:32768
    ds_read_b64_tr_b16 v[174:175], v223 offset:36864
    v_max3_f32 v120, v120, v13, v14
    v_mfma_f32_16x16x32_bf16 a[64:67], v[144:147], v[32:35], a[64:67]
    ds_read_b64_tr_b16 v[176:177], v224 offset:40960
    ds_read_b64_tr_b16 v[178:179], v224 offset:45056
    v_max3_f32 v121, v121, v29, v30
    v_mfma_f32_16x16x32_bf16 a[96:99], v[144:147], v[48:51], a[96:99]
    ds_read_b64_tr_b16 v[180:181], v225 offset:40960
    ds_read_b64_tr_b16 v[182:183], v225 offset:45056
    v_max3_f32 v122, v122, v45, v46
    v_mfma_f32_16x16x32_bf16 a[128:131], v[144:147], v[64:67], a[128:131]
    ds_read_b64_tr_b16 v[184:185], v226 offset:40960
    ds_read_b64_tr_b16 v[186:187], v226 offset:45056
    v_max3_f32 v123, v123, v61, v62
    s_waitcnt lgkmcnt(15)
    v_mfma_f32_16x16x32_bf16 a[4:7], v[148:151], v[0:3], a[4:7]
    ds_read_b64_tr_b16 v[188:189], v227 offset:40960
    ds_read_b64_tr_b16 v[190:191], v227 offset:45056
    v_max_f32 v120, v120, v15
    v_mfma_f32_16x16x32_bf16 a[36:39], v[148:151], v[16:19], a[36:39]
    ds_read_b64_tr_b16 v[192:193], v228 offset:40960
    ds_read_b64_tr_b16 v[194:195], v228 offset:45056
    v_max_f32 v121, v121, v31
    v_mfma_f32_16x16x32_bf16 a[68:71], v[148:151], v[32:35], a[68:71]
    ds_read_b64_tr_b16 v[196:197], v229 offset:40960
    ds_read_b64_tr_b16 v[198:199], v229 offset:45056
    v_max_f32 v122, v122, v47
    v_mfma_f32_16x16x32_bf16 a[100:103], v[148:151], v[48:51], a[100:103]
    ds_read_b64_tr_b16 v[200:201], v230 offset:40960
    ds_read_b64_tr_b16 v[202:203], v230 offset:45056
    v_max_f32 v123, v123, v63
    v_mfma_f32_16x16x32_bf16 a[132:135], v[148:151], v[64:67], a[132:135]
    ds_read_b64_tr_b16 v[204:205], v231 offset:40960
    ds_read_b64_tr_b16 v[206:207], v231 offset:45056
    v_mfma_f32_16x16x32_bf16 a[8:11], v[152:155], v[0:3], a[8:11]
    v_mfma_f32_16x16x32_bf16 a[40:43], v[152:155], v[16:19], a[40:43]
    v_mfma_f32_16x16x32_bf16 a[72:75], v[152:155], v[32:35], a[72:75]
    v_mfma_f32_16x16x32_bf16 a[104:107], v[152:155], v[48:51], a[104:107]
    v_mfma_f32_16x16x32_bf16 a[136:139], v[152:155], v[64:67], a[136:139]
    s_waitcnt lgkmcnt(15)
    v_mfma_f32_16x16x32_bf16 a[12:15], v[156:159], v[0:3], a[12:15]
    v_mfma_f32_16x16x32_bf16 a[44:47], v[156:159], v[16:19], a[44:47]
    v_mfma_f32_16x16x32_bf16 a[76:79], v[156:159], v[32:35], a[76:79]
    v_mfma_f32_16x16x32_bf16 a[108:111], v[156:159], v[48:51], a[108:111]
    v_mfma_f32_16x16x32_bf16 a[140:143], v[156:159], v[64:67], a[140:143]
    v_mfma_f32_16x16x32_bf16 a[16:19], v[160:163], v[0:3], a[16:19]
    v_mfma_f32_16x16x32_bf16 a[48:51], v[160:163], v[16:19], a[48:51]
    v_mfma_f32_16x16x32_bf16 a[80:83], v[160:163], v[32:35], a[80:83]
    v_mfma_f32_16x16x32_bf16 a[112:115], v[160:163], v[48:51], a[112:115]
    v_mfma_f32_16x16x32_bf16 a[144:147], v[160:163], v[64:67], a[144:147]
    v_mfma_f32_16x16x32_bf16 a[20:23], v[164:167], v[0:3], a[20:23]
    v_mfma_f32_16x16x32_bf16 a[52:55], v[164:167], v[16:19], a[52:55]
    v_mfma_f32_16x16x32_bf16 a[84:87], v[164:167], v[32:35], a[84:87]
    v_mfma_f32_16x16x32_bf16 a[116:119], v[164:167], v[48:51], a[116:119]
    v_mfma_f32_16x16x32_bf16 a[148:151], v[164:167], v[64:67], a[148:151]
    v_mfma_f32_16x16x32_bf16 a[24:27], v[168:171], v[0:3], a[24:27]
    v_mfma_f32_16x16x32_bf16 a[56:59], v[168:171], v[16:19], a[56:59]
    v_mfma_f32_16x16x32_bf16 a[88:91], v[168:171], v[32:35], a[88:91]
    v_mfma_f32_16x16x32_bf16 a[120:123], v[168:171], v[48:51], a[120:123]
    v_mfma_f32_16x16x32_bf16 a[152:155], v[168:171], v[64:67], a[152:155]
    v_mfma_f32_16x16x32_bf16 a[28:31], v[172:175], v[0:3], a[28:31]
    v_mfma_f32_16x16x32_bf16 a[60:63], v[172:175], v[16:19], a[60:63]
    v_mfma_f32_16x16x32_bf16 a[92:95], v[172:175], v[32:35], a[92:95]
    v_mfma_f32_16x16x32_bf16 a[124:127], v[172:175], v[48:51], a[124:127]
    v_mfma_f32_16x16x32_bf16 a[156:159], v[172:175], v[64:67], a[156:159]
    v_max3_f32 v125, v120, v121, v122
    v_max_f32 v125, v125, v123
    v_cmp_lt_f32 vcc, s59, v125
    s_nop 4
    s_cbranch_vccnz attn_kernel_n14
attn_kernel_n15:
    v_exp_f32 v8, v8
    v_exp_f32 v9, v9
    v_exp_f32 v10, v10
    v_exp_f32 v11, v11
    v_exp_f32 v12, v12
    v_exp_f32 v13, v13
    v_exp_f32 v14, v14
    v_exp_f32 v15, v15
    v_cvt_pk_bf16_f32 v8, v8, v9
    v_cvt_pk_bf16_f32 v9, v10, v11
    v_cvt_pk_bf16_f32 v10, v12, v13
    v_cvt_pk_bf16_f32 v11, v14, v15
    v_exp_f32 v24, v24
    v_exp_f32 v25, v25
    v_exp_f32 v26, v26
    v_exp_f32 v27, v27
    v_exp_f32 v28, v28
    v_exp_f32 v29, v29
    v_exp_f32 v30, v30
    v_exp_f32 v31, v31
    v_cvt_pk_bf16_f32 v24, v24, v25
    v_cvt_pk_bf16_f32 v25, v26, v27
    v_cvt_pk_bf16_f32 v26, v28, v29
    v_cvt_pk_bf16_f32 v27, v30, v31
    v_exp_f32 v40, v40
    v_exp_f32 v41, v41
    v_exp_f32 v42, v42
    v_exp_f32 v43, v43
    v_exp_f32 v44, v44
    v_exp_f32 v45, v45
    v_exp_f32 v46, v46
    v_exp_f32 v47, v47
    v_cvt_pk_bf16_f32 v40, v40, v41
    v_cvt_pk_bf16_f32 v41, v42, v43
    v_cvt_pk_bf16_f32 v42, v44, v45
    v_cvt_pk_bf16_f32 v43, v46, v47
    v_exp_f32 v56, v56
    v_exp_f32 v57, v57
    v_exp_f32 v58, v58
    v_exp_f32 v59, v59
    v_exp_f32 v60, v60
    v_exp_f32 v61, v61
    v_exp_f32 v62, v62
    v_exp_f32 v63, v63
    v_cvt_pk_bf16_f32 v56, v56, v57
    v_cvt_pk_bf16_f32 v57, v58, v59
    v_cvt_pk_bf16_f32 v58, v60, v61
    v_cvt_pk_bf16_f32 v59, v62, v63
    v_mfma_f32_16x16x32_bf16 v[92:95], v[112:115], v[8:11], v[92:95]
    v_mfma_f32_16x16x32_bf16 v[96:99], v[112:115], v[24:27], v[96:99]
    v_mfma_f32_16x16x32_bf16 v[100:103], v[112:115], v[40:43], v[100:103]
    v_mfma_f32_16x16x32_bf16 v[104:107], v[112:115], v[56:59], v[104:107]
    s_waitcnt lgkmcnt(14)
    v_mfma_f32_16x16x32_bf16 a[0:3], v[176:179], v[8:11], a[0:3]
    v_mfma_f32_16x16x32_bf16 a[32:35], v[176:179], v[24:27], a[32:35]
    v_mfma_f32_16x16x32_bf16 a[64:67], v[176:179], v[40:43], a[64:67]
    v_mfma_f32_16x16x32_bf16 a[96:99], v[176:179], v[56:59], a[96:99]
    s_waitcnt lgkmcnt(12)
    v_mfma_f32_16x16x32_bf16 a[4:7], v[180:183], v[8:11], a[4:7]
    v_mfma_f32_16x16x32_bf16 a[36:39], v[180:183], v[24:27], a[36:39]
    v_mfma_f32_16x16x32_bf16 a[68:71], v[180:183], v[40:43], a[68:71]
    v_mfma_f32_16x16x32_bf16 a[100:103], v[180:183], v[56:59], a[100:103]
    s_waitcnt lgkmcnt(10)
    v_mfma_f32_16x16x32_bf16 a[8:11], v[184:187], v[8:11], a[8:11]
    v_mfma_f32_16x16x32_bf16 a[40:43], v[184:187], v[24:27], a[40:43]
    v_mfma_f32_16x16x32_bf16 a[72:75], v[184:187], v[40:43], a[72:75]
    v_mfma_f32_16x16x32_bf16 a[104:107], v[184:187], v[56:59], a[104:107]
    s_waitcnt lgkmcnt(8)
    v_mfma_f32_16x16x32_bf16 a[12:15], v[188:191], v[8:11], a[12:15]
    v_mfma_f32_16x16x32_bf16 a[44:47], v[188:191], v[24:27], a[44:47]
    v_mfma_f32_16x16x32_bf16 a[76:79], v[188:191], v[40:43], a[76:79]
    v_mfma_f32_16x16x32_bf16 a[108:111], v[188:191], v[56:59], a[108:111]
    s_waitcnt lgkmcnt(6)
    v_mfma_f32_16x16x32_bf16 a[16:19], v[192:195], v[8:11], a[16:19]
    v_mfma_f32_16x16x32_bf16 a[48:51], v[192:195], v[24:27], a[48:51]
    v_mfma_f32_16x16x32_bf16 a[80:83], v[192:195], v[40:43], a[80:83]
    v_mfma_f32_16x16x32_bf16 a[112:115], v[192:195], v[56:59], a[112:115]
    s_waitcnt lgkmcnt(4)
    v_mfma_f32_16x16x32_bf16 a[20:23], v[196:199], v[8:11], a[20:23]
    v_mfma_f32_16x16x32_bf16 a[52:55], v[196:199], v[24:27], a[52:55]
    v_mfma_f32_16x16x32_bf16 a[84:87], v[196:199], v[40:43], a[84:87]
    v_mfma_f32_16x16x32_bf16 a[116:119], v[196:199], v[56:59], a[116:119]
    s_waitcnt lgkmcnt(2)
    v_mfma_f32_16x16x32_bf16 a[24:27], v[200:203], v[8:11], a[24:27]
    v_mfma_f32_16x16x32_bf16 a[56:59], v[200:203], v[24:27], a[56:59]
    v_mfma_f32_16x16x32_bf16 a[88:91], v[200:203], v[40:43], a[88:91]
    v_mfma_f32_16x16x32_bf16 a[120:123], v[200:203], v[56:59], a[120:123]
    s_waitcnt lgkmcnt(0)
    v_mfma_f32_16x16x32_bf16 a[28:31], v[204:207], v[8:11], a[28:31]
    v_mfma_f32_16x16x32_bf16 a[60:63], v[204:207], v[24:27], a[60:63]
    v_mfma_f32_16x16x32_bf16 a[92:95], v[204:207], v[40:43], a[92:95]
    v_mfma_f32_16x16x32_bf16 a[124:127], v[204:207], v[56:59], a[124:127]
    s_waitcnt lgkmcnt(0)
    s_nop 9
    s_waitcnt vmcnt(0) lgkmcnt(0)
    v_mbcnt_lo_u32_b32 v0, -1, 0
    v_mbcnt_hi_u32_b32 v0, -1, v0
    v_lshrrev_b32 v1, 4, v0
    v_and_b32 v2, 15, v0
    v_and_b32 v4, 1, v1
    v_lshrrev_b32 v5, 1, v1
    v_lshl_add_u32 v4, v4, 1, v5
    v_lshlrev_b32 v5, 4, v2
    v_lshl_add_u32 v8, v4, 8, v5
    s_barrier
    v_mov_b32 v6, v88
    v_mov_b32 v7, v108
    s_lshl_b32 s51, s36, 7
    v_lshlrev_b32 v4, 3, v2
    v_add_u32 v5, s51, v4
    ds_write_b64 v5, v[6:7]
    s_waitcnt lgkmcnt(0)
    s_barrier
    ds_read_b64 v[12:13], v4
    ds_read_b64 v[14:15], v4 offset:128
    s_waitcnt lgkmcnt(0)
    v_min_f32 v5, v12, v14
    v_mov_b32 v6, 0
    v_sub_f32 v7, v5, v12
    v_exp_f32 v7, v7
    s_nop 0
    v_fma_f32 v6, v7, v13, v6
    v_sub_f32 v7, v5, v14
    v_exp_f32 v7, v7
    s_nop 0
    v_fma_f32 v6, v7, v15, v6
    v_sub_f32 v7, v5, v88
    v_exp_f32 v7, v7
    v_rcp_f32 v6, v6
    s_nop 0
    v_mul_f32 v7, v7, v6
    v_accvgpr_read_b32 v32, a128
    v_accvgpr_read_b32 v33, a129
    v_accvgpr_read_b32 v34, a130
    v_accvgpr_read_b32 v35, a131
    v_accvgpr_read_b32 v36, a132
    v_accvgpr_read_b32 v37, a133
    v_accvgpr_read_b32 v38, a134
    v_accvgpr_read_b32 v39, a135
    v_accvgpr_read_b32 v40, a136
    v_accvgpr_read_b32 v41, a137
    v_accvgpr_read_b32 v42, a138
    v_accvgpr_read_b32 v43, a139
    v_accvgpr_read_b32 v44, a140
    v_accvgpr_read_b32 v45, a141
    v_accvgpr_read_b32 v46, a142
    v_accvgpr_read_b32 v47, a143
    v_accvgpr_read_b32 v48, a144
    v_accvgpr_read_b32 v49, a145
    v_accvgpr_read_b32 v50, a146
    v_accvgpr_read_b32 v51, a147
    v_accvgpr_read_b32 v52, a148
    v_accvgpr_read_b32 v53, a149
    v_accvgpr_read_b32 v54, a150
    v_accvgpr_read_b32 v55, a151
    v_accvgpr_read_b32 v56, a152
    v_accvgpr_read_b32 v57, a153
    v_accvgpr_read_b32 v58, a154
    v_accvgpr_read_b32 v59, a155
    v_accvgpr_read_b32 v60, a156
    v_accvgpr_read_b32 v61, a157
    v_accvgpr_read_b32 v62, a158
    v_accvgpr_read_b32 v63, a159
    v_mul_f32 v32, v32, v7
    v_mul_f32 v33, v33, v7
    v_mul_f32 v34, v34, v7
    v_mul_f32 v35, v35, v7
    v_mul_f32 v36, v36, v7
    v_mul_f32 v37, v37, v7
    v_mul_f32 v38, v38, v7
    v_mul_f32 v39, v39, v7
    v_mul_f32 v40, v40, v7
    v_mul_f32 v41, v41, v7
    v_mul_f32 v42, v42, v7
    v_mul_f32 v43, v43, v7
    v_mul_f32 v44, v44, v7
    v_mul_f32 v45, v45, v7
    v_mul_f32 v46, v46, v7
    v_mul_f32 v47, v47, v7
    v_mul_f32 v48, v48, v7
    v_mul_f32 v49, v49, v7
    v_mul_f32 v50, v50, v7
    v_mul_f32 v51, v51, v7
    v_mul_f32 v52, v52, v7
    v_mul_f32 v53, v53, v7
    v_mul_f32 v54, v54, v7
    v_mul_f32 v55, v55, v7
    v_mul_f32 v56, v56, v7
    v_mul_f32 v57, v57, v7
    v_mul_f32 v58, v58, v7
    v_mul_f32 v59, v59, v7
    v_mul_f32 v60, v60, v7
    v_mul_f32 v61, v61, v7
    v_mul_f32 v62, v62, v7
    v_mul_f32 v63, v63, v7
    v_lshlrev_b32 v4, 4, v0
    s_lshl_b32 s51, s36, 13
    v_add_u32 v5, s51, v4
    ds_write_b128 v5, v[32:35] offset:4096
    ds_write_b128 v5, v[36:39] offset:5120
    ds_write_b128 v5, v[40:43] offset:6144
    ds_write_b128 v5, v[44:47] offset:7168
    ds_write_b128 v5, v[48:51] offset:8192
    ds_write_b128 v5, v[52:55] offset:9216
    ds_write_b128 v5, v[56:59] offset:10240
    ds_write_b128 v5, v[60:63] offset:11264
    v_rcp_f32 v6, v92
    s_lshl_b32 s51, s36, 12
    s_add_u32 s51, s51, 0
    v_accvgpr_read_b32 v144, a0
    v_accvgpr_read_b32 v145, a1
    v_accvgpr_read_b32 v146, a2
    v_accvgpr_read_b32 v147, a3
    v_accvgpr_read_b32 v148, a4
    v_accvgpr_read_b32 v149, a5
    v_accvgpr_read_b32 v150, a6
    v_accvgpr_read_b32 v151, a7
    v_mul_f32 v144, v144, v6
    v_mul_f32 v145, v145, v6
    v_mul_f32 v146, v146, v6
    v_mul_f32 v147, v147, v6
    v_mul_f32 v148, v148, v6
    v_mul_f32 v149, v149, v6
    v_mul_f32 v150, v150, v6
    v_mul_f32 v151, v151, v6
    v_cvt_pk_bf16_f32 v144, v144, v145
    v_cvt_pk_bf16_f32 v145, v146, v147
    v_cvt_pk_bf16_f32 v146, v148, v149
    v_cvt_pk_bf16_f32 v147, v150, v151
    s_nop 0
    v_permlane16_swap_b32 v144, v146
    v_permlane16_swap_b32 v145, v147
    s_add_u32 s52, s51, 0
    buffer_store_dwordx4 v[144:147], v8, s[32:35], s52 offen sc0 sc1
    v_accvgpr_read_b32 v152, a8
    v_accvgpr_read_b32 v153, a9
    v_accvgpr_read_b32 v154, a10
    v_accvgpr_read_b32 v155, a11
    v_accvgpr_read_b32 v156, a12
    v_accvgpr_read_b32 v157, a13
    v_accvgpr_read_b32 v158, a14
    v_accvgpr_read_b32 v159, a15
    v_mul_f32 v152, v152, v6
    v_mul_f32 v153, v153, v6
    v_mul_f32 v154, v154, v6
    v_mul_f32 v155, v155, v6
    v_mul_f32 v156, v156, v6
    v_mul_f32 v157, v157, v6
    v_mul_f32 v158, v158, v6
    v_mul_f32 v159, v159, v6
    v_cvt_pk_bf16_f32 v152, v152, v153
    v_cvt_pk_bf16_f32 v153, v154, v155
    v_cvt_pk_bf16_f32 v154, v156, v157
    v_cvt_pk_bf16_f32 v155, v158, v159
    s_nop 0
    v_permlane16_swap_b32 v152, v154
    v_permlane16_swap_b32 v153, v155
    s_add_u32 s52, s51, 9216
    buffer_store_dwordx4 v[152:155], v8, s[32:35], s52 offen sc0 sc1
    v_accvgpr_read_b32 v160, a16
    v_accvgpr_read_b32 v161, a17
    v_accvgpr_read_b32 v162, a18
    v_accvgpr_read_b32 v163, a19
    v_accvgpr_read_b32 v164, a20
    v_accvgpr_read_b32 v165, a21
    v_accvgpr_read_b32 v166, a22
    v_accvgpr_read_b32 v167, a23
    v_mul_f32 v160, v160, v6
    v_mul_f32 v161, v161, v6
    v_mul_f32 v162, v162, v6
    v_mul_f32 v163, v163, v6
    v_mul_f32 v164, v164, v6
    v_mul_f32 v165, v165, v6
    v_mul_f32 v166, v166, v6
    v_mul_f32 v167, v167, v6
    v_cvt_pk_bf16_f32 v160, v160, v161
    v_cvt_pk_bf16_f32 v161, v162, v163
    v_cvt_pk_bf16_f32 v162, v164, v165
    v_cvt_pk_bf16_f32 v163, v166, v167
    s_nop 0
    v_permlane16_swap_b32 v160, v162
    v_permlane16_swap_b32 v161, v163
    s_add_u32 s52, s51, 18432
    buffer_store_dwordx4 v[160:163], v8, s[32:35], s52 offen sc0 sc1
    v_accvgpr_read_b32 v168, a24
    v_accvgpr_read_b32 v169, a25
    v_accvgpr_read_b32 v170, a26
    v_accvgpr_read_b32 v171, a27
    v_accvgpr_read_b32 v172, a28
    v_accvgpr_read_b32 v173, a29
    v_accvgpr_read_b32 v174, a30
    v_accvgpr_read_b32 v175, a31
    v_mul_f32 v168, v168, v6
    v_mul_f32 v169, v169, v6
    v_mul_f32 v170, v170, v6
    v_mul_f32 v171, v171, v6
    v_mul_f32 v172, v172, v6
    v_mul_f32 v173, v173, v6
    v_mul_f32 v174, v174, v6
    v_mul_f32 v175, v175, v6
    v_cvt_pk_bf16_f32 v168, v168, v169
    v_cvt_pk_bf16_f32 v169, v170, v171
    v_cvt_pk_bf16_f32 v170, v172, v173
    v_cvt_pk_bf16_f32 v171, v174, v175
    s_nop 0
    v_permlane16_swap_b32 v168, v170
    v_permlane16_swap_b32 v169, v171
    s_add_u32 s52, s51, 27648
    buffer_store_dwordx4 v[168:171], v8, s[32:35], s52 offen sc0 sc1
    v_rcp_f32 v6, v96
    s_lshl_b32 s51, s36, 12
    s_add_u32 s51, s51, 1024
    v_accvgpr_read_b32 v176, a32
    v_accvgpr_read_b32 v177, a33
    v_accvgpr_read_b32 v178, a34
    v_accvgpr_read_b32 v179, a35
    v_accvgpr_read_b32 v180, a36
    v_accvgpr_read_b32 v181, a37
    v_accvgpr_read_b32 v182, a38
    v_accvgpr_read_b32 v183, a39
    v_mul_f32 v176, v176, v6
    v_mul_f32 v177, v177, v6
    v_mul_f32 v178, v178, v6
    v_mul_f32 v179, v179, v6
    v_mul_f32 v180, v180, v6
    v_mul_f32 v181, v181, v6
    v_mul_f32 v182, v182, v6
    v_mul_f32 v183, v183, v6
    v_cvt_pk_bf16_f32 v176, v176, v177
    v_cvt_pk_bf16_f32 v177, v178, v179
    v_cvt_pk_bf16_f32 v178, v180, v181
    v_cvt_pk_bf16_f32 v179, v182, v183
    s_nop 0
    v_permlane16_swap_b32 v176, v178
    v_permlane16_swap_b32 v177, v179
    s_add_u32 s52, s51, 0
    buffer_store_dwordx4 v[176:179], v8, s[32:35], s52 offen sc0 sc1
    v_accvgpr_read_b32 v184, a40
    v_accvgpr_read_b32 v185, a41
    v_accvgpr_read_b32 v186, a42
    v_accvgpr_read_b32 v187, a43
    v_accvgpr_read_b32 v188, a44
    v_accvgpr_read_b32 v189, a45
    v_accvgpr_read_b32 v190, a46
    v_accvgpr_read_b32 v191, a47
    v_mul_f32 v184, v184, v6
    v_mul_f32 v185, v185, v6
    v_mul_f32 v186, v186, v6
    v_mul_f32 v187, v187, v6
    v_mul_f32 v188, v188, v6
    v_mul_f32 v189, v189, v6
    v_mul_f32 v190, v190, v6
    v_mul_f32 v191, v191, v6
    v_cvt_pk_bf16_f32 v184, v184, v185
    v_cvt_pk_bf16_f32 v185, v186, v187
    v_cvt_pk_bf16_f32 v186, v188, v189
    v_cvt_pk_bf16_f32 v187, v190, v191
    s_nop 0
    v_permlane16_swap_b32 v184, v186
    v_permlane16_swap_b32 v185, v187
    s_add_u32 s52, s51, 9216
    buffer_store_dwordx4 v[184:187], v8, s[32:35], s52 offen sc0 sc1
    v_accvgpr_read_b32 v192, a48
    v_accvgpr_read_b32 v193, a49
    v_accvgpr_read_b32 v194, a50
    v_accvgpr_read_b32 v195, a51
    v_accvgpr_read_b32 v196, a52
    v_accvgpr_read_b32 v197, a53
    v_accvgpr_read_b32 v198, a54
    v_accvgpr_read_b32 v199, a55
    v_mul_f32 v192, v192, v6
    v_mul_f32 v193, v193, v6
    v_mul_f32 v194, v194, v6
    v_mul_f32 v195, v195, v6
    v_mul_f32 v196, v196, v6
    v_mul_f32 v197, v197, v6
    v_mul_f32 v198, v198, v6
    v_mul_f32 v199, v199, v6
    v_cvt_pk_bf16_f32 v192, v192, v193
    v_cvt_pk_bf16_f32 v193, v194, v195
    v_cvt_pk_bf16_f32 v194, v196, v197
    v_cvt_pk_bf16_f32 v195, v198, v199
    s_nop 0
    v_permlane16_swap_b32 v192, v194
    v_permlane16_swap_b32 v193, v195
    s_add_u32 s52, s51, 18432
    buffer_store_dwordx4 v[192:195], v8, s[32:35], s52 offen sc0 sc1
    v_accvgpr_read_b32 v200, a56
    v_accvgpr_read_b32 v201, a57
    v_accvgpr_read_b32 v202, a58
    v_accvgpr_read_b32 v203, a59
    v_accvgpr_read_b32 v204, a60
    v_accvgpr_read_b32 v205, a61
    v_accvgpr_read_b32 v206, a62
    v_accvgpr_read_b32 v207, a63
    v_mul_f32 v200, v200, v6
    v_mul_f32 v201, v201, v6
    v_mul_f32 v202, v202, v6
    v_mul_f32 v203, v203, v6
    v_mul_f32 v204, v204, v6
    v_mul_f32 v205, v205, v6
    v_mul_f32 v206, v206, v6
    v_mul_f32 v207, v207, v6
    v_cvt_pk_bf16_f32 v200, v200, v201
    v_cvt_pk_bf16_f32 v201, v202, v203
    v_cvt_pk_bf16_f32 v202, v204, v205
    v_cvt_pk_bf16_f32 v203, v206, v207
    s_nop 0
    v_permlane16_swap_b32 v200, v202
    v_permlane16_swap_b32 v201, v203
    s_add_u32 s52, s51, 27648
    buffer_store_dwordx4 v[200:203], v8, s[32:35], s52 offen sc0 sc1
    v_rcp_f32 v6, v100
    s_lshl_b32 s51, s36, 12
    s_add_u32 s51, s51, 2048
    v_accvgpr_read_b32 v144, a64
    v_accvgpr_read_b32 v145, a65
    v_accvgpr_read_b32 v146, a66
    v_accvgpr_read_b32 v147, a67
    v_accvgpr_read_b32 v148, a68
    v_accvgpr_read_b32 v149, a69
    v_accvgpr_read_b32 v150, a70
    v_accvgpr_read_b32 v151, a71
    v_mul_f32 v144, v144, v6
    v_mul_f32 v145, v145, v6
    v_mul_f32 v146, v146, v6
    v_mul_f32 v147, v147, v6
    v_mul_f32 v148, v148, v6
    v_mul_f32 v149, v149, v6
    v_mul_f32 v150, v150, v6
    v_mul_f32 v151, v151, v6
    v_cvt_pk_bf16_f32 v144, v144, v145
    v_cvt_pk_bf16_f32 v145, v146, v147
    v_cvt_pk_bf16_f32 v146, v148, v149
    v_cvt_pk_bf16_f32 v147, v150, v151
    s_nop 0
    v_permlane16_swap_b32 v144, v146
    v_permlane16_swap_b32 v145, v147
    s_add_u32 s52, s51, 0
    buffer_store_dwordx4 v[144:147], v8, s[32:35], s52 offen sc0 sc1
    v_accvgpr_read_b32 v152, a72
    v_accvgpr_read_b32 v153, a73
    v_accvgpr_read_b32 v154, a74
    v_accvgpr_read_b32 v155, a75
    v_accvgpr_read_b32 v156, a76
    v_accvgpr_read_b32 v157, a77
    v_accvgpr_read_b32 v158, a78
    v_accvgpr_read_b32 v159, a79
    v_mul_f32 v152, v152, v6
    v_mul_f32 v153, v153, v6
    v_mul_f32 v154, v154, v6
    v_mul_f32 v155, v155, v6
    v_mul_f32 v156, v156, v6
    v_mul_f32 v157, v157, v6
    v_mul_f32 v158, v158, v6
    v_mul_f32 v159, v159, v6
    v_cvt_pk_bf16_f32 v152, v152, v153
    v_cvt_pk_bf16_f32 v153, v154, v155
    v_cvt_pk_bf16_f32 v154, v156, v157
    v_cvt_pk_bf16_f32 v155, v158, v159
    s_nop 0
    v_permlane16_swap_b32 v152, v154
    v_permlane16_swap_b32 v153, v155
    s_add_u32 s52, s51, 9216
    buffer_store_dwordx4 v[152:155], v8, s[32:35], s52 offen sc0 sc1
    v_accvgpr_read_b32 v160, a80
    v_accvgpr_read_b32 v161, a81
    v_accvgpr_read_b32 v162, a82
    v_accvgpr_read_b32 v163, a83
    v_accvgpr_read_b32 v164, a84
    v_accvgpr_read_b32 v165, a85
    v_accvgpr_read_b32 v166, a86
    v_accvgpr_read_b32 v167, a87
    v_mul_f32 v160, v160, v6
    v_mul_f32 v161, v161, v6
    v_mul_f32 v162, v162, v6
    v_mul_f32 v163, v163, v6
    v_mul_f32 v164, v164, v6
    v_mul_f32 v165, v165, v6
    v_mul_f32 v166, v166, v6
    v_mul_f32 v167, v167, v6
    v_cvt_pk_bf16_f32 v160, v160, v161
    v_cvt_pk_bf16_f32 v161, v162, v163
    v_cvt_pk_bf16_f32 v162, v164, v165
    v_cvt_pk_bf16_f32 v163, v166, v167
    s_nop 0
    v_permlane16_swap_b32 v160, v162
    v_permlane16_swap_b32 v161, v163
    s_add_u32 s52, s51, 18432
    buffer_store_dwordx4 v[160:163], v8, s[32:35], s52 offen sc0 sc1
    v_accvgpr_read_b32 v168, a88
    v_accvgpr_read_b32 v169, a89
    v_accvgpr_read_b32 v170, a90
    v_accvgpr_read_b32 v171, a91
    v_accvgpr_read_b32 v172, a92
    v_accvgpr_read_b32 v173, a93
    v_accvgpr_read_b32 v174, a94
    v_accvgpr_read_b32 v175, a95
    v_mul_f32 v168, v168, v6
    v_mul_f32 v169, v169, v6
    v_mul_f32 v170, v170, v6
    v_mul_f32 v171, v171, v6
    v_mul_f32 v172, v172, v6
    v_mul_f32 v173, v173, v6
    v_mul_f32 v174, v174, v6
    v_mul_f32 v175, v175, v6
    v_cvt_pk_bf16_f32 v168, v168, v169
    v_cvt_pk_bf16_f32 v169, v170, v171
    v_cvt_pk_bf16_f32 v170, v172, v173
    v_cvt_pk_bf16_f32 v171, v174, v175
    s_nop 0
    v_permlane16_swap_b32 v168, v170
    v_permlane16_swap_b32 v169, v171
    s_add_u32 s52, s51, 27648
    buffer_store_dwordx4 v[168:171], v8, s[32:35], s52 offen sc0 sc1
    v_rcp_f32 v6, v104
    s_lshl_b32 s51, s36, 12
    s_add_u32 s51, s51, 3072
    v_accvgpr_read_b32 v176, a96
    v_accvgpr_read_b32 v177, a97
    v_accvgpr_read_b32 v178, a98
    v_accvgpr_read_b32 v179, a99
    v_accvgpr_read_b32 v180, a100
    v_accvgpr_read_b32 v181, a101
    v_accvgpr_read_b32 v182, a102
    v_accvgpr_read_b32 v183, a103
    v_mul_f32 v176, v176, v6
    v_mul_f32 v177, v177, v6
    v_mul_f32 v178, v178, v6
    v_mul_f32 v179, v179, v6
    v_mul_f32 v180, v180, v6
    v_mul_f32 v181, v181, v6
    v_mul_f32 v182, v182, v6
    v_mul_f32 v183, v183, v6
    v_cvt_pk_bf16_f32 v176, v176, v177
    v_cvt_pk_bf16_f32 v177, v178, v179
    v_cvt_pk_bf16_f32 v178, v180, v181
    v_cvt_pk_bf16_f32 v179, v182, v183
    s_nop 0
    v_permlane16_swap_b32 v176, v178
    v_permlane16_swap_b32 v177, v179
    s_add_u32 s52, s51, 0
    buffer_store_dwordx4 v[176:179], v8, s[32:35], s52 offen sc0 sc1
    v_accvgpr_read_b32 v184, a104
    v_accvgpr_read_b32 v185, a105
    v_accvgpr_read_b32 v186, a106
    v_accvgpr_read_b32 v187, a107
    v_accvgpr_read_b32 v188, a108
    v_accvgpr_read_b32 v189, a109
    v_accvgpr_read_b32 v190, a110
    v_accvgpr_read_b32 v191, a111
    v_mul_f32 v184, v184, v6
    v_mul_f32 v185, v185, v6
    v_mul_f32 v186, v186, v6
    v_mul_f32 v187, v187, v6
    v_mul_f32 v188, v188, v6
    v_mul_f32 v189, v189, v6
    v_mul_f32 v190, v190, v6
    v_mul_f32 v191, v191, v6
    v_cvt_pk_bf16_f32 v184, v184, v185
    v_cvt_pk_bf16_f32 v185, v186, v187
    v_cvt_pk_bf16_f32 v186, v188, v189
    v_cvt_pk_bf16_f32 v187, v190, v191
    s_nop 0
    v_permlane16_swap_b32 v184, v186
    v_permlane16_swap_b32 v185, v187
    s_add_u32 s52, s51, 9216
    buffer_store_dwordx4 v[184:187], v8, s[32:35], s52 offen sc0 sc1
    v_accvgpr_read_b32 v192, a112
    v_accvgpr_read_b32 v193, a113
    v_accvgpr_read_b32 v194, a114
    v_accvgpr_read_b32 v195, a115
    v_accvgpr_read_b32 v196, a116
    v_accvgpr_read_b32 v197, a117
    v_accvgpr_read_b32 v198, a118
    v_accvgpr_read_b32 v199, a119
    v_mul_f32 v192, v192, v6
    v_mul_f32 v193, v193, v6
    v_mul_f32 v194, v194, v6
    v_mul_f32 v195, v195, v6
    v_mul_f32 v196, v196, v6
    v_mul_f32 v197, v197, v6
    v_mul_f32 v198, v198, v6
    v_mul_f32 v199, v199, v6
    v_cvt_pk_bf16_f32 v192, v192, v193
    v_cvt_pk_bf16_f32 v193, v194, v195
    v_cvt_pk_bf16_f32 v194, v196, v197
    v_cvt_pk_bf16_f32 v195, v198, v199
    s_nop 0
    v_permlane16_swap_b32 v192, v194
    v_permlane16_swap_b32 v193, v195
    s_add_u32 s52, s51, 18432
    buffer_store_dwordx4 v[192:195], v8, s[32:35], s52 offen sc0 sc1
    v_accvgpr_read_b32 v200, a120
    v_accvgpr_read_b32 v201, a121
    v_accvgpr_read_b32 v202, a122
    v_accvgpr_read_b32 v203, a123
    v_accvgpr_read_b32 v204, a124
    v_accvgpr_read_b32 v205, a125
    v_accvgpr_read_b32 v206, a126
    v_accvgpr_read_b32 v207, a127
    v_mul_f32 v200, v200, v6
    v_mul_f32 v201, v201, v6
    v_mul_f32 v202, v202, v6
    v_mul_f32 v203, v203, v6
    v_mul_f32 v204, v204, v6
    v_mul_f32 v205, v205, v6
    v_mul_f32 v206, v206, v6
    v_mul_f32 v207, v207, v6
    v_cvt_pk_bf16_f32 v200, v200, v201
    v_cvt_pk_bf16_f32 v201, v202, v203
    v_cvt_pk_bf16_f32 v202, v204, v205
    v_cvt_pk_bf16_f32 v203, v206, v207
    s_nop 0
    v_permlane16_swap_b32 v200, v202
    v_permlane16_swap_b32 v201, v203
    s_add_u32 s52, s51, 27648
    buffer_store_dwordx4 v[200:203], v8, s[32:35], s52 offen sc0 sc1
    s_waitcnt lgkmcnt(0)
    s_barrier
    s_lshl_b32 s51, s36, 12
    v_add_u32 v5, s51, v4
    ds_read_b128 v[64:67], v5 offset:4096
    ds_read_b128 v[68:71], v5 offset:12288
    ds_read_b128 v[72:75], v5 offset:5120
    ds_read_b128 v[76:79], v5 offset:13312
    ds_read_b128 v[80:83], v5 offset:6144
    ds_read_b128 v[84:87], v5 offset:14336
    ds_read_b128 v[88:91], v5 offset:7168
    ds_read_b128 v[92:95], v5 offset:15360
    s_mul_i32 s51, s36, 18432
    s_add_u32 s51, s51, 8192
    s_waitcnt lgkmcnt(6)
    v_add_f32 v64, v64, v68
    v_add_f32 v65, v65, v69
    v_add_f32 v66, v66, v70
    v_add_f32 v67, v67, v71
    s_waitcnt lgkmcnt(4)
    v_add_f32 v72, v72, v76
    v_add_f32 v73, v73, v77
    v_add_f32 v74, v74, v78
    v_add_f32 v75, v75, v79
    s_waitcnt lgkmcnt(2)
    v_add_f32 v80, v80, v84
    v_add_f32 v81, v81, v85
    v_add_f32 v82, v82, v86
    v_add_f32 v83, v83, v87
    s_waitcnt lgkmcnt(0)
    v_add_f32 v88, v88, v92
    v_add_f32 v89, v89, v93
    v_add_f32 v90, v90, v94
    v_add_f32 v91, v91, v95
    v_cvt_pk_bf16_f32 v144, v64, v65
    v_cvt_pk_bf16_f32 v145, v66, v67
    v_cvt_pk_bf16_f32 v146, v72, v73
    v_cvt_pk_bf16_f32 v147, v74, v75
    s_nop 0
    v_permlane16_swap_b32 v144, v146
    v_permlane16_swap_b32 v145, v147
    s_add_u32 s52, s51, 0
    buffer_store_dwordx4 v[144:147], v8, s[32:35], s52 offen sc0 sc1
    v_cvt_pk_bf16_f32 v148, v80, v81
    v_cvt_pk_bf16_f32 v149, v82, v83
    v_cvt_pk_bf16_f32 v150, v88, v89
    v_cvt_pk_bf16_f32 v151, v90, v91
    s_nop 0
    v_permlane16_swap_b32 v148, v150
    v_permlane16_swap_b32 v149, v151
    s_add_u32 s52, s51, 9216
    buffer_store_dwordx4 v[148:151], v8, s[32:35], s52 offen sc0 sc1
attn_kernel_done:
    s_endpgm
attn_kernel_n1:
    s_nop 7
    v_mov_b32 v126, v120
    s_nop 1
    v_permlane16_swap_b32 v120, v126
    v_max_f32 v120, v120, v126
    v_mov_b32 v126, v120
    s_nop 1
    v_permlane32_swap_b32 v120, v126
    v_max_f32 v120, v120, v126
    v_cmp_eq_f32 vcc, 0, v92
    v_max_f32 v126, 0, v120
    s_nop 0
    v_cndmask_b32 v120, v126, v120, vcc
    v_sub_f32 v8, v8, v120
    v_sub_f32 v9, v9, v120
    v_sub_f32 v10, v10, v120
    v_sub_f32 v11, v11, v120
    v_sub_f32 v12, v12, v120
    v_sub_f32 v13, v13, v120
    v_sub_f32 v14, v14, v120
    v_sub_f32 v15, v15, v120
    v_sub_f32 v72, v72, v120
    v_sub_f32 v73, v73, v120
    v_sub_f32 v74, v74, v120
    v_sub_f32 v75, v75, v120
    v_exp_f32 v126, -v126
    s_nop 0
    v_mul_f32 v92, v92, v126
    v_mul_f32 v93, v93, v126
    v_mul_f32 v94, v94, v126
    v_mul_f32 v95, v95, v126
    v_accvgpr_read_b32 v127, a0
    v_mul_f32 v127, v127, v126
    v_accvgpr_write_b32 a0, v127
    v_accvgpr_read_b32 v127, a1
    v_mul_f32 v127, v127, v126
    v_accvgpr_write_b32 a1, v127
    v_accvgpr_read_b32 v127, a2
    v_mul_f32 v127, v127, v126
    v_accvgpr_write_b32 a2, v127
    v_accvgpr_read_b32 v127, a3
    v_mul_f32 v127, v127, v126
    v_accvgpr_write_b32 a3, v127
    v_accvgpr_read_b32 v127, a4
    v_mul_f32 v127, v127, v126
    v_accvgpr_write_b32 a4, v127
    v_accvgpr_read_b32 v127, a5
    v_mul_f32 v127, v127, v126
    v_accvgpr_write_b32 a5, v127
    v_accvgpr_read_b32 v127, a6
    v_mul_f32 v127, v127, v126
    v_accvgpr_write_b32 a6, v127
    v_accvgpr_read_b32 v127, a7
    v_mul_f32 v127, v127, v126
    v_accvgpr_write_b32 a7, v127
    v_accvgpr_read_b32 v127, a8
    v_mul_f32 v127, v127, v126
    v_accvgpr_write_b32 a8, v127
    v_accvgpr_read_b32 v127, a9
    v_mul_f32 v127, v127, v126
    v_accvgpr_write_b32 a9, v127
    v_accvgpr_read_b32 v127, a10
    v_mul_f32 v127, v127, v126
    v_accvgpr_write_b32 a10, v127
    v_accvgpr_read_b32 v127, a11
    v_mul_f32 v127, v127, v126
    v_accvgpr_write_b32 a11, v127
    v_accvgpr_read_b32 v127, a12
    v_mul_f32 v127, v127, v126
    v_accvgpr_write_b32 a12, v127
    v_accvgpr_read_b32 v127, a13
    v_mul_f32 v127, v127, v126
    v_accvgpr_write_b32 a13, v127
    v_accvgpr_read_b32 v127, a14
    v_mul_f32 v127, v127, v126
    v_accvgpr_write_b32 a14, v127
    v_accvgpr_read_b32 v127, a15
    v_mul_f32 v127, v127, v126
    v_accvgpr_write_b32 a15, v127
    v_accvgpr_read_b32 v127, a16
    v_mul_f32 v127, v127, v126
    v_accvgpr_write_b32 a16, v127
    v_accvgpr_read_b32 v127, a17
    v_mul_f32 v127, v127, v126
    v_accvgpr_write_b32 a17, v127
    v_accvgpr_read_b32 v127, a18
    v_mul_f32 v127, v127, v126
    v_accvgpr_write_b32 a18, v127
    v_accvgpr_read_b32 v127, a19
    v_mul_f32 v127, v127, v126
    v_accvgpr_write_b32 a19, v127
    v_accvgpr_read_b32 v127, a20
    v_mul_f32 v127, v127, v126
    v_accvgpr_write_b32 a20, v127
    v_accvgpr_read_b32 v127, a21
    v_mul_f32 v127, v127, v126
    v_accvgpr_write_b32 a21, v127
    v_accvgpr_read_b32 v127, a22
    v_mul_f32 v127, v127, v126
    v_accvgpr_write_b32 a22, v127
    v_accvgpr_read_b32 v127, a23
    v_mul_f32 v127, v127, v126
    v_accvgpr_write_b32 a23, v127
    v_accvgpr_read_b32 v127, a24
    v_mul_f32 v127, v127, v126
    v_accvgpr_write_b32 a24, v127
    v_accvgpr_read_b32 v127, a25
    v_mul_f32 v127, v127, v126
    v_accvgpr_write_b32 a25, v127
    v_accvgpr_read_b32 v127, a26
    v_mul_f32 v127, v127, v126
    v_accvgpr_write_b32 a26, v127
    v_accvgpr_read_b32 v127, a27
    v_mul_f32 v127, v127, v126
    v_accvgpr_write_b32 a27, v127
    v_accvgpr_read_b32 v127, a28
    v_mul_f32 v127, v127, v126
    v_accvgpr_write_b32 a28, v127
    v_accvgpr_read_b32 v127, a29
    v_mul_f32 v127, v127, v126
    v_accvgpr_write_b32 a29, v127
    v_accvgpr_read_b32 v127, a30
    v_mul_f32 v127, v127, v126
    v_accvgpr_write_b32 a30, v127
    v_accvgpr_read_b32 v127, a31
    v_mul_f32 v127, v127, v126
    v_accvgpr_write_b32 a31, v127
    v_mov_b32 v126, v121
    s_nop 1
    v_permlane16_swap_b32 v121, v126
    v_max_f32 v121, v121, v126
    v_mov_b32 v126, v121
    s_nop 1
    v_permlane32_swap_b32 v121, v126
    v_max_f32 v121, v121, v126
    v_cmp_eq_f32 vcc, 0, v96
    v_max_f32 v126, 0, v121
    s_nop 0
    v_cndmask_b32 v121, v126, v121, vcc
    v_sub_f32 v24, v24, v121
    v_sub_f32 v25, v25, v121
    v_sub_f32 v26, v26, v121
    v_sub_f32 v27, v27, v121
    v_sub_f32 v28, v28, v121
    v_sub_f32 v29, v29, v121
    v_sub_f32 v30, v30, v121
    v_sub_f32 v31, v31, v121
    v_sub_f32 v76, v76, v121
    v_sub_f32 v77, v77, v121
    v_sub_f32 v78, v78, v121
    v_sub_f32 v79, v79, v121
    v_exp_f32 v126, -v126
    s_nop 0
    v_mul_f32 v96, v96, v126
    v_mul_f32 v97, v97, v126
    v_mul_f32 v98, v98, v126
    v_mul_f32 v99, v99, v126
    v_accvgpr_read_b32 v127, a32
    v_mul_f32 v127, v127, v126
    v_accvgpr_write_b32 a32, v127
    v_accvgpr_read_b32 v127, a33
    v_mul_f32 v127, v127, v126
    v_accvgpr_write_b32 a33, v127
    v_accvgpr_read_b32 v127, a34
    v_mul_f32 v127, v127, v126
    v_accvgpr_write_b32 a34, v127
    v_accvgpr_read_b32 v127, a35
    v_mul_f32 v127, v127, v126
    v_accvgpr_write_b32 a35, v127
    v_accvgpr_read_b32 v127, a36
    v_mul_f32 v127, v127, v126
    v_accvgpr_write_b32 a36, v127
    v_accvgpr_read_b32 v127, a37
    v_mul_f32 v127, v127, v126
    v_accvgpr_write_b32 a37, v127
    v_accvgpr_read_b32 v127, a38
    v_mul_f32 v127, v127, v126
    v_accvgpr_write_b32 a38, v127
    v_accvgpr_read_b32 v127, a39
    v_mul_f32 v127, v127, v126
    v_accvgpr_write_b32 a39, v127
    v_accvgpr_read_b32 v127, a40
    v_mul_f32 v127, v127, v126
    v_accvgpr_write_b32 a40, v127
    v_accvgpr_read_b32 v127, a41
    v_mul_f32 v127, v127, v126
    v_accvgpr_write_b32 a41, v127
    v_accvgpr_read_b32 v127, a42
    v_mul_f32 v127, v127, v126
    v_accvgpr_write_b32 a42, v127
    v_accvgpr_read_b32 v127, a43
    v_mul_f32 v127, v127, v126
    v_accvgpr_write_b32 a43, v127
    v_accvgpr_read_b32 v127, a44
    v_mul_f32 v127, v127, v126
    v_accvgpr_write_b32 a44, v127
    v_accvgpr_read_b32 v127, a45
    v_mul_f32 v127, v127, v126
    v_accvgpr_write_b32 a45, v127
    v_accvgpr_read_b32 v127, a46
    v_mul_f32 v127, v127, v126
    v_accvgpr_write_b32 a46, v127
    v_accvgpr_read_b32 v127, a47
    v_mul_f32 v127, v127, v126
    v_accvgpr_write_b32 a47, v127
    v_accvgpr_read_b32 v127, a48
    v_mul_f32 v127, v127, v126
    v_accvgpr_write_b32 a48, v127
    v_accvgpr_read_b32 v127, a49
    v_mul_f32 v127, v127, v126
    v_accvgpr_write_b32 a49, v127
    v_accvgpr_read_b32 v127, a50
    v_mul_f32 v127, v127, v126
    v_accvgpr_write_b32 a50, v127
    v_accvgpr_read_b32 v127, a51
    v_mul_f32 v127, v127, v126
    v_accvgpr_write_b32 a51, v127
    v_accvgpr_read_b32 v127, a52
    v_mul_f32 v127, v127, v126
    v_accvgpr_write_b32 a52, v127
    v_accvgpr_read_b32 v127, a53
    v_mul_f32 v127, v127, v126
    v_accvgpr_write_b32 a53, v127
    v_accvgpr_read_b32 v127, a54
    v_mul_f32 v127, v127, v126
    v_accvgpr_write_b32 a54, v127
    v_accvgpr_read_b32 v127, a55
    v_mul_f32 v127, v127, v126
    v_accvgpr_write_b32 a55, v127
    v_accvgpr_read_b32 v127, a56
    v_mul_f32 v127, v127, v126
    v_accvgpr_write_b32 a56, v127
    v_accvgpr_read_b32 v127, a57
    v_mul_f32 v127, v127, v126
    v_accvgpr_write_b32 a57, v127
    v_accvgpr_read_b32 v127, a58
    v_mul_f32 v127, v127, v126
    v_accvgpr_write_b32 a58, v127
    v_accvgpr_read_b32 v127, a59
    v_mul_f32 v127, v127, v126
    v_accvgpr_write_b32 a59, v127
    v_accvgpr_read_b32 v127, a60
    v_mul_f32 v127, v127, v126
    v_accvgpr_write_b32 a60, v127
    v_accvgpr_read_b32 v127, a61
    v_mul_f32 v127, v127, v126
    v_accvgpr_write_b32 a61, v127
    v_accvgpr_read_b32 v127, a62
    v_mul_f32 v127, v127, v126
    v_accvgpr_write_b32 a62, v127
    v_accvgpr_read_b32 v127, a63
    v_mul_f32 v127, v127, v126
    v_accvgpr_write_b32 a63, v127
    v_mov_b32 v126, v122
    s_nop 1
    v_permlane16_swap_b32 v122, v126
    v_max_f32 v122, v122, v126
    v_mov_b32 v126, v122
    s_nop 1
    v_permlane32_swap_b32 v122, v126
    v_max_f32 v122, v122, v126
    v_cmp_eq_f32 vcc, 0, v100
    v_max_f32 v126, 0, v122
    s_nop 0
    v_cndmask_b32 v122, v126, v122, vcc
    v_sub_f32 v40, v40, v122
    v_sub_f32 v41, v41, v122
    v_sub_f32 v42, v42, v122
    v_sub_f32 v43, v43, v122
    v_sub_f32 v44, v44, v122
    v_sub_f32 v45, v45, v122
    v_sub_f32 v46, v46, v122
    v_sub_f32 v47, v47, v122
    v_sub_f32 v80, v80, v122
    v_sub_f32 v81, v81, v122
    v_sub_f32 v82, v82, v122
    v_sub_f32 v83, v83, v122
    v_exp_f32 v126, -v126
    s_nop 0
    v_mul_f32 v100, v100, v126
    v_mul_f32 v101, v101, v126
    v_mul_f32 v102, v102, v126
    v_mul_f32 v103, v103, v126
    v_accvgpr_read_b32 v127, a64
    v_mul_f32 v127, v127, v126
    v_accvgpr_write_b32 a64, v127
    v_accvgpr_read_b32 v127, a65
    v_mul_f32 v127, v127, v126
    v_accvgpr_write_b32 a65, v127
    v_accvgpr_read_b32 v127, a66
    v_mul_f32 v127, v127, v126
    v_accvgpr_write_b32 a66, v127
    v_accvgpr_read_b32 v127, a67
    v_mul_f32 v127, v127, v126
    v_accvgpr_write_b32 a67, v127
    v_accvgpr_read_b32 v127, a68
    v_mul_f32 v127, v127, v126
    v_accvgpr_write_b32 a68, v127
    v_accvgpr_read_b32 v127, a69
    v_mul_f32 v127, v127, v126
    v_accvgpr_write_b32 a69, v127
    v_accvgpr_read_b32 v127, a70
    v_mul_f32 v127, v127, v126
    v_accvgpr_write_b32 a70, v127
    v_accvgpr_read_b32 v127, a71
    v_mul_f32 v127, v127, v126
    v_accvgpr_write_b32 a71, v127
    v_accvgpr_read_b32 v127, a72
    v_mul_f32 v127, v127, v126
    v_accvgpr_write_b32 a72, v127
    v_accvgpr_read_b32 v127, a73
    v_mul_f32 v127, v127, v126
    v_accvgpr_write_b32 a73, v127
    v_accvgpr_read_b32 v127, a74
    v_mul_f32 v127, v127, v126
    v_accvgpr_write_b32 a74, v127
    v_accvgpr_read_b32 v127, a75
    v_mul_f32 v127, v127, v126
    v_accvgpr_write_b32 a75, v127
    v_accvgpr_read_b32 v127, a76
    v_mul_f32 v127, v127, v126
    v_accvgpr_write_b32 a76, v127
    v_accvgpr_read_b32 v127, a77
    v_mul_f32 v127, v127, v126
    v_accvgpr_write_b32 a77, v127
    v_accvgpr_read_b32 v127, a78
    v_mul_f32 v127, v127, v126
    v_accvgpr_write_b32 a78, v127
    v_accvgpr_read_b32 v127, a79
    v_mul_f32 v127, v127, v126
    v_accvgpr_write_b32 a79, v127
    v_accvgpr_read_b32 v127, a80
    v_mul_f32 v127, v127, v126
    v_accvgpr_write_b32 a80, v127
    v_accvgpr_read_b32 v127, a81
    v_mul_f32 v127, v127, v126
    v_accvgpr_write_b32 a81, v127
    v_accvgpr_read_b32 v127, a82
    v_mul_f32 v127, v127, v126
    v_accvgpr_write_b32 a82, v127
    v_accvgpr_read_b32 v127, a83
    v_mul_f32 v127, v127, v126
    v_accvgpr_write_b32 a83, v127
    v_accvgpr_read_b32 v127, a84
    v_mul_f32 v127, v127, v126
    v_accvgpr_write_b32 a84, v127
    v_accvgpr_read_b32 v127, a85
    v_mul_f32 v127, v127, v126
    v_accvgpr_write_b32 a85, v127
    v_accvgpr_read_b32 v127, a86
    v_mul_f32 v127, v127, v126
    v_accvgpr_write_b32 a86, v127
    v_accvgpr_read_b32 v127, a87
    v_mul_f32 v127, v127, v126
    v_accvgpr_write_b32 a87, v127
    v_accvgpr_read_b32 v127, a88
    v_mul_f32 v127, v127, v126
    v_accvgpr_write_b32 a88, v127
    v_accvgpr_read_b32 v127, a89
    v_mul_f32 v127, v127, v126
    v_accvgpr_write_b32 a89, v127
    v_accvgpr_read_b32 v127, a90
    v_mul_f32 v127, v127, v126
    v_accvgpr_write_b32 a90, v127
    v_accvgpr_read_b32 v127, a91
    v_mul_f32 v127, v127, v126
    v_accvgpr_write_b32 a91, v127
    v_accvgpr_read_b32 v127, a92
    v_mul_f32 v127, v127, v126
    v_accvgpr_write_b32 a92, v127
    v_accvgpr_read_b32 v127, a93
    v_mul_f32 v127, v127, v126
    v_accvgpr_write_b32 a93, v127
    v_accvgpr_read_b32 v127, a94
    v_mul_f32 v127, v127, v126
    v_accvgpr_write_b32 a94, v127
    v_accvgpr_read_b32 v127, a95
    v_mul_f32 v127, v127, v126
    v_accvgpr_write_b32 a95, v127
    v_mov_b32 v126, v123
    s_nop 1
    v_permlane16_swap_b32 v123, v126
    v_max_f32 v123, v123, v126
    v_mov_b32 v126, v123
    s_nop 1
    v_permlane32_swap_b32 v123, v126
    v_max_f32 v123, v123, v126
    v_cmp_eq_f32 vcc, 0, v104
    v_max_f32 v126, 0, v123
    s_nop 0
    v_cndmask_b32 v123, v126, v123, vcc
    v_sub_f32 v56, v56, v123
    v_sub_f32 v57, v57, v123
    v_sub_f32 v58, v58, v123
    v_sub_f32 v59, v59, v123
    v_sub_f32 v60, v60, v123
    v_sub_f32 v61, v61, v123
    v_sub_f32 v62, v62, v123
    v_sub_f32 v63, v63, v123
    v_sub_f32 v84, v84, v123
    v_sub_f32 v85, v85, v123
    v_sub_f32 v86, v86, v123
    v_sub_f32 v87, v87, v123
    v_exp_f32 v126, -v126
    s_nop 0
    v_mul_f32 v104, v104, v126
    v_mul_f32 v105, v105, v126
    v_mul_f32 v106, v106, v126
    v_mul_f32 v107, v107, v126
    v_accvgpr_read_b32 v127, a96
    v_mul_f32 v127, v127, v126
    v_accvgpr_write_b32 a96, v127
    v_accvgpr_read_b32 v127, a97
    v_mul_f32 v127, v127, v126
    v_accvgpr_write_b32 a97, v127
    v_accvgpr_read_b32 v127, a98
    v_mul_f32 v127, v127, v126
    v_accvgpr_write_b32 a98, v127
    v_accvgpr_read_b32 v127, a99
    v_mul_f32 v127, v127, v126
    v_accvgpr_write_b32 a99, v127
    v_accvgpr_read_b32 v127, a100
    v_mul_f32 v127, v127, v126
    v_accvgpr_write_b32 a100, v127
    v_accvgpr_read_b32 v127, a101
    v_mul_f32 v127, v127, v126
    v_accvgpr_write_b32 a101, v127
    v_accvgpr_read_b32 v127, a102
    v_mul_f32 v127, v127, v126
    v_accvgpr_write_b32 a102, v127
    v_accvgpr_read_b32 v127, a103
    v_mul_f32 v127, v127, v126
    v_accvgpr_write_b32 a103, v127
    v_accvgpr_read_b32 v127, a104
    v_mul_f32 v127, v127, v126
    v_accvgpr_write_b32 a104, v127
    v_accvgpr_read_b32 v127, a105
    v_mul_f32 v127, v127, v126
    v_accvgpr_write_b32 a105, v127
    v_accvgpr_read_b32 v127, a106
    v_mul_f32 v127, v127, v126
    v_accvgpr_write_b32 a106, v127
    v_accvgpr_read_b32 v127, a107
    v_mul_f32 v127, v127, v126
    v_accvgpr_write_b32 a107, v127
    v_accvgpr_read_b32 v127, a108
    v_mul_f32 v127, v127, v126
    v_accvgpr_write_b32 a108, v127
    v_accvgpr_read_b32 v127, a109
    v_mul_f32 v127, v127, v126
    v_accvgpr_write_b32 a109, v127
    v_accvgpr_read_b32 v127, a110
    v_mul_f32 v127, v127, v126
    v_accvgpr_write_b32 a110, v127
    v_accvgpr_read_b32 v127, a111
    v_mul_f32 v127, v127, v126
    v_accvgpr_write_b32 a111, v127
    v_accvgpr_read_b32 v127, a112
    v_mul_f32 v127, v127, v126
    v_accvgpr_write_b32 a112, v127
    v_accvgpr_read_b32 v127, a113
    v_mul_f32 v127, v127, v126
    v_accvgpr_write_b32 a113, v127
    v_accvgpr_read_b32 v127, a114
    v_mul_f32 v127, v127, v126
    v_accvgpr_write_b32 a114, v127
    v_accvgpr_read_b32 v127, a115
    v_mul_f32 v127, v127, v126
    v_accvgpr_write_b32 a115, v127
    v_accvgpr_read_b32 v127, a116
    v_mul_f32 v127, v127, v126
    v_accvgpr_write_b32 a116, v127
    v_accvgpr_read_b32 v127, a117
    v_mul_f32 v127, v127, v126
    v_accvgpr_write_b32 a117, v127
    v_accvgpr_read_b32 v127, a118
    v_mul_f32 v127, v127, v126
    v_accvgpr_write_b32 a118, v127
    v_accvgpr_read_b32 v127, a119
    v_mul_f32 v127, v127, v126
    v_accvgpr_write_b32 a119, v127
    v_accvgpr_read_b32 v127, a120
    v_mul_f32 v127, v127, v126
    v_accvgpr_write_b32 a120, v127
    v_accvgpr_read_b32 v127, a121
    v_mul_f32 v127, v127, v126
    v_accvgpr_write_b32 a121, v127
    v_accvgpr_read_b32 v127, a122
    v_mul_f32 v127, v127, v126
    v_accvgpr_write_b32 a122, v127
    v_accvgpr_read_b32 v127, a123
    v_mul_f32 v127, v127, v126
    v_accvgpr_write_b32 a123, v127
    v_accvgpr_read_b32 v127, a124
    v_mul_f32 v127, v127, v126
    v_accvgpr_write_b32 a124, v127
    v_accvgpr_read_b32 v127, a125
    v_mul_f32 v127, v127, v126
    v_accvgpr_write_b32 a125, v127
    v_accvgpr_read_b32 v127, a126
    v_mul_f32 v127, v127, v126
    v_accvgpr_write_b32 a126, v127
    v_accvgpr_read_b32 v127, a127
    v_mul_f32 v127, v127, v126
    v_accvgpr_write_b32 a127, v127
    s_nop 3
    s_branch attn_kernel_n2
attn_kernel_n3:
    s_nop 7
    v_mov_b32 v126, v120
    s_nop 1
    v_permlane16_swap_b32 v120, v126
    v_max_f32 v120, v120, v126
    v_mov_b32 v126, v120
    s_nop 1
    v_permlane32_swap_b32 v120, v126
    v_max_f32 v120, v120, v126
    v_cmp_eq_f32 vcc, 0, v92
    v_max_f32 v126, 0, v120
    s_nop 0
    v_cndmask_b32 v120, v126, v120, vcc
    v_sub_f32 v0, v0, v120
    v_sub_f32 v1, v1, v120
    v_sub_f32 v2, v2, v120
    v_sub_f32 v3, v3, v120
    v_sub_f32 v4, v4, v120
    v_sub_f32 v5, v5, v120
    v_sub_f32 v6, v6, v120
    v_sub_f32 v7, v7, v120
    v_sub_f32 v72, v72, v120
    v_sub_f32 v73, v73, v120
    v_sub_f32 v74, v74, v120
    v_sub_f32 v75, v75, v120
    v_exp_f32 v126, -v126
    s_nop 0
    v_mul_f32 v92, v92, v126
    v_mul_f32 v93, v93, v126
    v_mul_f32 v94, v94, v126
    v_mul_f32 v95, v95, v126
    v_accvgpr_read_b32 v127, a0
    v_mul_f32 v127, v127, v126
    v_accvgpr_write_b32 a0, v127
    v_accvgpr_read_b32 v127, a1
    v_mul_f32 v127, v127, v126
    v_accvgpr_write_b32 a1, v127
    v_accvgpr_read_b32 v127, a2
    v_mul_f32 v127, v127, v126
    v_accvgpr_write_b32 a2, v127
    v_accvgpr_read_b32 v127, a3
    v_mul_f32 v127, v127, v126
    v_accvgpr_write_b32 a3, v127
    v_accvgpr_read_b32 v127, a4
    v_mul_f32 v127, v127, v126
    v_accvgpr_write_b32 a4, v127
    v_accvgpr_read_b32 v127, a5
    v_mul_f32 v127, v127, v126
    v_accvgpr_write_b32 a5, v127
    v_accvgpr_read_b32 v127, a6
    v_mul_f32 v127, v127, v126
    v_accvgpr_write_b32 a6, v127
    v_accvgpr_read_b32 v127, a7
    v_mul_f32 v127, v127, v126
    v_accvgpr_write_b32 a7, v127
    v_accvgpr_read_b32 v127, a8
    v_mul_f32 v127, v127, v126
    v_accvgpr_write_b32 a8, v127
    v_accvgpr_read_b32 v127, a9
    v_mul_f32 v127, v127, v126
    v_accvgpr_write_b32 a9, v127
    v_accvgpr_read_b32 v127, a10
    v_mul_f32 v127, v127, v126
    v_accvgpr_write_b32 a10, v127
    v_accvgpr_read_b32 v127, a11
    v_mul_f32 v127, v127, v126
    v_accvgpr_write_b32 a11, v127
    v_accvgpr_read_b32 v127, a12
    v_mul_f32 v127, v127, v126
    v_accvgpr_write_b32 a12, v127
    v_accvgpr_read_b32 v127, a13
    v_mul_f32 v127, v127, v126
    v_accvgpr_write_b32 a13, v127
    v_accvgpr_read_b32 v127, a14
    v_mul_f32 v127, v127, v126
    v_accvgpr_write_b32 a14, v127
    v_accvgpr_read_b32 v127, a15
    v_mul_f32 v127, v127, v126
    v_accvgpr_write_b32 a15, v127
    v_accvgpr_read_b32 v127, a16
    v_mul_f32 v127, v127, v126
    v_accvgpr_write_b32 a16, v127
    v_accvgpr_read_b32 v127, a17
    v_mul_f32 v127, v127, v126
    v_accvgpr_write_b32 a17, v127
    v_accvgpr_read_b32 v127, a18
    v_mul_f32 v127, v127, v126
    v_accvgpr_write_b32 a18, v127
    v_accvgpr_read_b32 v127, a19
    v_mul_f32 v127, v127, v126
    v_accvgpr_write_b32 a19, v127
    v_accvgpr_read_b32 v127, a20
    v_mul_f32 v127, v127, v126
    v_accvgpr_write_b32 a20, v127
    v_accvgpr_read_b32 v127, a21
    v_mul_f32 v127, v127, v126
    v_accvgpr_write_b32 a21, v127
    v_accvgpr_read_b32 v127, a22
    v_mul_f32 v127, v127, v126
    v_accvgpr_write_b32 a22, v127
    v_accvgpr_read_b32 v127, a23
    v_mul_f32 v127, v127, v126
    v_accvgpr_write_b32 a23, v127
    v_accvgpr_read_b32 v127, a24
    v_mul_f32 v127, v127, v126
    v_accvgpr_write_b32 a24, v127
    v_accvgpr_read_b32 v127, a25
    v_mul_f32 v127, v127, v126
    v_accvgpr_write_b32 a25, v127
    v_accvgpr_read_b32 v127, a26
    v_mul_f32 v127, v127, v126
    v_accvgpr_write_b32 a26, v127
    v_accvgpr_read_b32 v127, a27
    v_mul_f32 v127, v127, v126
    v_accvgpr_write_b32 a27, v127
    v_accvgpr_read_b32 v127, a28
    v_mul_f32 v127, v127, v126
    v_accvgpr_write_b32 a28, v127
    v_accvgpr_read_b32 v127, a29
    v_mul_f32 v127, v127, v126
    v_accvgpr_write_b32 a29, v127
    v_accvgpr_read_b32 v127, a30
    v_mul_f32 v127, v127, v126
    v_accvgpr_write_b32 a30, v127
    v_accvgpr_read_b32 v127, a31
    v_mul_f32 v127, v127, v126
    v_accvgpr_write_b32 a31, v127
    v_mov_b32 v126, v121
    s_nop 1
    v_permlane16_swap_b32 v121, v126
    v_max_f32 v121, v121, v126
    v_mov_b32 v126, v121
    s_nop 1
    v_permlane32_swap_b32 v121, v126
    v_max_f32 v121, v121, v126
    v_cmp_eq_f32 vcc, 0, v96
    v_max_f32 v126, 0, v121
    s_nop 0
    v_cndmask_b32 v121, v126, v121, vcc
    v_sub_f32 v16, v16, v121
    v_sub_f32 v17, v17, v121
    v_sub_f32 v18, v18, v121
    v_sub_f32 v19, v19, v121
    v_sub_f32 v20, v20, v121
    v_sub_f32 v21, v21, v121
    v_sub_f32 v22, v22, v121
    v_sub_f32 v23, v23, v121
    v_sub_f32 v76, v76, v121
    v_sub_f32 v77, v77, v121
    v_sub_f32 v78, v78, v121
    v_sub_f32 v79, v79, v121
    v_exp_f32 v126, -v126
    s_nop 0
    v_mul_f32 v96, v96, v126
    v_mul_f32 v97, v97, v126
    v_mul_f32 v98, v98, v126
    v_mul_f32 v99, v99, v126
    v_accvgpr_read_b32 v127, a32
    v_mul_f32 v127, v127, v126
    v_accvgpr_write_b32 a32, v127
    v_accvgpr_read_b32 v127, a33
    v_mul_f32 v127, v127, v126
    v_accvgpr_write_b32 a33, v127
    v_accvgpr_read_b32 v127, a34
    v_mul_f32 v127, v127, v126
    v_accvgpr_write_b32 a34, v127
    v_accvgpr_read_b32 v127, a35
    v_mul_f32 v127, v127, v126
    v_accvgpr_write_b32 a35, v127
    v_accvgpr_read_b32 v127, a36
    v_mul_f32 v127, v127, v126
    v_accvgpr_write_b32 a36, v127
    v_accvgpr_read_b32 v127, a37
    v_mul_f32 v127, v127, v126
    v_accvgpr_write_b32 a37, v127
    v_accvgpr_read_b32 v127, a38
    v_mul_f32 v127, v127, v126
    v_accvgpr_write_b32 a38, v127
    v_accvgpr_read_b32 v127, a39
    v_mul_f32 v127, v127, v126
    v_accvgpr_write_b32 a39, v127
    v_accvgpr_read_b32 v127, a40
    v_mul_f32 v127, v127, v126
    v_accvgpr_write_b32 a40, v127
    v_accvgpr_read_b32 v127, a41
    v_mul_f32 v127, v127, v126
    v_accvgpr_write_b32 a41, v127
    v_accvgpr_read_b32 v127, a42
    v_mul_f32 v127, v127, v126
    v_accvgpr_write_b32 a42, v127
    v_accvgpr_read_b32 v127, a43
    v_mul_f32 v127, v127, v126
    v_accvgpr_write_b32 a43, v127
    v_accvgpr_read_b32 v127, a44
    v_mul_f32 v127, v127, v126
    v_accvgpr_write_b32 a44, v127
    v_accvgpr_read_b32 v127, a45
    v_mul_f32 v127, v127, v126
    v_accvgpr_write_b32 a45, v127
    v_accvgpr_read_b32 v127, a46
    v_mul_f32 v127, v127, v126
    v_accvgpr_write_b32 a46, v127
    v_accvgpr_read_b32 v127, a47
    v_mul_f32 v127, v127, v126
    v_accvgpr_write_b32 a47, v127
    v_accvgpr_read_b32 v127, a48
    v_mul_f32 v127, v127, v126
    v_accvgpr_write_b32 a48, v127
    v_accvgpr_read_b32 v127, a49
    v_mul_f32 v127, v127, v126
    v_accvgpr_write_b32 a49, v127
    v_accvgpr_read_b32 v127, a50
    v_mul_f32 v127, v127, v126
    v_accvgpr_write_b32 a50, v127
    v_accvgpr_read_b32 v127, a51
    v_mul_f32 v127, v127, v126
    v_accvgpr_write_b32 a51, v127
    v_accvgpr_read_b32 v127, a52
    v_mul_f32 v127, v127, v126
    v_accvgpr_write_b32 a52, v127
    v_accvgpr_read_b32 v127, a53
    v_mul_f32 v127, v127, v126
    v_accvgpr_write_b32 a53, v127
    v_accvgpr_read_b32 v127, a54
    v_mul_f32 v127, v127, v126
    v_accvgpr_write_b32 a54, v127
    v_accvgpr_read_b32 v127, a55
    v_mul_f32 v127, v127, v126
    v_accvgpr_write_b32 a55, v127
    v_accvgpr_read_b32 v127, a56
    v_mul_f32 v127, v127, v126
    v_accvgpr_write_b32 a56, v127
    v_accvgpr_read_b32 v127, a57
    v_mul_f32 v127, v127, v126
    v_accvgpr_write_b32 a57, v127
    v_accvgpr_read_b32 v127, a58
    v_mul_f32 v127, v127, v126
    v_accvgpr_write_b32 a58, v127
    v_accvgpr_read_b32 v127, a59
    v_mul_f32 v127, v127, v126
    v_accvgpr_write_b32 a59, v127
    v_accvgpr_read_b32 v127, a60
    v_mul_f32 v127, v127, v126
    v_accvgpr_write_b32 a60, v127
    v_accvgpr_read_b32 v127, a61
    v_mul_f32 v127, v127, v126
    v_accvgpr_write_b32 a61, v127
    v_accvgpr_read_b32 v127, a62
    v_mul_f32 v127, v127, v126
    v_accvgpr_write_b32 a62, v127
    v_accvgpr_read_b32 v127, a63
    v_mul_f32 v127, v127, v126
    v_accvgpr_write_b32 a63, v127
    v_mov_b32 v126, v122
    s_nop 1
    v_permlane16_swap_b32 v122, v126
    v_max_f32 v122, v122, v126
    v_mov_b32 v126, v122
    s_nop 1
    v_permlane32_swap_b32 v122, v126
    v_max_f32 v122, v122, v126
    v_cmp_eq_f32 vcc, 0, v100
    v_max_f32 v126, 0, v122
    s_nop 0
    v_cndmask_b32 v122, v126, v122, vcc
    v_sub_f32 v32, v32, v122
    v_sub_f32 v33, v33, v122
    v_sub_f32 v34, v34, v122
    v_sub_f32 v35, v35, v122
    v_sub_f32 v36, v36, v122
    v_sub_f32 v37, v37, v122
    v_sub_f32 v38, v38, v122
    v_sub_f32 v39, v39, v122
    v_sub_f32 v80, v80, v122
    v_sub_f32 v81, v81, v122
    v_sub_f32 v82, v82, v122
    v_sub_f32 v83, v83, v122
    v_exp_f32 v126, -v126
    s_nop 0
    v_mul_f32 v100, v100, v126
    v_mul_f32 v101, v101, v126
    v_mul_f32 v102, v102, v126
    v_mul_f32 v103, v103, v126
    v_accvgpr_read_b32 v127, a64
    v_mul_f32 v127, v127, v126
    v_accvgpr_write_b32 a64, v127
    v_accvgpr_read_b32 v127, a65
    v_mul_f32 v127, v127, v126
    v_accvgpr_write_b32 a65, v127
    v_accvgpr_read_b32 v127, a66
    v_mul_f32 v127, v127, v126
    v_accvgpr_write_b32 a66, v127
    v_accvgpr_read_b32 v127, a67
    v_mul_f32 v127, v127, v126
    v_accvgpr_write_b32 a67, v127
    v_accvgpr_read_b32 v127, a68
    v_mul_f32 v127, v127, v126
    v_accvgpr_write_b32 a68, v127
    v_accvgpr_read_b32 v127, a69
    v_mul_f32 v127, v127, v126
    v_accvgpr_write_b32 a69, v127
    v_accvgpr_read_b32 v127, a70
    v_mul_f32 v127, v127, v126
    v_accvgpr_write_b32 a70, v127
    v_accvgpr_read_b32 v127, a71
    v_mul_f32 v127, v127, v126
    v_accvgpr_write_b32 a71, v127
    v_accvgpr_read_b32 v127, a72
    v_mul_f32 v127, v127, v126
    v_accvgpr_write_b32 a72, v127
    v_accvgpr_read_b32 v127, a73
    v_mul_f32 v127, v127, v126
    v_accvgpr_write_b32 a73, v127
    v_accvgpr_read_b32 v127, a74
    v_mul_f32 v127, v127, v126
    v_accvgpr_write_b32 a74, v127
    v_accvgpr_read_b32 v127, a75
    v_mul_f32 v127, v127, v126
    v_accvgpr_write_b32 a75, v127
    v_accvgpr_read_b32 v127, a76
    v_mul_f32 v127, v127, v126
    v_accvgpr_write_b32 a76, v127
    v_accvgpr_read_b32 v127, a77
    v_mul_f32 v127, v127, v126
    v_accvgpr_write_b32 a77, v127
    v_accvgpr_read_b32 v127, a78
    v_mul_f32 v127, v127, v126
    v_accvgpr_write_b32 a78, v127
    v_accvgpr_read_b32 v127, a79
    v_mul_f32 v127, v127, v126
    v_accvgpr_write_b32 a79, v127
    v_accvgpr_read_b32 v127, a80
    v_mul_f32 v127, v127, v126
    v_accvgpr_write_b32 a80, v127
    v_accvgpr_read_b32 v127, a81
    v_mul_f32 v127, v127, v126
    v_accvgpr_write_b32 a81, v127
    v_accvgpr_read_b32 v127, a82
    v_mul_f32 v127, v127, v126
    v_accvgpr_write_b32 a82, v127
    v_accvgpr_read_b32 v127, a83
    v_mul_f32 v127, v127, v126
    v_accvgpr_write_b32 a83, v127
    v_accvgpr_read_b32 v127, a84
    v_mul_f32 v127, v127, v126
    v_accvgpr_write_b32 a84, v127
    v_accvgpr_read_b32 v127, a85
    v_mul_f32 v127, v127, v126
    v_accvgpr_write_b32 a85, v127
    v_accvgpr_read_b32 v127, a86
    v_mul_f32 v127, v127, v126
    v_accvgpr_write_b32 a86, v127
    v_accvgpr_read_b32 v127, a87
    v_mul_f32 v127, v127, v126
    v_accvgpr_write_b32 a87, v127
    v_accvgpr_read_b32 v127, a88
    v_mul_f32 v127, v127, v126
    v_accvgpr_write_b32 a88, v127
    v_accvgpr_read_b32 v127, a89
    v_mul_f32 v127, v127, v126
    v_accvgpr_write_b32 a89, v127
    v_accvgpr_read_b32 v127, a90
    v_mul_f32 v127, v127, v126
    v_accvgpr_write_b32 a90, v127
    v_accvgpr_read_b32 v127, a91
    v_mul_f32 v127, v127, v126
    v_accvgpr_write_b32 a91, v127
    v_accvgpr_read_b32 v127, a92
    v_mul_f32 v127, v127, v126
    v_accvgpr_write_b32 a92, v127
    v_accvgpr_read_b32 v127, a93
    v_mul_f32 v127, v127, v126
    v_accvgpr_write_b32 a93, v127
    v_accvgpr_read_b32 v127, a94
    v_mul_f32 v127, v127, v126
    v_accvgpr_write_b32 a94, v127
    v_accvgpr_read_b32 v127, a95
    v_mul_f32 v127, v127, v126
    v_accvgpr_write_b32 a95, v127
    v_mov_b32 v126, v123
    s_nop 1
    v_permlane16_swap_b32 v123, v126
    v_max_f32 v123, v123, v126
    v_mov_b32 v126, v123
    s_nop 1
    v_permlane32_swap_b32 v123, v126
    v_max_f32 v123, v123, v126
    v_cmp_eq_f32 vcc, 0, v104
    v_max_f32 v126, 0, v123
    s_nop 0
    v_cndmask_b32 v123, v126, v123, vcc
    v_sub_f32 v48, v48, v123
    v_sub_f32 v49, v49, v123
    v_sub_f32 v50, v50, v123
    v_sub_f32 v51, v51, v123
    v_sub_f32 v52, v52, v123
    v_sub_f32 v53, v53, v123
    v_sub_f32 v54, v54, v123
    v_sub_f32 v55, v55, v123
    v_sub_f32 v84, v84, v123
    v_sub_f32 v85, v85, v123
    v_sub_f32 v86, v86, v123
    v_sub_f32 v87, v87, v123
    v_exp_f32 v126, -v126
    s_nop 0
    v_mul_f32 v104, v104, v126
    v_mul_f32 v105, v105, v126
    v_mul_f32 v106, v106, v126
    v_mul_f32 v107, v107, v126
    v_accvgpr_read_b32 v127, a96
    v_mul_f32 v127, v127, v126
    v_accvgpr_write_b32 a96, v127
    v_accvgpr_read_b32 v127, a97
    v_mul_f32 v127, v127, v126
    v_accvgpr_write_b32 a97, v127
    v_accvgpr_read_b32 v127, a98
    v_mul_f32 v127, v127, v126
    v_accvgpr_write_b32 a98, v127
    v_accvgpr_read_b32 v127, a99
    v_mul_f32 v127, v127, v126
    v_accvgpr_write_b32 a99, v127
    v_accvgpr_read_b32 v127, a100
    v_mul_f32 v127, v127, v126
    v_accvgpr_write_b32 a100, v127
    v_accvgpr_read_b32 v127, a101
    v_mul_f32 v127, v127, v126
    v_accvgpr_write_b32 a101, v127
    v_accvgpr_read_b32 v127, a102
    v_mul_f32 v127, v127, v126
    v_accvgpr_write_b32 a102, v127
    v_accvgpr_read_b32 v127, a103
    v_mul_f32 v127, v127, v126
    v_accvgpr_write_b32 a103, v127
    v_accvgpr_read_b32 v127, a104
    v_mul_f32 v127, v127, v126
    v_accvgpr_write_b32 a104, v127
    v_accvgpr_read_b32 v127, a105
    v_mul_f32 v127, v127, v126
    v_accvgpr_write_b32 a105, v127
    v_accvgpr_read_b32 v127, a106
    v_mul_f32 v127, v127, v126
    v_accvgpr_write_b32 a106, v127
    v_accvgpr_read_b32 v127, a107
    v_mul_f32 v127, v127, v126
    v_accvgpr_write_b32 a107, v127
    v_accvgpr_read_b32 v127, a108
    v_mul_f32 v127, v127, v126
    v_accvgpr_write_b32 a108, v127
    v_accvgpr_read_b32 v127, a109
    v_mul_f32 v127, v127, v126
    v_accvgpr_write_b32 a109, v127
    v_accvgpr_read_b32 v127, a110
    v_mul_f32 v127, v127, v126
    v_accvgpr_write_b32 a110, v127
    v_accvgpr_read_b32 v127, a111
    v_mul_f32 v127, v127, v126
    v_accvgpr_write_b32 a111, v127
    v_accvgpr_read_b32 v127, a112
    v_mul_f32 v127, v127, v126
    v_accvgpr_write_b32 a112, v127
    v_accvgpr_read_b32 v127, a113
    v_mul_f32 v127, v127, v126
    v_accvgpr_write_b32 a113, v127
    v_accvgpr_read_b32 v127, a114
    v_mul_f32 v127, v127, v126
    v_accvgpr_write_b32 a114, v127
    v_accvgpr_read_b32 v127, a115
    v_mul_f32 v127, v127, v126
    v_accvgpr_write_b32 a115, v127
    v_accvgpr_read_b32 v127, a116
    v_mul_f32 v127, v127, v126
    v_accvgpr_write_b32 a116, v127
    v_accvgpr_read_b32 v127, a117
    v_mul_f32 v127, v127, v126
    v_accvgpr_write_b32 a117, v127
    v_accvgpr_read_b32 v127, a118
    v_mul_f32 v127, v127, v126
    v_accvgpr_write_b32 a118, v127
    v_accvgpr_read_b32 v127, a119
    v_mul_f32 v127, v127, v126
    v_accvgpr_write_b32 a119, v127
    v_accvgpr_read_b32 v127, a120
    v_mul_f32 v127, v127, v126
    v_accvgpr_write_b32 a120, v127
    v_accvgpr_read_b32 v127, a121
    v_mul_f32 v127, v127, v126
    v_accvgpr_write_b32 a121, v127
    v_accvgpr_read_b32 v127, a122
    v_mul_f32 v127, v127, v126
    v_accvgpr_write_b32 a122, v127
    v_accvgpr_read_b32 v127, a123
    v_mul_f32 v127, v127, v126
    v_accvgpr_write_b32 a123, v127
    v_accvgpr_read_b32 v127, a124
    v_mul_f32 v127, v127, v126
    v_accvgpr_write_b32 a124, v127
    v_accvgpr_read_b32 v127, a125
    v_mul_f32 v127, v127, v126
    v_accvgpr_write_b32 a125, v127
    v_accvgpr_read_b32 v127, a126
    v_mul_f32 v127, v127, v126
    v_accvgpr_write_b32 a126, v127
    v_accvgpr_read_b32 v127, a127
    v_mul_f32 v127, v127, v126
    v_accvgpr_write_b32 a127, v127
    v_mov_b32 v126, v124
    s_nop 1
    v_permlane16_swap_b32 v124, v126
    v_max_f32 v124, v124, v126
    v_mov_b32 v126, v124
    s_nop 1
    v_permlane32_swap_b32 v124, v126
    v_max_f32 v124, v124, v126
    v_cmp_eq_f32 vcc, 0, v108
    v_max_f32 v126, 0, v124
    s_nop 0
    v_cndmask_b32 v124, v126, v124, vcc
    v_sub_f32 v64, v64, v124
    v_sub_f32 v65, v65, v124
    v_sub_f32 v66, v66, v124
    v_sub_f32 v67, v67, v124
    v_sub_f32 v68, v68, v124
    v_sub_f32 v69, v69, v124
    v_sub_f32 v70, v70, v124
    v_sub_f32 v71, v71, v124
    v_sub_f32 v88, v88, v124
    v_sub_f32 v89, v89, v124
    v_sub_f32 v90, v90, v124
    v_sub_f32 v91, v91, v124
    v_exp_f32 v126, -v126
    s_nop 0
    v_mul_f32 v108, v108, v126
    v_mul_f32 v109, v109, v126
    v_mul_f32 v110, v110, v126
    v_mul_f32 v111, v111, v126
    v_accvgpr_read_b32 v127, a128
    v_mul_f32 v127, v127, v126
    v_accvgpr_write_b32 a128, v127
    v_accvgpr_read_b32 v127, a129
    v_mul_f32 v127, v127, v126
    v_accvgpr_write_b32 a129, v127
    v_accvgpr_read_b32 v127, a130
    v_mul_f32 v127, v127, v126
    v_accvgpr_write_b32 a130, v127
    v_accvgpr_read_b32 v127, a131
    v_mul_f32 v127, v127, v126
    v_accvgpr_write_b32 a131, v127
    v_accvgpr_read_b32 v127, a132
    v_mul_f32 v127, v127, v126
    v_accvgpr_write_b32 a132, v127
    v_accvgpr_read_b32 v127, a133
    v_mul_f32 v127, v127, v126
    v_accvgpr_write_b32 a133, v127
    v_accvgpr_read_b32 v127, a134
    v_mul_f32 v127, v127, v126
    v_accvgpr_write_b32 a134, v127
    v_accvgpr_read_b32 v127, a135
    v_mul_f32 v127, v127, v126
    v_accvgpr_write_b32 a135, v127
    v_accvgpr_read_b32 v127, a136
    v_mul_f32 v127, v127, v126
    v_accvgpr_write_b32 a136, v127
    v_accvgpr_read_b32 v127, a137
    v_mul_f32 v127, v127, v126
    v_accvgpr_write_b32 a137, v127
    v_accvgpr_read_b32 v127, a138
    v_mul_f32 v127, v127, v126
    v_accvgpr_write_b32 a138, v127
    v_accvgpr_read_b32 v127, a139
    v_mul_f32 v127, v127, v126
    v_accvgpr_write_b32 a139, v127
    v_accvgpr_read_b32 v127, a140
    v_mul_f32 v127, v127, v126
    v_accvgpr_write_b32 a140, v127
    v_accvgpr_read_b32 v127, a141
    v_mul_f32 v127, v127, v126
    v_accvgpr_write_b32 a141, v127
    v_accvgpr_read_b32 v127, a142
    v_mul_f32 v127, v127, v126
    v_accvgpr_write_b32 a142, v127
    v_accvgpr_read_b32 v127, a143
    v_mul_f32 v127, v127, v126
    v_accvgpr_write_b32 a143, v127
    v_accvgpr_read_b32 v127, a144
    v_mul_f32 v127, v127, v126
    v_accvgpr_write_b32 a144, v127
    v_accvgpr_read_b32 v127, a145
    v_mul_f32 v127, v127, v126
    v_accvgpr_write_b32 a145, v127
    v_accvgpr_read_b32 v127, a146
    v_mul_f32 v127, v127, v126
    v_accvgpr_write_b32 a146, v127
    v_accvgpr_read_b32 v127, a147
    v_mul_f32 v127, v127, v126
    v_accvgpr_write_b32 a147, v127
    v_accvgpr_read_b32 v127, a148
    v_mul_f32 v127, v127, v126
    v_accvgpr_write_b32 a148, v127
    v_accvgpr_read_b32 v127, a149
    v_mul_f32 v127, v127, v126
    v_accvgpr_write_b32 a149, v127
    v_accvgpr_read_b32 v127, a150
    v_mul_f32 v127, v127, v126
    v_accvgpr_write_b32 a150, v127
    v_accvgpr_read_b32 v127, a151
    v_mul_f32 v127, v127, v126
    v_accvgpr_write_b32 a151, v127
    v_accvgpr_read_b32 v127, a152
    v_mul_f32 v127, v127, v126
    v_accvgpr_write_b32 a152, v127
    v_accvgpr_read_b32 v127, a153
    v_mul_f32 v127, v127, v126
    v_accvgpr_write_b32 a153, v127
    v_accvgpr_read_b32 v127, a154
    v_mul_f32 v127, v127, v126
    v_accvgpr_write_b32 a154, v127
    v_accvgpr_read_b32 v127, a155
    v_mul_f32 v127, v127, v126
    v_accvgpr_write_b32 a155, v127
    v_accvgpr_read_b32 v127, a156
    v_mul_f32 v127, v127, v126
    v_accvgpr_write_b32 a156, v127
    v_accvgpr_read_b32 v127, a157
    v_mul_f32 v127, v127, v126
    v_accvgpr_write_b32 a157, v127
    v_accvgpr_read_b32 v127, a158
    v_mul_f32 v127, v127, v126
    v_accvgpr_write_b32 a158, v127
    v_accvgpr_read_b32 v127, a159
    v_mul_f32 v127, v127, v126
    v_accvgpr_write_b32 a159, v127
    s_nop 3
    s_branch attn_kernel_n4
attn_kernel_n6:
    s_nop 7
    v_mov_b32 v126, v120
    s_nop 1
    v_permlane16_swap_b32 v120, v126
    v_max_f32 v120, v120, v126
    v_mov_b32 v126, v120
    s_nop 1
    v_permlane32_swap_b32 v120, v126
    v_max_f32 v120, v120, v126
    v_cmp_eq_f32 vcc, 0, v92
    v_max_f32 v126, 0, v120
    s_nop 0
    v_cndmask_b32 v120, v126, v120, vcc
    v_sub_f32 v8, v8, v120
    v_sub_f32 v9, v9, v120
    v_sub_f32 v10, v10, v120
    v_sub_f32 v11, v11, v120
    v_sub_f32 v12, v12, v120
    v_sub_f32 v13, v13, v120
    v_sub_f32 v14, v14, v120
    v_sub_f32 v15, v15, v120
    v_sub_f32 v72, v72, v120
    v_sub_f32 v73, v73, v120
    v_sub_f32 v74, v74, v120
    v_sub_f32 v75, v75, v120
    v_exp_f32 v126, -v126
    s_nop 0
    v_mul_f32 v92, v92, v126
    v_mul_f32 v93, v93, v126
    v_mul_f32 v94, v94, v126
    v_mul_f32 v95, v95, v126
    v_accvgpr_read_b32 v127, a0
    v_mul_f32 v127, v127, v126
    v_accvgpr_write_b32 a0, v127
    v_accvgpr_read_b32 v127, a1
    v_mul_f32 v127, v127, v126
    v_accvgpr_write_b32 a1, v127
    v_accvgpr_read_b32 v127, a2
    v_mul_f32 v127, v127, v126
    v_accvgpr_write_b32 a2, v127
    v_accvgpr_read_b32 v127, a3
    v_mul_f32 v127, v127, v126
    v_accvgpr_write_b32 a3, v127
    v_accvgpr_read_b32 v127, a4
    v_mul_f32 v127, v127, v126
    v_accvgpr_write_b32 a4, v127
    v_accvgpr_read_b32 v127, a5
    v_mul_f32 v127, v127, v126
    v_accvgpr_write_b32 a5, v127
    v_accvgpr_read_b32 v127, a6
    v_mul_f32 v127, v127, v126
    v_accvgpr_write_b32 a6, v127
    v_accvgpr_read_b32 v127, a7
    v_mul_f32 v127, v127, v126
    v_accvgpr_write_b32 a7, v127
    v_accvgpr_read_b32 v127, a8
    v_mul_f32 v127, v127, v126
    v_accvgpr_write_b32 a8, v127
    v_accvgpr_read_b32 v127, a9
    v_mul_f32 v127, v127, v126
    v_accvgpr_write_b32 a9, v127
    v_accvgpr_read_b32 v127, a10
    v_mul_f32 v127, v127, v126
    v_accvgpr_write_b32 a10, v127
    v_accvgpr_read_b32 v127, a11
    v_mul_f32 v127, v127, v126
    v_accvgpr_write_b32 a11, v127
    v_accvgpr_read_b32 v127, a12
    v_mul_f32 v127, v127, v126
    v_accvgpr_write_b32 a12, v127
    v_accvgpr_read_b32 v127, a13
    v_mul_f32 v127, v127, v126
    v_accvgpr_write_b32 a13, v127
    v_accvgpr_read_b32 v127, a14
    v_mul_f32 v127, v127, v126
    v_accvgpr_write_b32 a14, v127
    v_accvgpr_read_b32 v127, a15
    v_mul_f32 v127, v127, v126
    v_accvgpr_write_b32 a15, v127
    v_accvgpr_read_b32 v127, a16
    v_mul_f32 v127, v127, v126
    v_accvgpr_write_b32 a16, v127
    v_accvgpr_read_b32 v127, a17
    v_mul_f32 v127, v127, v126
    v_accvgpr_write_b32 a17, v127
    v_accvgpr_read_b32 v127, a18
    v_mul_f32 v127, v127, v126
    v_accvgpr_write_b32 a18, v127
    v_accvgpr_read_b32 v127, a19
    v_mul_f32 v127, v127, v126
    v_accvgpr_write_b32 a19, v127
    v_accvgpr_read_b32 v127, a20
    v_mul_f32 v127, v127, v126
    v_accvgpr_write_b32 a20, v127
    v_accvgpr_read_b32 v127, a21
    v_mul_f32 v127, v127, v126
    v_accvgpr_write_b32 a21, v127
    v_accvgpr_read_b32 v127, a22
    v_mul_f32 v127, v127, v126
    v_accvgpr_write_b32 a22, v127
    v_accvgpr_read_b32 v127, a23
    v_mul_f32 v127, v127, v126
    v_accvgpr_write_b32 a23, v127
    v_accvgpr_read_b32 v127, a24
    v_mul_f32 v127, v127, v126
    v_accvgpr_write_b32 a24, v127
    v_accvgpr_read_b32 v127, a25
    v_mul_f32 v127, v127, v126
    v_accvgpr_write_b32 a25, v127
    v_accvgpr_read_b32 v127, a26
    v_mul_f32 v127, v127, v126
    v_accvgpr_write_b32 a26, v127
    v_accvgpr_read_b32 v127, a27
    v_mul_f32 v127, v127, v126
    v_accvgpr_write_b32 a27, v127
    v_accvgpr_read_b32 v127, a28
    v_mul_f32 v127, v127, v126
    v_accvgpr_write_b32 a28, v127
    v_accvgpr_read_b32 v127, a29
    v_mul_f32 v127, v127, v126
    v_accvgpr_write_b32 a29, v127
    v_accvgpr_read_b32 v127, a30
    v_mul_f32 v127, v127, v126
    v_accvgpr_write_b32 a30, v127
    v_accvgpr_read_b32 v127, a31
    v_mul_f32 v127, v127, v126
    v_accvgpr_write_b32 a31, v127
    v_mov_b32 v126, v121
    s_nop 1
    v_permlane16_swap_b32 v121, v126
    v_max_f32 v121, v121, v126
    v_mov_b32 v126, v121
    s_nop 1
    v_permlane32_swap_b32 v121, v126
    v_max_f32 v121, v121, v126
    v_cmp_eq_f32 vcc, 0, v96
    v_max_f32 v126, 0, v121
    s_nop 0
    v_cndmask_b32 v121, v126, v121, vcc
    v_sub_f32 v24, v24, v121
    v_sub_f32 v25, v25, v121
    v_sub_f32 v26, v26, v121
    v_sub_f32 v27, v27, v121
    v_sub_f32 v28, v28, v121
    v_sub_f32 v29, v29, v121
    v_sub_f32 v30, v30, v121
    v_sub_f32 v31, v31, v121
    v_sub_f32 v76, v76, v121
    v_sub_f32 v77, v77, v121
    v_sub_f32 v78, v78, v121
    v_sub_f32 v79, v79, v121
    v_exp_f32 v126, -v126
    s_nop 0
    v_mul_f32 v96, v96, v126
    v_mul_f32 v97, v97, v126
    v_mul_f32 v98, v98, v126
    v_mul_f32 v99, v99, v126
    v_accvgpr_read_b32 v127, a32
    v_mul_f32 v127, v127, v126
    v_accvgpr_write_b32 a32, v127
    v_accvgpr_read_b32 v127, a33
    v_mul_f32 v127, v127, v126
    v_accvgpr_write_b32 a33, v127
    v_accvgpr_read_b32 v127, a34
    v_mul_f32 v127, v127, v126
    v_accvgpr_write_b32 a34, v127
    v_accvgpr_read_b32 v127, a35
    v_mul_f32 v127, v127, v126
    v_accvgpr_write_b32 a35, v127
    v_accvgpr_read_b32 v127, a36
    v_mul_f32 v127, v127, v126
    v_accvgpr_write_b32 a36, v127
    v_accvgpr_read_b32 v127, a37
    v_mul_f32 v127, v127, v126
    v_accvgpr_write_b32 a37, v127
    v_accvgpr_read_b32 v127, a38
    v_mul_f32 v127, v127, v126
    v_accvgpr_write_b32 a38, v127
    v_accvgpr_read_b32 v127, a39
    v_mul_f32 v127, v127, v126
    v_accvgpr_write_b32 a39, v127
    v_accvgpr_read_b32 v127, a40
    v_mul_f32 v127, v127, v126
    v_accvgpr_write_b32 a40, v127
    v_accvgpr_read_b32 v127, a41
    v_mul_f32 v127, v127, v126
    v_accvgpr_write_b32 a41, v127
    v_accvgpr_read_b32 v127, a42
    v_mul_f32 v127, v127, v126
    v_accvgpr_write_b32 a42, v127
    v_accvgpr_read_b32 v127, a43
    v_mul_f32 v127, v127, v126
    v_accvgpr_write_b32 a43, v127
    v_accvgpr_read_b32 v127, a44
    v_mul_f32 v127, v127, v126
    v_accvgpr_write_b32 a44, v127
    v_accvgpr_read_b32 v127, a45
    v_mul_f32 v127, v127, v126
    v_accvgpr_write_b32 a45, v127
    v_accvgpr_read_b32 v127, a46
    v_mul_f32 v127, v127, v126
    v_accvgpr_write_b32 a46, v127
    v_accvgpr_read_b32 v127, a47
    v_mul_f32 v127, v127, v126
    v_accvgpr_write_b32 a47, v127
    v_accvgpr_read_b32 v127, a48
    v_mul_f32 v127, v127, v126
    v_accvgpr_write_b32 a48, v127
    v_accvgpr_read_b32 v127, a49
    v_mul_f32 v127, v127, v126
    v_accvgpr_write_b32 a49, v127
    v_accvgpr_read_b32 v127, a50
    v_mul_f32 v127, v127, v126
    v_accvgpr_write_b32 a50, v127
    v_accvgpr_read_b32 v127, a51
    v_mul_f32 v127, v127, v126
    v_accvgpr_write_b32 a51, v127
    v_accvgpr_read_b32 v127, a52
    v_mul_f32 v127, v127, v126
    v_accvgpr_write_b32 a52, v127
    v_accvgpr_read_b32 v127, a53
    v_mul_f32 v127, v127, v126
    v_accvgpr_write_b32 a53, v127
    v_accvgpr_read_b32 v127, a54
    v_mul_f32 v127, v127, v126
    v_accvgpr_write_b32 a54, v127
    v_accvgpr_read_b32 v127, a55
    v_mul_f32 v127, v127, v126
    v_accvgpr_write_b32 a55, v127
    v_accvgpr_read_b32 v127, a56
    v_mul_f32 v127, v127, v126
    v_accvgpr_write_b32 a56, v127
    v_accvgpr_read_b32 v127, a57
    v_mul_f32 v127, v127, v126
    v_accvgpr_write_b32 a57, v127
    v_accvgpr_read_b32 v127, a58
    v_mul_f32 v127, v127, v126
    v_accvgpr_write_b32 a58, v127
    v_accvgpr_read_b32 v127, a59
    v_mul_f32 v127, v127, v126
    v_accvgpr_write_b32 a59, v127
    v_accvgpr_read_b32 v127, a60
    v_mul_f32 v127, v127, v126
    v_accvgpr_write_b32 a60, v127
    v_accvgpr_read_b32 v127, a61
    v_mul_f32 v127, v127, v126
    v_accvgpr_write_b32 a61, v127
    v_accvgpr_read_b32 v127, a62
    v_mul_f32 v127, v127, v126
    v_accvgpr_write_b32 a62, v127
    v_accvgpr_read_b32 v127, a63
    v_mul_f32 v127, v127, v126
    v_accvgpr_write_b32 a63, v127
    v_mov_b32 v126, v122
    s_nop 1
    v_permlane16_swap_b32 v122, v126
    v_max_f32 v122, v122, v126
    v_mov_b32 v126, v122
    s_nop 1
    v_permlane32_swap_b32 v122, v126
    v_max_f32 v122, v122, v126
    v_cmp_eq_f32 vcc, 0, v100
    v_max_f32 v126, 0, v122
    s_nop 0
    v_cndmask_b32 v122, v126, v122, vcc
    v_sub_f32 v40, v40, v122
    v_sub_f32 v41, v41, v122
    v_sub_f32 v42, v42, v122
    v_sub_f32 v43, v43, v122
    v_sub_f32 v44, v44, v122
    v_sub_f32 v45, v45, v122
    v_sub_f32 v46, v46, v122
    v_sub_f32 v47, v47, v122
    v_sub_f32 v80, v80, v122
    v_sub_f32 v81, v81, v122
    v_sub_f32 v82, v82, v122
    v_sub_f32 v83, v83, v122
    v_exp_f32 v126, -v126
    s_nop 0
    v_mul_f32 v100, v100, v126
    v_mul_f32 v101, v101, v126
    v_mul_f32 v102, v102, v126
    v_mul_f32 v103, v103, v126
    v_accvgpr_read_b32 v127, a64
    v_mul_f32 v127, v127, v126
    v_accvgpr_write_b32 a64, v127
    v_accvgpr_read_b32 v127, a65
    v_mul_f32 v127, v127, v126
    v_accvgpr_write_b32 a65, v127
    v_accvgpr_read_b32 v127, a66
    v_mul_f32 v127, v127, v126
    v_accvgpr_write_b32 a66, v127
    v_accvgpr_read_b32 v127, a67
    v_mul_f32 v127, v127, v126
    v_accvgpr_write_b32 a67, v127
    v_accvgpr_read_b32 v127, a68
    v_mul_f32 v127, v127, v126
    v_accvgpr_write_b32 a68, v127
    v_accvgpr_read_b32 v127, a69
    v_mul_f32 v127, v127, v126
    v_accvgpr_write_b32 a69, v127
    v_accvgpr_read_b32 v127, a70
    v_mul_f32 v127, v127, v126
    v_accvgpr_write_b32 a70, v127
    v_accvgpr_read_b32 v127, a71
    v_mul_f32 v127, v127, v126
    v_accvgpr_write_b32 a71, v127
    v_accvgpr_read_b32 v127, a72
    v_mul_f32 v127, v127, v126
    v_accvgpr_write_b32 a72, v127
    v_accvgpr_read_b32 v127, a73
    v_mul_f32 v127, v127, v126
    v_accvgpr_write_b32 a73, v127
    v_accvgpr_read_b32 v127, a74
    v_mul_f32 v127, v127, v126
    v_accvgpr_write_b32 a74, v127
    v_accvgpr_read_b32 v127, a75
    v_mul_f32 v127, v127, v126
    v_accvgpr_write_b32 a75, v127
    v_accvgpr_read_b32 v127, a76
    v_mul_f32 v127, v127, v126
    v_accvgpr_write_b32 a76, v127
    v_accvgpr_read_b32 v127, a77
    v_mul_f32 v127, v127, v126
    v_accvgpr_write_b32 a77, v127
    v_accvgpr_read_b32 v127, a78
    v_mul_f32 v127, v127, v126
    v_accvgpr_write_b32 a78, v127
    v_accvgpr_read_b32 v127, a79
    v_mul_f32 v127, v127, v126
    v_accvgpr_write_b32 a79, v127
    v_accvgpr_read_b32 v127, a80
    v_mul_f32 v127, v127, v126
    v_accvgpr_write_b32 a80, v127
    v_accvgpr_read_b32 v127, a81
    v_mul_f32 v127, v127, v126
    v_accvgpr_write_b32 a81, v127
    v_accvgpr_read_b32 v127, a82
    v_mul_f32 v127, v127, v126
    v_accvgpr_write_b32 a82, v127
    v_accvgpr_read_b32 v127, a83
    v_mul_f32 v127, v127, v126
    v_accvgpr_write_b32 a83, v127
    v_accvgpr_read_b32 v127, a84
    v_mul_f32 v127, v127, v126
    v_accvgpr_write_b32 a84, v127
    v_accvgpr_read_b32 v127, a85
    v_mul_f32 v127, v127, v126
    v_accvgpr_write_b32 a85, v127
    v_accvgpr_read_b32 v127, a86
    v_mul_f32 v127, v127, v126
    v_accvgpr_write_b32 a86, v127
    v_accvgpr_read_b32 v127, a87
    v_mul_f32 v127, v127, v126
    v_accvgpr_write_b32 a87, v127
    v_accvgpr_read_b32 v127, a88
    v_mul_f32 v127, v127, v126
    v_accvgpr_write_b32 a88, v127
    v_accvgpr_read_b32 v127, a89
    v_mul_f32 v127, v127, v126
    v_accvgpr_write_b32 a89, v127
    v_accvgpr_read_b32 v127, a90
    v_mul_f32 v127, v127, v126
    v_accvgpr_write_b32 a90, v127
    v_accvgpr_read_b32 v127, a91
    v_mul_f32 v127, v127, v126
    v_accvgpr_write_b32 a91, v127
    v_accvgpr_read_b32 v127, a92
    v_mul_f32 v127, v127, v126
    v_accvgpr_write_b32 a92, v127
    v_accvgpr_read_b32 v127, a93
    v_mul_f32 v127, v127, v126
    v_accvgpr_write_b32 a93, v127
    v_accvgpr_read_b32 v127, a94
    v_mul_f32 v127, v127, v126
    v_accvgpr_write_b32 a94, v127
    v_accvgpr_read_b32 v127, a95
    v_mul_f32 v127, v127, v126
    v_accvgpr_write_b32 a95, v127
    v_mov_b32 v126, v123
    s_nop 1
    v_permlane16_swap_b32 v123, v126
    v_max_f32 v123, v123, v126
    v_mov_b32 v126, v123
    s_nop 1
    v_permlane32_swap_b32 v123, v126
    v_max_f32 v123, v123, v126
    v_cmp_eq_f32 vcc, 0, v104
    v_max_f32 v126, 0, v123
    s_nop 0
    v_cndmask_b32 v123, v126, v123, vcc
    v_sub_f32 v56, v56, v123
    v_sub_f32 v57, v57, v123
    v_sub_f32 v58, v58, v123
    v_sub_f32 v59, v59, v123
    v_sub_f32 v60, v60, v123
    v_sub_f32 v61, v61, v123
    v_sub_f32 v62, v62, v123
    v_sub_f32 v63, v63, v123
    v_sub_f32 v84, v84, v123
    v_sub_f32 v85, v85, v123
    v_sub_f32 v86, v86, v123
    v_sub_f32 v87, v87, v123
    v_exp_f32 v126, -v126
    s_nop 0
    v_mul_f32 v104, v104, v126
    v_mul_f32 v105, v105, v126
    v_mul_f32 v106, v106, v126
    v_mul_f32 v107, v107, v126
    v_accvgpr_read_b32 v127, a96
    v_mul_f32 v127, v127, v126
    v_accvgpr_write_b32 a96, v127
    v_accvgpr_read_b32 v127, a97
    v_mul_f32 v127, v127, v126
    v_accvgpr_write_b32 a97, v127
    v_accvgpr_read_b32 v127, a98
    v_mul_f32 v127, v127, v126
    v_accvgpr_write_b32 a98, v127
    v_accvgpr_read_b32 v127, a99
    v_mul_f32 v127, v127, v126
    v_accvgpr_write_b32 a99, v127
    v_accvgpr_read_b32 v127, a100
    v_mul_f32 v127, v127, v126
    v_accvgpr_write_b32 a100, v127
    v_accvgpr_read_b32 v127, a101
    v_mul_f32 v127, v127, v126
    v_accvgpr_write_b32 a101, v127
    v_accvgpr_read_b32 v127, a102
    v_mul_f32 v127, v127, v126
    v_accvgpr_write_b32 a102, v127
    v_accvgpr_read_b32 v127, a103
    v_mul_f32 v127, v127, v126
    v_accvgpr_write_b32 a103, v127
    v_accvgpr_read_b32 v127, a104
    v_mul_f32 v127, v127, v126
    v_accvgpr_write_b32 a104, v127
    v_accvgpr_read_b32 v127, a105
    v_mul_f32 v127, v127, v126
    v_accvgpr_write_b32 a105, v127
    v_accvgpr_read_b32 v127, a106
    v_mul_f32 v127, v127, v126
    v_accvgpr_write_b32 a106, v127
    v_accvgpr_read_b32 v127, a107
    v_mul_f32 v127, v127, v126
    v_accvgpr_write_b32 a107, v127
    v_accvgpr_read_b32 v127, a108
    v_mul_f32 v127, v127, v126
    v_accvgpr_write_b32 a108, v127
    v_accvgpr_read_b32 v127, a109
    v_mul_f32 v127, v127, v126
    v_accvgpr_write_b32 a109, v127
    v_accvgpr_read_b32 v127, a110
    v_mul_f32 v127, v127, v126
    v_accvgpr_write_b32 a110, v127
    v_accvgpr_read_b32 v127, a111
    v_mul_f32 v127, v127, v126
    v_accvgpr_write_b32 a111, v127
    v_accvgpr_read_b32 v127, a112
    v_mul_f32 v127, v127, v126
    v_accvgpr_write_b32 a112, v127
    v_accvgpr_read_b32 v127, a113
    v_mul_f32 v127, v127, v126
    v_accvgpr_write_b32 a113, v127
    v_accvgpr_read_b32 v127, a114
    v_mul_f32 v127, v127, v126
    v_accvgpr_write_b32 a114, v127
    v_accvgpr_read_b32 v127, a115
    v_mul_f32 v127, v127, v126
    v_accvgpr_write_b32 a115, v127
    v_accvgpr_read_b32 v127, a116
    v_mul_f32 v127, v127, v126
    v_accvgpr_write_b32 a116, v127
    v_accvgpr_read_b32 v127, a117
    v_mul_f32 v127, v127, v126
    v_accvgpr_write_b32 a117, v127
    v_accvgpr_read_b32 v127, a118
    v_mul_f32 v127, v127, v126
    v_accvgpr_write_b32 a118, v127
    v_accvgpr_read_b32 v127, a119
    v_mul_f32 v127, v127, v126
    v_accvgpr_write_b32 a119, v127
    v_accvgpr_read_b32 v127, a120
    v_mul_f32 v127, v127, v126
    v_accvgpr_write_b32 a120, v127
    v_accvgpr_read_b32 v127, a121
    v_mul_f32 v127, v127, v126
    v_accvgpr_write_b32 a121, v127
    v_accvgpr_read_b32 v127, a122
    v_mul_f32 v127, v127, v126
    v_accvgpr_write_b32 a122, v127
    v_accvgpr_read_b32 v127, a123
    v_mul_f32 v127, v127, v126
    v_accvgpr_write_b32 a123, v127
    v_accvgpr_read_b32 v127, a124
    v_mul_f32 v127, v127, v126
    v_accvgpr_write_b32 a124, v127
    v_accvgpr_read_b32 v127, a125
    v_mul_f32 v127, v127, v126
    v_accvgpr_write_b32 a125, v127
    v_accvgpr_read_b32 v127, a126
    v_mul_f32 v127, v127, v126
    v_accvgpr_write_b32 a126, v127
    v_accvgpr_read_b32 v127, a127
    v_mul_f32 v127, v127, v126
    v_accvgpr_write_b32 a127, v127
    s_nop 3
    s_branch attn_kernel_n7
attn_kernel_n8:
    s_nop 7
    v_mov_b32 v126, v120
    s_nop 1
    v_permlane16_swap_b32 v120, v126
    v_max_f32 v120, v120, v126
    v_mov_b32 v126, v120
    s_nop 1
    v_permlane32_swap_b32 v120, v126
    v_max_f32 v120, v120, v126
    v_cmp_eq_f32 vcc, 0, v92
    v_max_f32 v126, 0, v120
    s_nop 0
    v_cndmask_b32 v120, v126, v120, vcc
    v_sub_f32 v0, v0, v120
    v_sub_f32 v1, v1, v120
    v_sub_f32 v2, v2, v120
    v_sub_f32 v3, v3, v120
    v_sub_f32 v4, v4, v120
    v_sub_f32 v5, v5, v120
    v_sub_f32 v6, v6, v120
    v_sub_f32 v7, v7, v120
    v_sub_f32 v72, v72, v120
    v_sub_f32 v73, v73, v120
    v_sub_f32 v74, v74, v120
    v_sub_f32 v75, v75, v120
    v_exp_f32 v126, -v126
    s_nop 0
    v_mul_f32 v92, v92, v126
    v_mul_f32 v93, v93, v126
    v_mul_f32 v94, v94, v126
    v_mul_f32 v95, v95, v126
    v_accvgpr_read_b32 v127, a0
    v_mul_f32 v127, v127, v126
    v_accvgpr_write_b32 a0, v127
    v_accvgpr_read_b32 v127, a1
    v_mul_f32 v127, v127, v126
    v_accvgpr_write_b32 a1, v127
    v_accvgpr_read_b32 v127, a2
    v_mul_f32 v127, v127, v126
    v_accvgpr_write_b32 a2, v127
    v_accvgpr_read_b32 v127, a3
    v_mul_f32 v127, v127, v126
    v_accvgpr_write_b32 a3, v127
    v_accvgpr_read_b32 v127, a4
    v_mul_f32 v127, v127, v126
    v_accvgpr_write_b32 a4, v127
    v_accvgpr_read_b32 v127, a5
    v_mul_f32 v127, v127, v126
    v_accvgpr_write_b32 a5, v127
    v_accvgpr_read_b32 v127, a6
    v_mul_f32 v127, v127, v126
    v_accvgpr_write_b32 a6, v127
    v_accvgpr_read_b32 v127, a7
    v_mul_f32 v127, v127, v126
    v_accvgpr_write_b32 a7, v127
    v_accvgpr_read_b32 v127, a8
    v_mul_f32 v127, v127, v126
    v_accvgpr_write_b32 a8, v127
    v_accvgpr_read_b32 v127, a9
    v_mul_f32 v127, v127, v126
    v_accvgpr_write_b32 a9, v127
    v_accvgpr_read_b32 v127, a10
    v_mul_f32 v127, v127, v126
    v_accvgpr_write_b32 a10, v127
    v_accvgpr_read_b32 v127, a11
    v_mul_f32 v127, v127, v126
    v_accvgpr_write_b32 a11, v127
    v_accvgpr_read_b32 v127, a12
    v_mul_f32 v127, v127, v126
    v_accvgpr_write_b32 a12, v127
    v_accvgpr_read_b32 v127, a13
    v_mul_f32 v127, v127, v126
    v_accvgpr_write_b32 a13, v127
    v_accvgpr_read_b32 v127, a14
    v_mul_f32 v127, v127, v126
    v_accvgpr_write_b32 a14, v127
    v_accvgpr_read_b32 v127, a15
    v_mul_f32 v127, v127, v126
    v_accvgpr_write_b32 a15, v127
    v_accvgpr_read_b32 v127, a16
    v_mul_f32 v127, v127, v126
    v_accvgpr_write_b32 a16, v127
    v_accvgpr_read_b32 v127, a17
    v_mul_f32 v127, v127, v126
    v_accvgpr_write_b32 a17, v127
    v_accvgpr_read_b32 v127, a18
    v_mul_f32 v127, v127, v126
    v_accvgpr_write_b32 a18, v127
    v_accvgpr_read_b32 v127, a19
    v_mul_f32 v127, v127, v126
    v_accvgpr_write_b32 a19, v127
    v_accvgpr_read_b32 v127, a20
    v_mul_f32 v127, v127, v126
    v_accvgpr_write_b32 a20, v127
    v_accvgpr_read_b32 v127, a21
    v_mul_f32 v127, v127, v126
    v_accvgpr_write_b32 a21, v127
    v_accvgpr_read_b32 v127, a22
    v_mul_f32 v127, v127, v126
    v_accvgpr_write_b32 a22, v127
    v_accvgpr_read_b32 v127, a23
    v_mul_f32 v127, v127, v126
    v_accvgpr_write_b32 a23, v127
    v_accvgpr_read_b32 v127, a24
    v_mul_f32 v127, v127, v126
    v_accvgpr_write_b32 a24, v127
    v_accvgpr_read_b32 v127, a25
    v_mul_f32 v127, v127, v126
    v_accvgpr_write_b32 a25, v127
    v_accvgpr_read_b32 v127, a26
    v_mul_f32 v127, v127, v126
    v_accvgpr_write_b32 a26, v127
    v_accvgpr_read_b32 v127, a27
    v_mul_f32 v127, v127, v126
    v_accvgpr_write_b32 a27, v127
    v_accvgpr_read_b32 v127, a28
    v_mul_f32 v127, v127, v126
    v_accvgpr_write_b32 a28, v127
    v_accvgpr_read_b32 v127, a29
    v_mul_f32 v127, v127, v126
    v_accvgpr_write_b32 a29, v127
    v_accvgpr_read_b32 v127, a30
    v_mul_f32 v127, v127, v126
    v_accvgpr_write_b32 a30, v127
    v_accvgpr_read_b32 v127, a31
    v_mul_f32 v127, v127, v126
    v_accvgpr_write_b32 a31, v127
    v_mov_b32 v126, v121
    s_nop 1
    v_permlane16_swap_b32 v121, v126
    v_max_f32 v121, v121, v126
    v_mov_b32 v126, v121
    s_nop 1
    v_permlane32_swap_b32 v121, v126
    v_max_f32 v121, v121, v126
    v_cmp_eq_f32 vcc, 0, v96
    v_max_f32 v126, 0, v121
    s_nop 0
    v_cndmask_b32 v121, v126, v121, vcc
    v_sub_f32 v16, v16, v121
    v_sub_f32 v17, v17, v121
    v_sub_f32 v18, v18, v121
    v_sub_f32 v19, v19, v121
    v_sub_f32 v20, v20, v121
    v_sub_f32 v21, v21, v121
    v_sub_f32 v22, v22, v121
    v_sub_f32 v23, v23, v121
    v_sub_f32 v76, v76, v121
    v_sub_f32 v77, v77, v121
    v_sub_f32 v78, v78, v121
    v_sub_f32 v79, v79, v121
    v_exp_f32 v126, -v126
    s_nop 0
    v_mul_f32 v96, v96, v126
    v_mul_f32 v97, v97, v126
    v_mul_f32 v98, v98, v126
    v_mul_f32 v99, v99, v126
    v_accvgpr_read_b32 v127, a32
    v_mul_f32 v127, v127, v126
    v_accvgpr_write_b32 a32, v127
    v_accvgpr_read_b32 v127, a33
    v_mul_f32 v127, v127, v126
    v_accvgpr_write_b32 a33, v127
    v_accvgpr_read_b32 v127, a34
    v_mul_f32 v127, v127, v126
    v_accvgpr_write_b32 a34, v127
    v_accvgpr_read_b32 v127, a35
    v_mul_f32 v127, v127, v126
    v_accvgpr_write_b32 a35, v127
    v_accvgpr_read_b32 v127, a36
    v_mul_f32 v127, v127, v126
    v_accvgpr_write_b32 a36, v127
    v_accvgpr_read_b32 v127, a37
    v_mul_f32 v127, v127, v126
    v_accvgpr_write_b32 a37, v127
    v_accvgpr_read_b32 v127, a38
    v_mul_f32 v127, v127, v126
    v_accvgpr_write_b32 a38, v127
    v_accvgpr_read_b32 v127, a39
    v_mul_f32 v127, v127, v126
    v_accvgpr_write_b32 a39, v127
    v_accvgpr_read_b32 v127, a40
    v_mul_f32 v127, v127, v126
    v_accvgpr_write_b32 a40, v127
    v_accvgpr_read_b32 v127, a41
    v_mul_f32 v127, v127, v126
    v_accvgpr_write_b32 a41, v127
    v_accvgpr_read_b32 v127, a42
    v_mul_f32 v127, v127, v126
    v_accvgpr_write_b32 a42, v127
    v_accvgpr_read_b32 v127, a43
    v_mul_f32 v127, v127, v126
    v_accvgpr_write_b32 a43, v127
    v_accvgpr_read_b32 v127, a44
    v_mul_f32 v127, v127, v126
    v_accvgpr_write_b32 a44, v127
    v_accvgpr_read_b32 v127, a45
    v_mul_f32 v127, v127, v126
    v_accvgpr_write_b32 a45, v127
    v_accvgpr_read_b32 v127, a46
    v_mul_f32 v127, v127, v126
    v_accvgpr_write_b32 a46, v127
    v_accvgpr_read_b32 v127, a47
    v_mul_f32 v127, v127, v126
    v_accvgpr_write_b32 a47, v127
    v_accvgpr_read_b32 v127, a48
    v_mul_f32 v127, v127, v126
    v_accvgpr_write_b32 a48, v127
    v_accvgpr_read_b32 v127, a49
    v_mul_f32 v127, v127, v126
    v_accvgpr_write_b32 a49, v127
    v_accvgpr_read_b32 v127, a50
    v_mul_f32 v127, v127, v126
    v_accvgpr_write_b32 a50, v127
    v_accvgpr_read_b32 v127, a51
    v_mul_f32 v127, v127, v126
    v_accvgpr_write_b32 a51, v127
    v_accvgpr_read_b32 v127, a52
    v_mul_f32 v127, v127, v126
    v_accvgpr_write_b32 a52, v127
    v_accvgpr_read_b32 v127, a53
    v_mul_f32 v127, v127, v126
    v_accvgpr_write_b32 a53, v127
    v_accvgpr_read_b32 v127, a54
    v_mul_f32 v127, v127, v126
    v_accvgpr_write_b32 a54, v127
    v_accvgpr_read_b32 v127, a55
    v_mul_f32 v127, v127, v126
    v_accvgpr_write_b32 a55, v127
    v_accvgpr_read_b32 v127, a56
    v_mul_f32 v127, v127, v126
    v_accvgpr_write_b32 a56, v127
    v_accvgpr_read_b32 v127, a57
    v_mul_f32 v127, v127, v126
    v_accvgpr_write_b32 a57, v127
    v_accvgpr_read_b32 v127, a58
    v_mul_f32 v127, v127, v126
    v_accvgpr_write_b32 a58, v127
    v_accvgpr_read_b32 v127, a59
    v_mul_f32 v127, v127, v126
    v_accvgpr_write_b32 a59, v127
    v_accvgpr_read_b32 v127, a60
    v_mul_f32 v127, v127, v126
    v_accvgpr_write_b32 a60, v127
    v_accvgpr_read_b32 v127, a61
    v_mul_f32 v127, v127, v126
    v_accvgpr_write_b32 a61, v127
    v_accvgpr_read_b32 v127, a62
    v_mul_f32 v127, v127, v126
    v_accvgpr_write_b32 a62, v127
    v_accvgpr_read_b32 v127, a63
    v_mul_f32 v127, v127, v126
    v_accvgpr_write_b32 a63, v127
    v_mov_b32 v126, v122
    s_nop 1
    v_permlane16_swap_b32 v122, v126
    v_max_f32 v122, v122, v126
    v_mov_b32 v126, v122
    s_nop 1
    v_permlane32_swap_b32 v122, v126
    v_max_f32 v122, v122, v126
    v_cmp_eq_f32 vcc, 0, v100
    v_max_f32 v126, 0, v122
    s_nop 0
    v_cndmask_b32 v122, v126, v122, vcc
    v_sub_f32 v32, v32, v122
    v_sub_f32 v33, v33, v122
    v_sub_f32 v34, v34, v122
    v_sub_f32 v35, v35, v122
    v_sub_f32 v36, v36, v122
    v_sub_f32 v37, v37, v122
    v_sub_f32 v38, v38, v122
    v_sub_f32 v39, v39, v122
    v_sub_f32 v80, v80, v122
    v_sub_f32 v81, v81, v122
    v_sub_f32 v82, v82, v122
    v_sub_f32 v83, v83, v122
    v_exp_f32 v126, -v126
    s_nop 0
    v_mul_f32 v100, v100, v126
    v_mul_f32 v101, v101, v126
    v_mul_f32 v102, v102, v126
    v_mul_f32 v103, v103, v126
    v_accvgpr_read_b32 v127, a64
    v_mul_f32 v127, v127, v126
    v_accvgpr_write_b32 a64, v127
    v_accvgpr_read_b32 v127, a65
    v_mul_f32 v127, v127, v126
    v_accvgpr_write_b32 a65, v127
    v_accvgpr_read_b32 v127, a66
    v_mul_f32 v127, v127, v126
    v_accvgpr_write_b32 a66, v127
    v_accvgpr_read_b32 v127, a67
    v_mul_f32 v127, v127, v126
    v_accvgpr_write_b32 a67, v127
    v_accvgpr_read_b32 v127, a68
    v_mul_f32 v127, v127, v126
    v_accvgpr_write_b32 a68, v127
    v_accvgpr_read_b32 v127, a69
    v_mul_f32 v127, v127, v126
    v_accvgpr_write_b32 a69, v127
    v_accvgpr_read_b32 v127, a70
    v_mul_f32 v127, v127, v126
    v_accvgpr_write_b32 a70, v127
    v_accvgpr_read_b32 v127, a71
    v_mul_f32 v127, v127, v126
    v_accvgpr_write_b32 a71, v127
    v_accvgpr_read_b32 v127, a72
    v_mul_f32 v127, v127, v126
    v_accvgpr_write_b32 a72, v127
    v_accvgpr_read_b32 v127, a73
    v_mul_f32 v127, v127, v126
    v_accvgpr_write_b32 a73, v127
    v_accvgpr_read_b32 v127, a74
    v_mul_f32 v127, v127, v126
    v_accvgpr_write_b32 a74, v127
    v_accvgpr_read_b32 v127, a75
    v_mul_f32 v127, v127, v126
    v_accvgpr_write_b32 a75, v127
    v_accvgpr_read_b32 v127, a76
    v_mul_f32 v127, v127, v126
    v_accvgpr_write_b32 a76, v127
    v_accvgpr_read_b32 v127, a77
    v_mul_f32 v127, v127, v126
    v_accvgpr_write_b32 a77, v127
    v_accvgpr_read_b32 v127, a78
    v_mul_f32 v127, v127, v126
    v_accvgpr_write_b32 a78, v127
    v_accvgpr_read_b32 v127, a79
    v_mul_f32 v127, v127, v126
    v_accvgpr_write_b32 a79, v127
    v_accvgpr_read_b32 v127, a80
    v_mul_f32 v127, v127, v126
    v_accvgpr_write_b32 a80, v127
    v_accvgpr_read_b32 v127, a81
    v_mul_f32 v127, v127, v126
    v_accvgpr_write_b32 a81, v127
    v_accvgpr_read_b32 v127, a82
    v_mul_f32 v127, v127, v126
    v_accvgpr_write_b32 a82, v127
    v_accvgpr_read_b32 v127, a83
    v_mul_f32 v127, v127, v126
    v_accvgpr_write_b32 a83, v127
    v_accvgpr_read_b32 v127, a84
    v_mul_f32 v127, v127, v126
    v_accvgpr_write_b32 a84, v127
    v_accvgpr_read_b32 v127, a85
    v_mul_f32 v127, v127, v126
    v_accvgpr_write_b32 a85, v127
    v_accvgpr_read_b32 v127, a86
    v_mul_f32 v127, v127, v126
    v_accvgpr_write_b32 a86, v127
    v_accvgpr_read_b32 v127, a87
    v_mul_f32 v127, v127, v126
    v_accvgpr_write_b32 a87, v127
    v_accvgpr_read_b32 v127, a88
    v_mul_f32 v127, v127, v126
    v_accvgpr_write_b32 a88, v127
    v_accvgpr_read_b32 v127, a89
    v_mul_f32 v127, v127, v126
    v_accvgpr_write_b32 a89, v127
    v_accvgpr_read_b32 v127, a90
    v_mul_f32 v127, v127, v126
    v_accvgpr_write_b32 a90, v127
    v_accvgpr_read_b32 v127, a91
    v_mul_f32 v127, v127, v126
    v_accvgpr_write_b32 a91, v127
    v_accvgpr_read_b32 v127, a92
    v_mul_f32 v127, v127, v126
    v_accvgpr_write_b32 a92, v127
    v_accvgpr_read_b32 v127, a93
    v_mul_f32 v127, v127, v126
    v_accvgpr_write_b32 a93, v127
    v_accvgpr_read_b32 v127, a94
    v_mul_f32 v127, v127, v126
    v_accvgpr_write_b32 a94, v127
    v_accvgpr_read_b32 v127, a95
    v_mul_f32 v127, v127, v126
    v_accvgpr_write_b32 a95, v127
    v_mov_b32 v126, v123
    s_nop 1
    v_permlane16_swap_b32 v123, v126
    v_max_f32 v123, v123, v126
    v_mov_b32 v126, v123
    s_nop 1
    v_permlane32_swap_b32 v123, v126
    v_max_f32 v123, v123, v126
    v_cmp_eq_f32 vcc, 0, v104
    v_max_f32 v126, 0, v123
    s_nop 0
    v_cndmask_b32 v123, v126, v123, vcc
    v_sub_f32 v48, v48, v123
    v_sub_f32 v49, v49, v123
    v_sub_f32 v50, v50, v123
    v_sub_f32 v51, v51, v123
    v_sub_f32 v52, v52, v123
    v_sub_f32 v53, v53, v123
    v_sub_f32 v54, v54, v123
    v_sub_f32 v55, v55, v123
    v_sub_f32 v84, v84, v123
    v_sub_f32 v85, v85, v123
    v_sub_f32 v86, v86, v123
    v_sub_f32 v87, v87, v123
    v_exp_f32 v126, -v126
    s_nop 0
    v_mul_f32 v104, v104, v126
    v_mul_f32 v105, v105, v126
    v_mul_f32 v106, v106, v126
    v_mul_f32 v107, v107, v126
    v_accvgpr_read_b32 v127, a96
    v_mul_f32 v127, v127, v126
    v_accvgpr_write_b32 a96, v127
    v_accvgpr_read_b32 v127, a97
    v_mul_f32 v127, v127, v126
    v_accvgpr_write_b32 a97, v127
    v_accvgpr_read_b32 v127, a98
    v_mul_f32 v127, v127, v126
    v_accvgpr_write_b32 a98, v127
    v_accvgpr_read_b32 v127, a99
    v_mul_f32 v127, v127, v126
    v_accvgpr_write_b32 a99, v127
    v_accvgpr_read_b32 v127, a100
    v_mul_f32 v127, v127, v126
    v_accvgpr_write_b32 a100, v127
    v_accvgpr_read_b32 v127, a101
    v_mul_f32 v127, v127, v126
    v_accvgpr_write_b32 a101, v127
    v_accvgpr_read_b32 v127, a102
    v_mul_f32 v127, v127, v126
    v_accvgpr_write_b32 a102, v127
    v_accvgpr_read_b32 v127, a103
    v_mul_f32 v127, v127, v126
    v_accvgpr_write_b32 a103, v127
    v_accvgpr_read_b32 v127, a104
    v_mul_f32 v127, v127, v126
    v_accvgpr_write_b32 a104, v127
    v_accvgpr_read_b32 v127, a105
    v_mul_f32 v127, v127, v126
    v_accvgpr_write_b32 a105, v127
    v_accvgpr_read_b32 v127, a106
    v_mul_f32 v127, v127, v126
    v_accvgpr_write_b32 a106, v127
    v_accvgpr_read_b32 v127, a107
    v_mul_f32 v127, v127, v126
    v_accvgpr_write_b32 a107, v127
    v_accvgpr_read_b32 v127, a108
    v_mul_f32 v127, v127, v126
    v_accvgpr_write_b32 a108, v127
    v_accvgpr_read_b32 v127, a109
    v_mul_f32 v127, v127, v126
    v_accvgpr_write_b32 a109, v127
    v_accvgpr_read_b32 v127, a110
    v_mul_f32 v127, v127, v126
    v_accvgpr_write_b32 a110, v127
    v_accvgpr_read_b32 v127, a111
    v_mul_f32 v127, v127, v126
    v_accvgpr_write_b32 a111, v127
    v_accvgpr_read_b32 v127, a112
    v_mul_f32 v127, v127, v126
    v_accvgpr_write_b32 a112, v127
    v_accvgpr_read_b32 v127, a113
    v_mul_f32 v127, v127, v126
    v_accvgpr_write_b32 a113, v127
    v_accvgpr_read_b32 v127, a114
    v_mul_f32 v127, v127, v126
    v_accvgpr_write_b32 a114, v127
    v_accvgpr_read_b32 v127, a115
    v_mul_f32 v127, v127, v126
    v_accvgpr_write_b32 a115, v127
    v_accvgpr_read_b32 v127, a116
    v_mul_f32 v127, v127, v126
    v_accvgpr_write_b32 a116, v127
    v_accvgpr_read_b32 v127, a117
    v_mul_f32 v127, v127, v126
    v_accvgpr_write_b32 a117, v127
    v_accvgpr_read_b32 v127, a118
    v_mul_f32 v127, v127, v126
    v_accvgpr_write_b32 a118, v127
    v_accvgpr_read_b32 v127, a119
    v_mul_f32 v127, v127, v126
    v_accvgpr_write_b32 a119, v127
    v_accvgpr_read_b32 v127, a120
    v_mul_f32 v127, v127, v126
    v_accvgpr_write_b32 a120, v127
    v_accvgpr_read_b32 v127, a121
    v_mul_f32 v127, v127, v126
    v_accvgpr_write_b32 a121, v127
    v_accvgpr_read_b32 v127, a122
    v_mul_f32 v127, v127, v126
    v_accvgpr_write_b32 a122, v127
    v_accvgpr_read_b32 v127, a123
    v_mul_f32 v127, v127, v126
    v_accvgpr_write_b32 a123, v127
    v_accvgpr_read_b32 v127, a124
    v_mul_f32 v127, v127, v126
    v_accvgpr_write_b32 a124, v127
    v_accvgpr_read_b32 v127, a125
    v_mul_f32 v127, v127, v126
    v_accvgpr_write_b32 a125, v127
    v_accvgpr_read_b32 v127, a126
    v_mul_f32 v127, v127, v126
    v_accvgpr_write_b32 a126, v127
    v_accvgpr_read_b32 v127, a127
    v_mul_f32 v127, v127, v126
    v_accvgpr_write_b32 a127, v127
    v_mov_b32 v126, v124
    s_nop 1
    v_permlane16_swap_b32 v124, v126
    v_max_f32 v124, v124, v126
    v_mov_b32 v126, v124
    s_nop 1
    v_permlane32_swap_b32 v124, v126
    v_max_f32 v124, v124, v126
    v_cmp_eq_f32 vcc, 0, v108
    v_max_f32 v126, 0, v124
    s_nop 0
    v_cndmask_b32 v124, v126, v124, vcc
    v_sub_f32 v64, v64, v124
    v_sub_f32 v65, v65, v124
    v_sub_f32 v66, v66, v124
    v_sub_f32 v67, v67, v124
    v_sub_f32 v68, v68, v124
    v_sub_f32 v69, v69, v124
    v_sub_f32 v70, v70, v124
    v_sub_f32 v71, v71, v124
    v_sub_f32 v88, v88, v124
    v_sub_f32 v89, v89, v124
    v_sub_f32 v90, v90, v124
    v_sub_f32 v91, v91, v124
    v_exp_f32 v126, -v126
    s_nop 0
    v_mul_f32 v108, v108, v126
    v_mul_f32 v109, v109, v126
    v_mul_f32 v110, v110, v126
    v_mul_f32 v111, v111, v126
    v_accvgpr_read_b32 v127, a128
    v_mul_f32 v127, v127, v126
    v_accvgpr_write_b32 a128, v127
    v_accvgpr_read_b32 v127, a129
    v_mul_f32 v127, v127, v126
    v_accvgpr_write_b32 a129, v127
    v_accvgpr_read_b32 v127, a130
    v_mul_f32 v127, v127, v126
    v_accvgpr_write_b32 a130, v127
    v_accvgpr_read_b32 v127, a131
    v_mul_f32 v127, v127, v126
    v_accvgpr_write_b32 a131, v127
    v_accvgpr_read_b32 v127, a132
    v_mul_f32 v127, v127, v126
    v_accvgpr_write_b32 a132, v127
    v_accvgpr_read_b32 v127, a133
    v_mul_f32 v127, v127, v126
    v_accvgpr_write_b32 a133, v127
    v_accvgpr_read_b32 v127, a134
    v_mul_f32 v127, v127, v126
    v_accvgpr_write_b32 a134, v127
    v_accvgpr_read_b32 v127, a135
    v_mul_f32 v127, v127, v126
    v_accvgpr_write_b32 a135, v127
    v_accvgpr_read_b32 v127, a136
    v_mul_f32 v127, v127, v126
    v_accvgpr_write_b32 a136, v127
    v_accvgpr_read_b32 v127, a137
    v_mul_f32 v127, v127, v126
    v_accvgpr_write_b32 a137, v127
    v_accvgpr_read_b32 v127, a138
    v_mul_f32 v127, v127, v126
    v_accvgpr_write_b32 a138, v127
    v_accvgpr_read_b32 v127, a139
    v_mul_f32 v127, v127, v126
    v_accvgpr_write_b32 a139, v127
    v_accvgpr_read_b32 v127, a140
    v_mul_f32 v127, v127, v126
    v_accvgpr_write_b32 a140, v127
    v_accvgpr_read_b32 v127, a141
    v_mul_f32 v127, v127, v126
    v_accvgpr_write_b32 a141, v127
    v_accvgpr_read_b32 v127, a142
    v_mul_f32 v127, v127, v126
    v_accvgpr_write_b32 a142, v127
    v_accvgpr_read_b32 v127, a143
    v_mul_f32 v127, v127, v126
    v_accvgpr_write_b32 a143, v127
    v_accvgpr_read_b32 v127, a144
    v_mul_f32 v127, v127, v126
    v_accvgpr_write_b32 a144, v127
    v_accvgpr_read_b32 v127, a145
    v_mul_f32 v127, v127, v126
    v_accvgpr_write_b32 a145, v127
    v_accvgpr_read_b32 v127, a146
    v_mul_f32 v127, v127, v126
    v_accvgpr_write_b32 a146, v127
    v_accvgpr_read_b32 v127, a147
    v_mul_f32 v127, v127, v126
    v_accvgpr_write_b32 a147, v127
    v_accvgpr_read_b32 v127, a148
    v_mul_f32 v127, v127, v126
    v_accvgpr_write_b32 a148, v127
    v_accvgpr_read_b32 v127, a149
    v_mul_f32 v127, v127, v126
    v_accvgpr_write_b32 a149, v127
    v_accvgpr_read_b32 v127, a150
    v_mul_f32 v127, v127, v126
    v_accvgpr_write_b32 a150, v127
    v_accvgpr_read_b32 v127, a151
    v_mul_f32 v127, v127, v126
    v_accvgpr_write_b32 a151, v127
    v_accvgpr_read_b32 v127, a152
    v_mul_f32 v127, v127, v126
    v_accvgpr_write_b32 a152, v127
    v_accvgpr_read_b32 v127, a153
    v_mul_f32 v127, v127, v126
    v_accvgpr_write_b32 a153, v127
    v_accvgpr_read_b32 v127, a154
    v_mul_f32 v127, v127, v126
    v_accvgpr_write_b32 a154, v127
    v_accvgpr_read_b32 v127, a155
    v_mul_f32 v127, v127, v126
    v_accvgpr_write_b32 a155, v127
    v_accvgpr_read_b32 v127, a156
    v_mul_f32 v127, v127, v126
    v_accvgpr_write_b32 a156, v127
    v_accvgpr_read_b32 v127, a157
    v_mul_f32 v127, v127, v126
    v_accvgpr_write_b32 a157, v127
    v_accvgpr_read_b32 v127, a158
    v_mul_f32 v127, v127, v126
    v_accvgpr_write_b32 a158, v127
    v_accvgpr_read_b32 v127, a159
    v_mul_f32 v127, v127, v126
    v_accvgpr_write_b32 a159, v127
    s_nop 3
    s_branch attn_kernel_n9
attn_kernel_n10:
    s_nop 7
    v_mov_b32 v126, v120
    s_nop 1
    v_permlane16_swap_b32 v120, v126
    v_max_f32 v120, v120, v126
    v_mov_b32 v126, v120
    s_nop 1
    v_permlane32_swap_b32 v120, v126
    v_max_f32 v120, v120, v126
    v_cmp_eq_f32 vcc, 0, v92
    v_max_f32 v126, 0, v120
    s_nop 0
    v_cndmask_b32 v120, v126, v120, vcc
    v_sub_f32 v8, v8, v120
    v_sub_f32 v9, v9, v120
    v_sub_f32 v10, v10, v120
    v_sub_f32 v11, v11, v120
    v_sub_f32 v12, v12, v120
    v_sub_f32 v13, v13, v120
    v_sub_f32 v14, v14, v120
    v_sub_f32 v15, v15, v120
    v_sub_f32 v72, v72, v120
    v_sub_f32 v73, v73, v120
    v_sub_f32 v74, v74, v120
    v_sub_f32 v75, v75, v120
    v_exp_f32 v126, -v126
    s_nop 0
    v_mul_f32 v92, v92, v126
    v_mul_f32 v93, v93, v126
    v_mul_f32 v94, v94, v126
    v_mul_f32 v95, v95, v126
    v_accvgpr_read_b32 v127, a0
    v_mul_f32 v127, v127, v126
    v_accvgpr_write_b32 a0, v127
    v_accvgpr_read_b32 v127, a1
    v_mul_f32 v127, v127, v126
    v_accvgpr_write_b32 a1, v127
    v_accvgpr_read_b32 v127, a2
    v_mul_f32 v127, v127, v126
    v_accvgpr_write_b32 a2, v127
    v_accvgpr_read_b32 v127, a3
    v_mul_f32 v127, v127, v126
    v_accvgpr_write_b32 a3, v127
    v_accvgpr_read_b32 v127, a4
    v_mul_f32 v127, v127, v126
    v_accvgpr_write_b32 a4, v127
    v_accvgpr_read_b32 v127, a5
    v_mul_f32 v127, v127, v126
    v_accvgpr_write_b32 a5, v127
    v_accvgpr_read_b32 v127, a6
    v_mul_f32 v127, v127, v126
    v_accvgpr_write_b32 a6, v127
    v_accvgpr_read_b32 v127, a7
    v_mul_f32 v127, v127, v126
    v_accvgpr_write_b32 a7, v127
    v_accvgpr_read_b32 v127, a8
    v_mul_f32 v127, v127, v126
    v_accvgpr_write_b32 a8, v127
    v_accvgpr_read_b32 v127, a9
    v_mul_f32 v127, v127, v126
    v_accvgpr_write_b32 a9, v127
    v_accvgpr_read_b32 v127, a10
    v_mul_f32 v127, v127, v126
    v_accvgpr_write_b32 a10, v127
    v_accvgpr_read_b32 v127, a11
    v_mul_f32 v127, v127, v126
    v_accvgpr_write_b32 a11, v127
    v_accvgpr_read_b32 v127, a12
    v_mul_f32 v127, v127, v126
    v_accvgpr_write_b32 a12, v127
    v_accvgpr_read_b32 v127, a13
    v_mul_f32 v127, v127, v126
    v_accvgpr_write_b32 a13, v127
    v_accvgpr_read_b32 v127, a14
    v_mul_f32 v127, v127, v126
    v_accvgpr_write_b32 a14, v127
    v_accvgpr_read_b32 v127, a15
    v_mul_f32 v127, v127, v126
    v_accvgpr_write_b32 a15, v127
    v_accvgpr_read_b32 v127, a16
    v_mul_f32 v127, v127, v126
    v_accvgpr_write_b32 a16, v127
    v_accvgpr_read_b32 v127, a17
    v_mul_f32 v127, v127, v126
    v_accvgpr_write_b32 a17, v127
    v_accvgpr_read_b32 v127, a18
    v_mul_f32 v127, v127, v126
    v_accvgpr_write_b32 a18, v127
    v_accvgpr_read_b32 v127, a19
    v_mul_f32 v127, v127, v126
    v_accvgpr_write_b32 a19, v127
    v_accvgpr_read_b32 v127, a20
    v_mul_f32 v127, v127, v126
    v_accvgpr_write_b32 a20, v127
    v_accvgpr_read_b32 v127, a21
    v_mul_f32 v127, v127, v126
    v_accvgpr_write_b32 a21, v127
    v_accvgpr_read_b32 v127, a22
    v_mul_f32 v127, v127, v126
    v_accvgpr_write_b32 a22, v127
    v_accvgpr_read_b32 v127, a23
    v_mul_f32 v127, v127, v126
    v_accvgpr_write_b32 a23, v127
    v_accvgpr_read_b32 v127, a24
    v_mul_f32 v127, v127, v126
    v_accvgpr_write_b32 a24, v127
    v_accvgpr_read_b32 v127, a25
    v_mul_f32 v127, v127, v126
    v_accvgpr_write_b32 a25, v127
    v_accvgpr_read_b32 v127, a26
    v_mul_f32 v127, v127, v126
    v_accvgpr_write_b32 a26, v127
    v_accvgpr_read_b32 v127, a27
    v_mul_f32 v127, v127, v126
    v_accvgpr_write_b32 a27, v127
    v_accvgpr_read_b32 v127, a28
    v_mul_f32 v127, v127, v126
    v_accvgpr_write_b32 a28, v127
    v_accvgpr_read_b32 v127, a29
    v_mul_f32 v127, v127, v126
    v_accvgpr_write_b32 a29, v127
    v_accvgpr_read_b32 v127, a30
    v_mul_f32 v127, v127, v126
    v_accvgpr_write_b32 a30, v127
    v_accvgpr_read_b32 v127, a31
    v_mul_f32 v127, v127, v126
    v_accvgpr_write_b32 a31, v127
    v_mov_b32 v126, v121
    s_nop 1
    v_permlane16_swap_b32 v121, v126
    v_max_f32 v121, v121, v126
    v_mov_b32 v126, v121
    s_nop 1
    v_permlane32_swap_b32 v121, v126
    v_max_f32 v121, v121, v126
    v_cmp_eq_f32 vcc, 0, v96
    v_max_f32 v126, 0, v121
    s_nop 0
    v_cndmask_b32 v121, v126, v121, vcc
    v_sub_f32 v24, v24, v121
    v_sub_f32 v25, v25, v121
    v_sub_f32 v26, v26, v121
    v_sub_f32 v27, v27, v121
    v_sub_f32 v28, v28, v121
    v_sub_f32 v29, v29, v121
    v_sub_f32 v30, v30, v121
    v_sub_f32 v31, v31, v121
    v_sub_f32 v76, v76, v121
    v_sub_f32 v77, v77, v121
    v_sub_f32 v78, v78, v121
    v_sub_f32 v79, v79, v121
    v_exp_f32 v126, -v126
    s_nop 0
    v_mul_f32 v96, v96, v126
    v_mul_f32 v97, v97, v126
    v_mul_f32 v98, v98, v126
    v_mul_f32 v99, v99, v126
    v_accvgpr_read_b32 v127, a32
    v_mul_f32 v127, v127, v126
    v_accvgpr_write_b32 a32, v127
    v_accvgpr_read_b32 v127, a33
    v_mul_f32 v127, v127, v126
    v_accvgpr_write_b32 a33, v127
    v_accvgpr_read_b32 v127, a34
    v_mul_f32 v127, v127, v126
    v_accvgpr_write_b32 a34, v127
    v_accvgpr_read_b32 v127, a35
    v_mul_f32 v127, v127, v126
    v_accvgpr_write_b32 a35, v127
    v_accvgpr_read_b32 v127, a36
    v_mul_f32 v127, v127, v126
    v_accvgpr_write_b32 a36, v127
    v_accvgpr_read_b32 v127, a37
    v_mul_f32 v127, v127, v126
    v_accvgpr_write_b32 a37, v127
    v_accvgpr_read_b32 v127, a38
    v_mul_f32 v127, v127, v126
    v_accvgpr_write_b32 a38, v127
    v_accvgpr_read_b32 v127, a39
    v_mul_f32 v127, v127, v126
    v_accvgpr_write_b32 a39, v127
    v_accvgpr_read_b32 v127, a40
    v_mul_f32 v127, v127, v126
    v_accvgpr_write_b32 a40, v127
    v_accvgpr_read_b32 v127, a41
    v_mul_f32 v127, v127, v126
    v_accvgpr_write_b32 a41, v127
    v_accvgpr_read_b32 v127, a42
    v_mul_f32 v127, v127, v126
    v_accvgpr_write_b32 a42, v127
    v_accvgpr_read_b32 v127, a43
    v_mul_f32 v127, v127, v126
    v_accvgpr_write_b32 a43, v127
    v_accvgpr_read_b32 v127, a44
    v_mul_f32 v127, v127, v126
    v_accvgpr_write_b32 a44, v127
    v_accvgpr_read_b32 v127, a45
    v_mul_f32 v127, v127, v126
    v_accvgpr_write_b32 a45, v127
    v_accvgpr_read_b32 v127, a46
    v_mul_f32 v127, v127, v126
    v_accvgpr_write_b32 a46, v127
    v_accvgpr_read_b32 v127, a47
    v_mul_f32 v127, v127, v126
    v_accvgpr_write_b32 a47, v127
    v_accvgpr_read_b32 v127, a48
    v_mul_f32 v127, v127, v126
    v_accvgpr_write_b32 a48, v127
    v_accvgpr_read_b32 v127, a49
    v_mul_f32 v127, v127, v126
    v_accvgpr_write_b32 a49, v127
    v_accvgpr_read_b32 v127, a50
    v_mul_f32 v127, v127, v126
    v_accvgpr_write_b32 a50, v127
    v_accvgpr_read_b32 v127, a51
    v_mul_f32 v127, v127, v126
    v_accvgpr_write_b32 a51, v127
    v_accvgpr_read_b32 v127, a52
    v_mul_f32 v127, v127, v126
    v_accvgpr_write_b32 a52, v127
    v_accvgpr_read_b32 v127, a53
    v_mul_f32 v127, v127, v126
    v_accvgpr_write_b32 a53, v127
    v_accvgpr_read_b32 v127, a54
    v_mul_f32 v127, v127, v126
    v_accvgpr_write_b32 a54, v127
    v_accvgpr_read_b32 v127, a55
    v_mul_f32 v127, v127, v126
    v_accvgpr_write_b32 a55, v127
    v_accvgpr_read_b32 v127, a56
    v_mul_f32 v127, v127, v126
    v_accvgpr_write_b32 a56, v127
    v_accvgpr_read_b32 v127, a57
    v_mul_f32 v127, v127, v126
    v_accvgpr_write_b32 a57, v127
    v_accvgpr_read_b32 v127, a58
    v_mul_f32 v127, v127, v126
    v_accvgpr_write_b32 a58, v127
    v_accvgpr_read_b32 v127, a59
    v_mul_f32 v127, v127, v126
    v_accvgpr_write_b32 a59, v127
    v_accvgpr_read_b32 v127, a60
    v_mul_f32 v127, v127, v126
    v_accvgpr_write_b32 a60, v127
    v_accvgpr_read_b32 v127, a61
    v_mul_f32 v127, v127, v126
    v_accvgpr_write_b32 a61, v127
    v_accvgpr_read_b32 v127, a62
    v_mul_f32 v127, v127, v126
    v_accvgpr_write_b32 a62, v127
    v_accvgpr_read_b32 v127, a63
    v_mul_f32 v127, v127, v126
    v_accvgpr_write_b32 a63, v127
    v_mov_b32 v126, v122
    s_nop 1
    v_permlane16_swap_b32 v122, v126
    v_max_f32 v122, v122, v126
    v_mov_b32 v126, v122
    s_nop 1
    v_permlane32_swap_b32 v122, v126
    v_max_f32 v122, v122, v126
    v_cmp_eq_f32 vcc, 0, v100
    v_max_f32 v126, 0, v122
    s_nop 0
    v_cndmask_b32 v122, v126, v122, vcc
    v_sub_f32 v40, v40, v122
    v_sub_f32 v41, v41, v122
    v_sub_f32 v42, v42, v122
    v_sub_f32 v43, v43, v122
    v_sub_f32 v44, v44, v122
    v_sub_f32 v45, v45, v122
    v_sub_f32 v46, v46, v122
    v_sub_f32 v47, v47, v122
    v_sub_f32 v80, v80, v122
    v_sub_f32 v81, v81, v122
    v_sub_f32 v82, v82, v122
    v_sub_f32 v83, v83, v122
    v_exp_f32 v126, -v126
    s_nop 0
    v_mul_f32 v100, v100, v126
    v_mul_f32 v101, v101, v126
    v_mul_f32 v102, v102, v126
    v_mul_f32 v103, v103, v126
    v_accvgpr_read_b32 v127, a64
    v_mul_f32 v127, v127, v126
    v_accvgpr_write_b32 a64, v127
    v_accvgpr_read_b32 v127, a65
    v_mul_f32 v127, v127, v126
    v_accvgpr_write_b32 a65, v127
    v_accvgpr_read_b32 v127, a66
    v_mul_f32 v127, v127, v126
    v_accvgpr_write_b32 a66, v127
    v_accvgpr_read_b32 v127, a67
    v_mul_f32 v127, v127, v126
    v_accvgpr_write_b32 a67, v127
    v_accvgpr_read_b32 v127, a68
    v_mul_f32 v127, v127, v126
    v_accvgpr_write_b32 a68, v127
    v_accvgpr_read_b32 v127, a69
    v_mul_f32 v127, v127, v126
    v_accvgpr_write_b32 a69, v127
    v_accvgpr_read_b32 v127, a70
    v_mul_f32 v127, v127, v126
    v_accvgpr_write_b32 a70, v127
    v_accvgpr_read_b32 v127, a71
    v_mul_f32 v127, v127, v126
    v_accvgpr_write_b32 a71, v127
    v_accvgpr_read_b32 v127, a72
    v_mul_f32 v127, v127, v126
    v_accvgpr_write_b32 a72, v127
    v_accvgpr_read_b32 v127, a73
    v_mul_f32 v127, v127, v126
    v_accvgpr_write_b32 a73, v127
    v_accvgpr_read_b32 v127, a74
    v_mul_f32 v127, v127, v126
    v_accvgpr_write_b32 a74, v127
    v_accvgpr_read_b32 v127, a75
    v_mul_f32 v127, v127, v126
    v_accvgpr_write_b32 a75, v127
    v_accvgpr_read_b32 v127, a76
    v_mul_f32 v127, v127, v126
    v_accvgpr_write_b32 a76, v127
    v_accvgpr_read_b32 v127, a77
    v_mul_f32 v127, v127, v126
    v_accvgpr_write_b32 a77, v127
    v_accvgpr_read_b32 v127, a78
    v_mul_f32 v127, v127, v126
    v_accvgpr_write_b32 a78, v127
    v_accvgpr_read_b32 v127, a79
    v_mul_f32 v127, v127, v126
    v_accvgpr_write_b32 a79, v127
    v_accvgpr_read_b32 v127, a80
    v_mul_f32 v127, v127, v126
    v_accvgpr_write_b32 a80, v127
    v_accvgpr_read_b32 v127, a81
    v_mul_f32 v127, v127, v126
    v_accvgpr_write_b32 a81, v127
    v_accvgpr_read_b32 v127, a82
    v_mul_f32 v127, v127, v126
    v_accvgpr_write_b32 a82, v127
    v_accvgpr_read_b32 v127, a83
    v_mul_f32 v127, v127, v126
    v_accvgpr_write_b32 a83, v127
    v_accvgpr_read_b32 v127, a84
    v_mul_f32 v127, v127, v126
    v_accvgpr_write_b32 a84, v127
    v_accvgpr_read_b32 v127, a85
    v_mul_f32 v127, v127, v126
    v_accvgpr_write_b32 a85, v127
    v_accvgpr_read_b32 v127, a86
    v_mul_f32 v127, v127, v126
    v_accvgpr_write_b32 a86, v127
    v_accvgpr_read_b32 v127, a87
    v_mul_f32 v127, v127, v126
    v_accvgpr_write_b32 a87, v127
    v_accvgpr_read_b32 v127, a88
    v_mul_f32 v127, v127, v126
    v_accvgpr_write_b32 a88, v127
    v_accvgpr_read_b32 v127, a89
    v_mul_f32 v127, v127, v126
    v_accvgpr_write_b32 a89, v127
    v_accvgpr_read_b32 v127, a90
    v_mul_f32 v127, v127, v126
    v_accvgpr_write_b32 a90, v127
    v_accvgpr_read_b32 v127, a91
    v_mul_f32 v127, v127, v126
    v_accvgpr_write_b32 a91, v127
    v_accvgpr_read_b32 v127, a92
    v_mul_f32 v127, v127, v126
    v_accvgpr_write_b32 a92, v127
    v_accvgpr_read_b32 v127, a93
    v_mul_f32 v127, v127, v126
    v_accvgpr_write_b32 a93, v127
    v_accvgpr_read_b32 v127, a94
    v_mul_f32 v127, v127, v126
    v_accvgpr_write_b32 a94, v127
    v_accvgpr_read_b32 v127, a95
    v_mul_f32 v127, v127, v126
    v_accvgpr_write_b32 a95, v127
    v_mov_b32 v126, v123
    s_nop 1
    v_permlane16_swap_b32 v123, v126
    v_max_f32 v123, v123, v126
    v_mov_b32 v126, v123
    s_nop 1
    v_permlane32_swap_b32 v123, v126
    v_max_f32 v123, v123, v126
    v_cmp_eq_f32 vcc, 0, v104
    v_max_f32 v126, 0, v123
    s_nop 0
    v_cndmask_b32 v123, v126, v123, vcc
    v_sub_f32 v56, v56, v123
    v_sub_f32 v57, v57, v123
    v_sub_f32 v58, v58, v123
    v_sub_f32 v59, v59, v123
    v_sub_f32 v60, v60, v123
    v_sub_f32 v61, v61, v123
    v_sub_f32 v62, v62, v123
    v_sub_f32 v63, v63, v123
    v_sub_f32 v84, v84, v123
    v_sub_f32 v85, v85, v123
    v_sub_f32 v86, v86, v123
    v_sub_f32 v87, v87, v123
    v_exp_f32 v126, -v126
    s_nop 0
    v_mul_f32 v104, v104, v126
    v_mul_f32 v105, v105, v126
    v_mul_f32 v106, v106, v126
    v_mul_f32 v107, v107, v126
    v_accvgpr_read_b32 v127, a96
    v_mul_f32 v127, v127, v126
    v_accvgpr_write_b32 a96, v127
    v_accvgpr_read_b32 v127, a97
    v_mul_f32 v127, v127, v126
    v_accvgpr_write_b32 a97, v127
    v_accvgpr_read_b32 v127, a98
    v_mul_f32 v127, v127, v126
    v_accvgpr_write_b32 a98, v127
    v_accvgpr_read_b32 v127, a99
    v_mul_f32 v127, v127, v126
    v_accvgpr_write_b32 a99, v127
    v_accvgpr_read_b32 v127, a100
    v_mul_f32 v127, v127, v126
    v_accvgpr_write_b32 a100, v127
    v_accvgpr_read_b32 v127, a101
    v_mul_f32 v127, v127, v126
    v_accvgpr_write_b32 a101, v127
    v_accvgpr_read_b32 v127, a102
    v_mul_f32 v127, v127, v126
    v_accvgpr_write_b32 a102, v127
    v_accvgpr_read_b32 v127, a103
    v_mul_f32 v127, v127, v126
    v_accvgpr_write_b32 a103, v127
    v_accvgpr_read_b32 v127, a104
    v_mul_f32 v127, v127, v126
    v_accvgpr_write_b32 a104, v127
    v_accvgpr_read_b32 v127, a105
    v_mul_f32 v127, v127, v126
    v_accvgpr_write_b32 a105, v127
    v_accvgpr_read_b32 v127, a106
    v_mul_f32 v127, v127, v126
    v_accvgpr_write_b32 a106, v127
    v_accvgpr_read_b32 v127, a107
    v_mul_f32 v127, v127, v126
    v_accvgpr_write_b32 a107, v127
    v_accvgpr_read_b32 v127, a108
    v_mul_f32 v127, v127, v126
    v_accvgpr_write_b32 a108, v127
    v_accvgpr_read_b32 v127, a109
    v_mul_f32 v127, v127, v126
    v_accvgpr_write_b32 a109, v127
    v_accvgpr_read_b32 v127, a110
    v_mul_f32 v127, v127, v126
    v_accvgpr_write_b32 a110, v127
    v_accvgpr_read_b32 v127, a111
    v_mul_f32 v127, v127, v126
    v_accvgpr_write_b32 a111, v127
    v_accvgpr_read_b32 v127, a112
    v_mul_f32 v127, v127, v126
    v_accvgpr_write_b32 a112, v127
    v_accvgpr_read_b32 v127, a113
    v_mul_f32 v127, v127, v126
    v_accvgpr_write_b32 a113, v127
    v_accvgpr_read_b32 v127, a114
    v_mul_f32 v127, v127, v126
    v_accvgpr_write_b32 a114, v127
    v_accvgpr_read_b32 v127, a115
    v_mul_f32 v127, v127, v126
    v_accvgpr_write_b32 a115, v127
    v_accvgpr_read_b32 v127, a116
    v_mul_f32 v127, v127, v126
    v_accvgpr_write_b32 a116, v127
    v_accvgpr_read_b32 v127, a117
    v_mul_f32 v127, v127, v126
    v_accvgpr_write_b32 a117, v127
    v_accvgpr_read_b32 v127, a118
    v_mul_f32 v127, v127, v126
    v_accvgpr_write_b32 a118, v127
    v_accvgpr_read_b32 v127, a119
    v_mul_f32 v127, v127, v126
    v_accvgpr_write_b32 a119, v127
    v_accvgpr_read_b32 v127, a120
    v_mul_f32 v127, v127, v126
    v_accvgpr_write_b32 a120, v127
    v_accvgpr_read_b32 v127, a121
    v_mul_f32 v127, v127, v126
    v_accvgpr_write_b32 a121, v127
    v_accvgpr_read_b32 v127, a122
    v_mul_f32 v127, v127, v126
    v_accvgpr_write_b32 a122, v127
    v_accvgpr_read_b32 v127, a123
    v_mul_f32 v127, v127, v126
    v_accvgpr_write_b32 a123, v127
    v_accvgpr_read_b32 v127, a124
    v_mul_f32 v127, v127, v126
    v_accvgpr_write_b32 a124, v127
    v_accvgpr_read_b32 v127, a125
    v_mul_f32 v127, v127, v126
    v_accvgpr_write_b32 a125, v127
    v_accvgpr_read_b32 v127, a126
    v_mul_f32 v127, v127, v126
    v_accvgpr_write_b32 a126, v127
    v_accvgpr_read_b32 v127, a127
    v_mul_f32 v127, v127, v126
    v_accvgpr_write_b32 a127, v127
    s_nop 3
    s_branch attn_kernel_n11
attn_kernel_n12:
    s_nop 7
    v_mov_b32 v126, v120
    s_nop 1
    v_permlane16_swap_b32 v120, v126
    v_max_f32 v120, v120, v126
    v_mov_b32 v126, v120
    s_nop 1
    v_permlane32_swap_b32 v120, v126
    v_max_f32 v120, v120, v126
    v_cmp_eq_f32 vcc, 0, v92
    v_max_f32 v126, 0, v120
    s_nop 0
    v_cndmask_b32 v120, v126, v120, vcc
    v_sub_f32 v0, v0, v120
    v_sub_f32 v1, v1, v120
    v_sub_f32 v2, v2, v120
    v_sub_f32 v3, v3, v120
    v_sub_f32 v4, v4, v120
    v_sub_f32 v5, v5, v120
    v_sub_f32 v6, v6, v120
    v_sub_f32 v7, v7, v120
    v_sub_f32 v72, v72, v120
    v_sub_f32 v73, v73, v120
    v_sub_f32 v74, v74, v120
    v_sub_f32 v75, v75, v120
    v_exp_f32 v126, -v126
    s_nop 0
    v_mul_f32 v92, v92, v126
    v_mul_f32 v93, v93, v126
    v_mul_f32 v94, v94, v126
    v_mul_f32 v95, v95, v126
    v_accvgpr_read_b32 v127, a0
    v_mul_f32 v127, v127, v126
    v_accvgpr_write_b32 a0, v127
    v_accvgpr_read_b32 v127, a1
    v_mul_f32 v127, v127, v126
    v_accvgpr_write_b32 a1, v127
    v_accvgpr_read_b32 v127, a2
    v_mul_f32 v127, v127, v126
    v_accvgpr_write_b32 a2, v127
    v_accvgpr_read_b32 v127, a3
    v_mul_f32 v127, v127, v126
    v_accvgpr_write_b32 a3, v127
    v_accvgpr_read_b32 v127, a4
    v_mul_f32 v127, v127, v126
    v_accvgpr_write_b32 a4, v127
    v_accvgpr_read_b32 v127, a5
    v_mul_f32 v127, v127, v126
    v_accvgpr_write_b32 a5, v127
    v_accvgpr_read_b32 v127, a6
    v_mul_f32 v127, v127, v126
    v_accvgpr_write_b32 a6, v127
    v_accvgpr_read_b32 v127, a7
    v_mul_f32 v127, v127, v126
    v_accvgpr_write_b32 a7, v127
    v_accvgpr_read_b32 v127, a8
    v_mul_f32 v127, v127, v126
    v_accvgpr_write_b32 a8, v127
    v_accvgpr_read_b32 v127, a9
    v_mul_f32 v127, v127, v126
    v_accvgpr_write_b32 a9, v127
    v_accvgpr_read_b32 v127, a10
    v_mul_f32 v127, v127, v126
    v_accvgpr_write_b32 a10, v127
    v_accvgpr_read_b32 v127, a11
    v_mul_f32 v127, v127, v126
    v_accvgpr_write_b32 a11, v127
    v_accvgpr_read_b32 v127, a12
    v_mul_f32 v127, v127, v126
    v_accvgpr_write_b32 a12, v127
    v_accvgpr_read_b32 v127, a13
    v_mul_f32 v127, v127, v126
    v_accvgpr_write_b32 a13, v127
    v_accvgpr_read_b32 v127, a14
    v_mul_f32 v127, v127, v126
    v_accvgpr_write_b32 a14, v127
    v_accvgpr_read_b32 v127, a15
    v_mul_f32 v127, v127, v126
    v_accvgpr_write_b32 a15, v127
    v_accvgpr_read_b32 v127, a16
    v_mul_f32 v127, v127, v126
    v_accvgpr_write_b32 a16, v127
    v_accvgpr_read_b32 v127, a17
    v_mul_f32 v127, v127, v126
    v_accvgpr_write_b32 a17, v127
    v_accvgpr_read_b32 v127, a18
    v_mul_f32 v127, v127, v126
    v_accvgpr_write_b32 a18, v127
    v_accvgpr_read_b32 v127, a19
    v_mul_f32 v127, v127, v126
    v_accvgpr_write_b32 a19, v127
    v_accvgpr_read_b32 v127, a20
    v_mul_f32 v127, v127, v126
    v_accvgpr_write_b32 a20, v127
    v_accvgpr_read_b32 v127, a21
    v_mul_f32 v127, v127, v126
    v_accvgpr_write_b32 a21, v127
    v_accvgpr_read_b32 v127, a22
    v_mul_f32 v127, v127, v126
    v_accvgpr_write_b32 a22, v127
    v_accvgpr_read_b32 v127, a23
    v_mul_f32 v127, v127, v126
    v_accvgpr_write_b32 a23, v127
    v_accvgpr_read_b32 v127, a24
    v_mul_f32 v127, v127, v126
    v_accvgpr_write_b32 a24, v127
    v_accvgpr_read_b32 v127, a25
    v_mul_f32 v127, v127, v126
    v_accvgpr_write_b32 a25, v127
    v_accvgpr_read_b32 v127, a26
    v_mul_f32 v127, v127, v126
    v_accvgpr_write_b32 a26, v127
    v_accvgpr_read_b32 v127, a27
    v_mul_f32 v127, v127, v126
    v_accvgpr_write_b32 a27, v127
    v_accvgpr_read_b32 v127, a28
    v_mul_f32 v127, v127, v126
    v_accvgpr_write_b32 a28, v127
    v_accvgpr_read_b32 v127, a29
    v_mul_f32 v127, v127, v126
    v_accvgpr_write_b32 a29, v127
    v_accvgpr_read_b32 v127, a30
    v_mul_f32 v127, v127, v126
    v_accvgpr_write_b32 a30, v127
    v_accvgpr_read_b32 v127, a31
    v_mul_f32 v127, v127, v126
    v_accvgpr_write_b32 a31, v127
    v_mov_b32 v126, v121
    s_nop 1
    v_permlane16_swap_b32 v121, v126
    v_max_f32 v121, v121, v126
    v_mov_b32 v126, v121
    s_nop 1
    v_permlane32_swap_b32 v121, v126
    v_max_f32 v121, v121, v126
    v_cmp_eq_f32 vcc, 0, v96
    v_max_f32 v126, 0, v121
    s_nop 0
    v_cndmask_b32 v121, v126, v121, vcc
    v_sub_f32 v16, v16, v121
    v_sub_f32 v17, v17, v121
    v_sub_f32 v18, v18, v121
    v_sub_f32 v19, v19, v121
    v_sub_f32 v20, v20, v121
    v_sub_f32 v21, v21, v121
    v_sub_f32 v22, v22, v121
    v_sub_f32 v23, v23, v121
    v_sub_f32 v76, v76, v121
    v_sub_f32 v77, v77, v121
    v_sub_f32 v78, v78, v121
    v_sub_f32 v79, v79, v121
    v_exp_f32 v126, -v126
    s_nop 0
    v_mul_f32 v96, v96, v126
    v_mul_f32 v97, v97, v126
    v_mul_f32 v98, v98, v126
    v_mul_f32 v99, v99, v126
    v_accvgpr_read_b32 v127, a32
    v_mul_f32 v127, v127, v126
    v_accvgpr_write_b32 a32, v127
    v_accvgpr_read_b32 v127, a33
    v_mul_f32 v127, v127, v126
    v_accvgpr_write_b32 a33, v127
    v_accvgpr_read_b32 v127, a34
    v_mul_f32 v127, v127, v126
    v_accvgpr_write_b32 a34, v127
    v_accvgpr_read_b32 v127, a35
    v_mul_f32 v127, v127, v126
    v_accvgpr_write_b32 a35, v127
    v_accvgpr_read_b32 v127, a36
    v_mul_f32 v127, v127, v126
    v_accvgpr_write_b32 a36, v127
    v_accvgpr_read_b32 v127, a37
    v_mul_f32 v127, v127, v126
    v_accvgpr_write_b32 a37, v127
    v_accvgpr_read_b32 v127, a38
    v_mul_f32 v127, v127, v126
    v_accvgpr_write_b32 a38, v127
    v_accvgpr_read_b32 v127, a39
    v_mul_f32 v127, v127, v126
    v_accvgpr_write_b32 a39, v127
    v_accvgpr_read_b32 v127, a40
    v_mul_f32 v127, v127, v126
    v_accvgpr_write_b32 a40, v127
    v_accvgpr_read_b32 v127, a41
    v_mul_f32 v127, v127, v126
    v_accvgpr_write_b32 a41, v127
    v_accvgpr_read_b32 v127, a42
    v_mul_f32 v127, v127, v126
    v_accvgpr_write_b32 a42, v127
    v_accvgpr_read_b32 v127, a43
    v_mul_f32 v127, v127, v126
    v_accvgpr_write_b32 a43, v127
    v_accvgpr_read_b32 v127, a44
    v_mul_f32 v127, v127, v126
    v_accvgpr_write_b32 a44, v127
    v_accvgpr_read_b32 v127, a45
    v_mul_f32 v127, v127, v126
    v_accvgpr_write_b32 a45, v127
    v_accvgpr_read_b32 v127, a46
    v_mul_f32 v127, v127, v126
    v_accvgpr_write_b32 a46, v127
    v_accvgpr_read_b32 v127, a47
    v_mul_f32 v127, v127, v126
    v_accvgpr_write_b32 a47, v127
    v_accvgpr_read_b32 v127, a48
    v_mul_f32 v127, v127, v126
    v_accvgpr_write_b32 a48, v127
    v_accvgpr_read_b32 v127, a49
    v_mul_f32 v127, v127, v126
    v_accvgpr_write_b32 a49, v127
    v_accvgpr_read_b32 v127, a50
    v_mul_f32 v127, v127, v126
    v_accvgpr_write_b32 a50, v127
    v_accvgpr_read_b32 v127, a51
    v_mul_f32 v127, v127, v126
    v_accvgpr_write_b32 a51, v127
    v_accvgpr_read_b32 v127, a52
    v_mul_f32 v127, v127, v126
    v_accvgpr_write_b32 a52, v127
    v_accvgpr_read_b32 v127, a53
    v_mul_f32 v127, v127, v126
    v_accvgpr_write_b32 a53, v127
    v_accvgpr_read_b32 v127, a54
    v_mul_f32 v127, v127, v126
    v_accvgpr_write_b32 a54, v127
    v_accvgpr_read_b32 v127, a55
    v_mul_f32 v127, v127, v126
    v_accvgpr_write_b32 a55, v127
    v_accvgpr_read_b32 v127, a56
    v_mul_f32 v127, v127, v126
    v_accvgpr_write_b32 a56, v127
    v_accvgpr_read_b32 v127, a57
    v_mul_f32 v127, v127, v126
    v_accvgpr_write_b32 a57, v127
    v_accvgpr_read_b32 v127, a58
    v_mul_f32 v127, v127, v126
    v_accvgpr_write_b32 a58, v127
    v_accvgpr_read_b32 v127, a59
    v_mul_f32 v127, v127, v126
    v_accvgpr_write_b32 a59, v127
    v_accvgpr_read_b32 v127, a60
    v_mul_f32 v127, v127, v126
    v_accvgpr_write_b32 a60, v127
    v_accvgpr_read_b32 v127, a61
    v_mul_f32 v127, v127, v126
    v_accvgpr_write_b32 a61, v127
    v_accvgpr_read_b32 v127, a62
    v_mul_f32 v127, v127, v126
    v_accvgpr_write_b32 a62, v127
    v_accvgpr_read_b32 v127, a63
    v_mul_f32 v127, v127, v126
    v_accvgpr_write_b32 a63, v127
    v_mov_b32 v126, v122
    s_nop 1
    v_permlane16_swap_b32 v122, v126
    v_max_f32 v122, v122, v126
    v_mov_b32 v126, v122
    s_nop 1
    v_permlane32_swap_b32 v122, v126
    v_max_f32 v122, v122, v126
    v_cmp_eq_f32 vcc, 0, v100
    v_max_f32 v126, 0, v122
    s_nop 0
    v_cndmask_b32 v122, v126, v122, vcc
    v_sub_f32 v32, v32, v122
    v_sub_f32 v33, v33, v122
    v_sub_f32 v34, v34, v122
    v_sub_f32 v35, v35, v122
    v_sub_f32 v36, v36, v122
    v_sub_f32 v37, v37, v122
    v_sub_f32 v38, v38, v122
    v_sub_f32 v39, v39, v122
    v_sub_f32 v80, v80, v122
    v_sub_f32 v81, v81, v122
    v_sub_f32 v82, v82, v122
    v_sub_f32 v83, v83, v122
    v_exp_f32 v126, -v126
    s_nop 0
    v_mul_f32 v100, v100, v126
    v_mul_f32 v101, v101, v126
    v_mul_f32 v102, v102, v126
    v_mul_f32 v103, v103, v126
    v_accvgpr_read_b32 v127, a64
    v_mul_f32 v127, v127, v126
    v_accvgpr_write_b32 a64, v127
    v_accvgpr_read_b32 v127, a65
    v_mul_f32 v127, v127, v126
    v_accvgpr_write_b32 a65, v127
    v_accvgpr_read_b32 v127, a66
    v_mul_f32 v127, v127, v126
    v_accvgpr_write_b32 a66, v127
    v_accvgpr_read_b32 v127, a67
    v_mul_f32 v127, v127, v126
    v_accvgpr_write_b32 a67, v127
    v_accvgpr_read_b32 v127, a68
    v_mul_f32 v127, v127, v126
    v_accvgpr_write_b32 a68, v127
    v_accvgpr_read_b32 v127, a69
    v_mul_f32 v127, v127, v126
    v_accvgpr_write_b32 a69, v127
    v_accvgpr_read_b32 v127, a70
    v_mul_f32 v127, v127, v126
    v_accvgpr_write_b32 a70, v127
    v_accvgpr_read_b32 v127, a71
    v_mul_f32 v127, v127, v126
    v_accvgpr_write_b32 a71, v127
    v_accvgpr_read_b32 v127, a72
    v_mul_f32 v127, v127, v126
    v_accvgpr_write_b32 a72, v127
    v_accvgpr_read_b32 v127, a73
    v_mul_f32 v127, v127, v126
    v_accvgpr_write_b32 a73, v127
    v_accvgpr_read_b32 v127, a74
    v_mul_f32 v127, v127, v126
    v_accvgpr_write_b32 a74, v127
    v_accvgpr_read_b32 v127, a75
    v_mul_f32 v127, v127, v126
    v_accvgpr_write_b32 a75, v127
    v_accvgpr_read_b32 v127, a76
    v_mul_f32 v127, v127, v126
    v_accvgpr_write_b32 a76, v127
    v_accvgpr_read_b32 v127, a77
    v_mul_f32 v127, v127, v126
    v_accvgpr_write_b32 a77, v127
    v_accvgpr_read_b32 v127, a78
    v_mul_f32 v127, v127, v126
    v_accvgpr_write_b32 a78, v127
    v_accvgpr_read_b32 v127, a79
    v_mul_f32 v127, v127, v126
    v_accvgpr_write_b32 a79, v127
    v_accvgpr_read_b32 v127, a80
    v_mul_f32 v127, v127, v126
    v_accvgpr_write_b32 a80, v127
    v_accvgpr_read_b32 v127, a81
    v_mul_f32 v127, v127, v126
    v_accvgpr_write_b32 a81, v127
    v_accvgpr_read_b32 v127, a82
    v_mul_f32 v127, v127, v126
    v_accvgpr_write_b32 a82, v127
    v_accvgpr_read_b32 v127, a83
    v_mul_f32 v127, v127, v126
    v_accvgpr_write_b32 a83, v127
    v_accvgpr_read_b32 v127, a84
    v_mul_f32 v127, v127, v126
    v_accvgpr_write_b32 a84, v127
    v_accvgpr_read_b32 v127, a85
    v_mul_f32 v127, v127, v126
    v_accvgpr_write_b32 a85, v127
    v_accvgpr_read_b32 v127, a86
    v_mul_f32 v127, v127, v126
    v_accvgpr_write_b32 a86, v127
    v_accvgpr_read_b32 v127, a87
    v_mul_f32 v127, v127, v126
    v_accvgpr_write_b32 a87, v127
    v_accvgpr_read_b32 v127, a88
    v_mul_f32 v127, v127, v126
    v_accvgpr_write_b32 a88, v127
    v_accvgpr_read_b32 v127, a89
    v_mul_f32 v127, v127, v126
    v_accvgpr_write_b32 a89, v127
    v_accvgpr_read_b32 v127, a90
    v_mul_f32 v127, v127, v126
    v_accvgpr_write_b32 a90, v127
    v_accvgpr_read_b32 v127, a91
    v_mul_f32 v127, v127, v126
    v_accvgpr_write_b32 a91, v127
    v_accvgpr_read_b32 v127, a92
    v_mul_f32 v127, v127, v126
    v_accvgpr_write_b32 a92, v127
    v_accvgpr_read_b32 v127, a93
    v_mul_f32 v127, v127, v126
    v_accvgpr_write_b32 a93, v127
    v_accvgpr_read_b32 v127, a94
    v_mul_f32 v127, v127, v126
    v_accvgpr_write_b32 a94, v127
    v_accvgpr_read_b32 v127, a95
    v_mul_f32 v127, v127, v126
    v_accvgpr_write_b32 a95, v127
    v_mov_b32 v126, v123
    s_nop 1
    v_permlane16_swap_b32 v123, v126
    v_max_f32 v123, v123, v126
    v_mov_b32 v126, v123
    s_nop 1
    v_permlane32_swap_b32 v123, v126
    v_max_f32 v123, v123, v126
    v_cmp_eq_f32 vcc, 0, v104
    v_max_f32 v126, 0, v123
    s_nop 0
    v_cndmask_b32 v123, v126, v123, vcc
    v_sub_f32 v48, v48, v123
    v_sub_f32 v49, v49, v123
    v_sub_f32 v50, v50, v123
    v_sub_f32 v51, v51, v123
    v_sub_f32 v52, v52, v123
    v_sub_f32 v53, v53, v123
    v_sub_f32 v54, v54, v123
    v_sub_f32 v55, v55, v123
    v_sub_f32 v84, v84, v123
    v_sub_f32 v85, v85, v123
    v_sub_f32 v86, v86, v123
    v_sub_f32 v87, v87, v123
    v_exp_f32 v126, -v126
    s_nop 0
    v_mul_f32 v104, v104, v126
    v_mul_f32 v105, v105, v126
    v_mul_f32 v106, v106, v126
    v_mul_f32 v107, v107, v126
    v_accvgpr_read_b32 v127, a96
    v_mul_f32 v127, v127, v126
    v_accvgpr_write_b32 a96, v127
    v_accvgpr_read_b32 v127, a97
    v_mul_f32 v127, v127, v126
    v_accvgpr_write_b32 a97, v127
    v_accvgpr_read_b32 v127, a98
    v_mul_f32 v127, v127, v126
    v_accvgpr_write_b32 a98, v127
    v_accvgpr_read_b32 v127, a99
    v_mul_f32 v127, v127, v126
    v_accvgpr_write_b32 a99, v127
    v_accvgpr_read_b32 v127, a100
    v_mul_f32 v127, v127, v126
    v_accvgpr_write_b32 a100, v127
    v_accvgpr_read_b32 v127, a101
    v_mul_f32 v127, v127, v126
    v_accvgpr_write_b32 a101, v127
    v_accvgpr_read_b32 v127, a102
    v_mul_f32 v127, v127, v126
    v_accvgpr_write_b32 a102, v127
    v_accvgpr_read_b32 v127, a103
    v_mul_f32 v127, v127, v126
    v_accvgpr_write_b32 a103, v127
    v_accvgpr_read_b32 v127, a104
    v_mul_f32 v127, v127, v126
    v_accvgpr_write_b32 a104, v127
    v_accvgpr_read_b32 v127, a105
    v_mul_f32 v127, v127, v126
    v_accvgpr_write_b32 a105, v127
    v_accvgpr_read_b32 v127, a106
    v_mul_f32 v127, v127, v126
    v_accvgpr_write_b32 a106, v127
    v_accvgpr_read_b32 v127, a107
    v_mul_f32 v127, v127, v126
    v_accvgpr_write_b32 a107, v127
    v_accvgpr_read_b32 v127, a108
    v_mul_f32 v127, v127, v126
    v_accvgpr_write_b32 a108, v127
    v_accvgpr_read_b32 v127, a109
    v_mul_f32 v127, v127, v126
    v_accvgpr_write_b32 a109, v127
    v_accvgpr_read_b32 v127, a110
    v_mul_f32 v127, v127, v126
    v_accvgpr_write_b32 a110, v127
    v_accvgpr_read_b32 v127, a111
    v_mul_f32 v127, v127, v126
    v_accvgpr_write_b32 a111, v127
    v_accvgpr_read_b32 v127, a112
    v_mul_f32 v127, v127, v126
    v_accvgpr_write_b32 a112, v127
    v_accvgpr_read_b32 v127, a113
    v_mul_f32 v127, v127, v126
    v_accvgpr_write_b32 a113, v127
    v_accvgpr_read_b32 v127, a114
    v_mul_f32 v127, v127, v126
    v_accvgpr_write_b32 a114, v127
    v_accvgpr_read_b32 v127, a115
    v_mul_f32 v127, v127, v126
    v_accvgpr_write_b32 a115, v127
    v_accvgpr_read_b32 v127, a116
    v_mul_f32 v127, v127, v126
    v_accvgpr_write_b32 a116, v127
    v_accvgpr_read_b32 v127, a117
    v_mul_f32 v127, v127, v126
    v_accvgpr_write_b32 a117, v127
    v_accvgpr_read_b32 v127, a118
    v_mul_f32 v127, v127, v126
    v_accvgpr_write_b32 a118, v127
    v_accvgpr_read_b32 v127, a119
    v_mul_f32 v127, v127, v126
    v_accvgpr_write_b32 a119, v127
    v_accvgpr_read_b32 v127, a120
    v_mul_f32 v127, v127, v126
    v_accvgpr_write_b32 a120, v127
    v_accvgpr_read_b32 v127, a121
    v_mul_f32 v127, v127, v126
    v_accvgpr_write_b32 a121, v127
    v_accvgpr_read_b32 v127, a122
    v_mul_f32 v127, v127, v126
    v_accvgpr_write_b32 a122, v127
    v_accvgpr_read_b32 v127, a123
    v_mul_f32 v127, v127, v126
    v_accvgpr_write_b32 a123, v127
    v_accvgpr_read_b32 v127, a124
    v_mul_f32 v127, v127, v126
    v_accvgpr_write_b32 a124, v127
    v_accvgpr_read_b32 v127, a125
    v_mul_f32 v127, v127, v126
    v_accvgpr_write_b32 a125, v127
    v_accvgpr_read_b32 v127, a126
    v_mul_f32 v127, v127, v126
    v_accvgpr_write_b32 a126, v127
    v_accvgpr_read_b32 v127, a127
    v_mul_f32 v127, v127, v126
    v_accvgpr_write_b32 a127, v127
    v_mov_b32 v126, v124
    s_nop 1
    v_permlane16_swap_b32 v124, v126
    v_max_f32 v124, v124, v126
    v_mov_b32 v126, v124
    s_nop 1
    v_permlane32_swap_b32 v124, v126
    v_max_f32 v124, v124, v126
    v_cmp_eq_f32 vcc, 0, v108
    v_max_f32 v126, 0, v124
    s_nop 0
    v_cndmask_b32 v124, v126, v124, vcc
    v_sub_f32 v64, v64, v124
    v_sub_f32 v65, v65, v124
    v_sub_f32 v66, v66, v124
    v_sub_f32 v67, v67, v124
    v_sub_f32 v68, v68, v124
    v_sub_f32 v69, v69, v124
    v_sub_f32 v70, v70, v124
    v_sub_f32 v71, v71, v124
    v_sub_f32 v88, v88, v124
    v_sub_f32 v89, v89, v124
    v_sub_f32 v90, v90, v124
    v_sub_f32 v91, v91, v124
    v_exp_f32 v126, -v126
    s_nop 0
    v_mul_f32 v108, v108, v126
    v_mul_f32 v109, v109, v126
    v_mul_f32 v110, v110, v126
    v_mul_f32 v111, v111, v126
    v_accvgpr_read_b32 v127, a128
    v_mul_f32 v127, v127, v126
    v_accvgpr_write_b32 a128, v127
    v_accvgpr_read_b32 v127, a129
    v_mul_f32 v127, v127, v126
    v_accvgpr_write_b32 a129, v127
    v_accvgpr_read_b32 v127, a130
    v_mul_f32 v127, v127, v126
    v_accvgpr_write_b32 a130, v127
    v_accvgpr_read_b32 v127, a131
    v_mul_f32 v127, v127, v126
    v_accvgpr_write_b32 a131, v127
    v_accvgpr_read_b32 v127, a132
    v_mul_f32 v127, v127, v126
    v_accvgpr_write_b32 a132, v127
    v_accvgpr_read_b32 v127, a133
    v_mul_f32 v127, v127, v126
    v_accvgpr_write_b32 a133, v127
    v_accvgpr_read_b32 v127, a134
    v_mul_f32 v127, v127, v126
    v_accvgpr_write_b32 a134, v127
    v_accvgpr_read_b32 v127, a135
    v_mul_f32 v127, v127, v126
    v_accvgpr_write_b32 a135, v127
    v_accvgpr_read_b32 v127, a136
    v_mul_f32 v127, v127, v126
    v_accvgpr_write_b32 a136, v127
    v_accvgpr_read_b32 v127, a137
    v_mul_f32 v127, v127, v126
    v_accvgpr_write_b32 a137, v127
    v_accvgpr_read_b32 v127, a138
    v_mul_f32 v127, v127, v126
    v_accvgpr_write_b32 a138, v127
    v_accvgpr_read_b32 v127, a139
    v_mul_f32 v127, v127, v126
    v_accvgpr_write_b32 a139, v127
    v_accvgpr_read_b32 v127, a140
    v_mul_f32 v127, v127, v126
    v_accvgpr_write_b32 a140, v127
    v_accvgpr_read_b32 v127, a141
    v_mul_f32 v127, v127, v126
    v_accvgpr_write_b32 a141, v127
    v_accvgpr_read_b32 v127, a142
    v_mul_f32 v127, v127, v126
    v_accvgpr_write_b32 a142, v127
    v_accvgpr_read_b32 v127, a143
    v_mul_f32 v127, v127, v126
    v_accvgpr_write_b32 a143, v127
    v_accvgpr_read_b32 v127, a144
    v_mul_f32 v127, v127, v126
    v_accvgpr_write_b32 a144, v127
    v_accvgpr_read_b32 v127, a145
    v_mul_f32 v127, v127, v126
    v_accvgpr_write_b32 a145, v127
    v_accvgpr_read_b32 v127, a146
    v_mul_f32 v127, v127, v126
    v_accvgpr_write_b32 a146, v127
    v_accvgpr_read_b32 v127, a147
    v_mul_f32 v127, v127, v126
    v_accvgpr_write_b32 a147, v127
    v_accvgpr_read_b32 v127, a148
    v_mul_f32 v127, v127, v126
    v_accvgpr_write_b32 a148, v127
    v_accvgpr_read_b32 v127, a149
    v_mul_f32 v127, v127, v126
    v_accvgpr_write_b32 a149, v127
    v_accvgpr_read_b32 v127, a150
    v_mul_f32 v127, v127, v126
    v_accvgpr_write_b32 a150, v127
    v_accvgpr_read_b32 v127, a151
    v_mul_f32 v127, v127, v126
    v_accvgpr_write_b32 a151, v127
    v_accvgpr_read_b32 v127, a152
    v_mul_f32 v127, v127, v126
    v_accvgpr_write_b32 a152, v127
    v_accvgpr_read_b32 v127, a153
    v_mul_f32 v127, v127, v126
    v_accvgpr_write_b32 a153, v127
    v_accvgpr_read_b32 v127, a154
    v_mul_f32 v127, v127, v126
    v_accvgpr_write_b32 a154, v127
    v_accvgpr_read_b32 v127, a155
    v_mul_f32 v127, v127, v126
    v_accvgpr_write_b32 a155, v127
    v_accvgpr_read_b32 v127, a156
    v_mul_f32 v127, v127, v126
    v_accvgpr_write_b32 a156, v127
    v_accvgpr_read_b32 v127, a157
    v_mul_f32 v127, v127, v126
    v_accvgpr_write_b32 a157, v127
    v_accvgpr_read_b32 v127, a158
    v_mul_f32 v127, v127, v126
    v_accvgpr_write_b32 a158, v127
    v_accvgpr_read_b32 v127, a159
    v_mul_f32 v127, v127, v126
    v_accvgpr_write_b32 a159, v127
    s_nop 3
    s_branch attn_kernel_n13
attn_kernel_n14:
    s_nop 7
    v_mov_b32 v126, v120
    s_nop 1
    v_permlane16_swap_b32 v120, v126
    v_max_f32 v120, v120, v126
    v_mov_b32 v126, v120
    s_nop 1
    v_permlane32_swap_b32 v120, v126
    v_max_f32 v120, v120, v126
    v_cmp_eq_f32 vcc, 0, v92
    v_max_f32 v126, 0, v120
    s_nop 0
    v_cndmask_b32 v120, v126, v120, vcc
    v_sub_f32 v8, v8, v120
    v_sub_f32 v9, v9, v120
    v_sub_f32 v10, v10, v120
    v_sub_f32 v11, v11, v120
    v_sub_f32 v12, v12, v120
    v_sub_f32 v13, v13, v120
    v_sub_f32 v14, v14, v120
    v_sub_f32 v15, v15, v120
    v_sub_f32 v72, v72, v120
    v_sub_f32 v73, v73, v120
    v_sub_f32 v74, v74, v120
    v_sub_f32 v75, v75, v120
    v_exp_f32 v126, -v126
    s_nop 0
    v_mul_f32 v92, v92, v126
    v_mul_f32 v93, v93, v126
    v_mul_f32 v94, v94, v126
    v_mul_f32 v95, v95, v126
    v_accvgpr_read_b32 v127, a0
    v_mul_f32 v127, v127, v126
    v_accvgpr_write_b32 a0, v127
    v_accvgpr_read_b32 v127, a1
    v_mul_f32 v127, v127, v126
    v_accvgpr_write_b32 a1, v127
    v_accvgpr_read_b32 v127, a2
    v_mul_f32 v127, v127, v126
    v_accvgpr_write_b32 a2, v127
    v_accvgpr_read_b32 v127, a3
    v_mul_f32 v127, v127, v126
    v_accvgpr_write_b32 a3, v127
    v_accvgpr_read_b32 v127, a4
    v_mul_f32 v127, v127, v126
    v_accvgpr_write_b32 a4, v127
    v_accvgpr_read_b32 v127, a5
    v_mul_f32 v127, v127, v126
    v_accvgpr_write_b32 a5, v127
    v_accvgpr_read_b32 v127, a6
    v_mul_f32 v127, v127, v126
    v_accvgpr_write_b32 a6, v127
    v_accvgpr_read_b32 v127, a7
    v_mul_f32 v127, v127, v126
    v_accvgpr_write_b32 a7, v127
    v_accvgpr_read_b32 v127, a8
    v_mul_f32 v127, v127, v126
    v_accvgpr_write_b32 a8, v127
    v_accvgpr_read_b32 v127, a9
    v_mul_f32 v127, v127, v126
    v_accvgpr_write_b32 a9, v127
    v_accvgpr_read_b32 v127, a10
    v_mul_f32 v127, v127, v126
    v_accvgpr_write_b32 a10, v127
    v_accvgpr_read_b32 v127, a11
    v_mul_f32 v127, v127, v126
    v_accvgpr_write_b32 a11, v127
    v_accvgpr_read_b32 v127, a12
    v_mul_f32 v127, v127, v126
    v_accvgpr_write_b32 a12, v127
    v_accvgpr_read_b32 v127, a13
    v_mul_f32 v127, v127, v126
    v_accvgpr_write_b32 a13, v127
    v_accvgpr_read_b32 v127, a14
    v_mul_f32 v127, v127, v126
    v_accvgpr_write_b32 a14, v127
    v_accvgpr_read_b32 v127, a15
    v_mul_f32 v127, v127, v126
    v_accvgpr_write_b32 a15, v127
    v_accvgpr_read_b32 v127, a16
    v_mul_f32 v127, v127, v126
    v_accvgpr_write_b32 a16, v127
    v_accvgpr_read_b32 v127, a17
    v_mul_f32 v127, v127, v126
    v_accvgpr_write_b32 a17, v127
    v_accvgpr_read_b32 v127, a18
    v_mul_f32 v127, v127, v126
    v_accvgpr_write_b32 a18, v127
    v_accvgpr_read_b32 v127, a19
    v_mul_f32 v127, v127, v126
    v_accvgpr_write_b32 a19, v127
    v_accvgpr_read_b32 v127, a20
    v_mul_f32 v127, v127, v126
    v_accvgpr_write_b32 a20, v127
    v_accvgpr_read_b32 v127, a21
    v_mul_f32 v127, v127, v126
    v_accvgpr_write_b32 a21, v127
    v_accvgpr_read_b32 v127, a22
    v_mul_f32 v127, v127, v126
    v_accvgpr_write_b32 a22, v127
    v_accvgpr_read_b32 v127, a23
    v_mul_f32 v127, v127, v126
    v_accvgpr_write_b32 a23, v127
    v_accvgpr_read_b32 v127, a24
    v_mul_f32 v127, v127, v126
    v_accvgpr_write_b32 a24, v127
    v_accvgpr_read_b32 v127, a25
    v_mul_f32 v127, v127, v126
    v_accvgpr_write_b32 a25, v127
    v_accvgpr_read_b32 v127, a26
    v_mul_f32 v127, v127, v126
    v_accvgpr_write_b32 a26, v127
    v_accvgpr_read_b32 v127, a27
    v_mul_f32 v127, v127, v126
    v_accvgpr_write_b32 a27, v127
    v_accvgpr_read_b32 v127, a28
    v_mul_f32 v127, v127, v126
    v_accvgpr_write_b32 a28, v127
    v_accvgpr_read_b32 v127, a29
    v_mul_f32 v127, v127, v126
    v_accvgpr_write_b32 a29, v127
    v_accvgpr_read_b32 v127, a30
    v_mul_f32 v127, v127, v126
    v_accvgpr_write_b32 a30, v127
    v_accvgpr_read_b32 v127, a31
    v_mul_f32 v127, v127, v126
    v_accvgpr_write_b32 a31, v127
    v_mov_b32 v126, v121
    s_nop 1
    v_permlane16_swap_b32 v121, v126
    v_max_f32 v121, v121, v126
    v_mov_b32 v126, v121
    s_nop 1
    v_permlane32_swap_b32 v121, v126
    v_max_f32 v121, v121, v126
    v_cmp_eq_f32 vcc, 0, v96
    v_max_f32 v126, 0, v121
    s_nop 0
    v_cndmask_b32 v121, v126, v121, vcc
    v_sub_f32 v24, v24, v121
    v_sub_f32 v25, v25, v121
    v_sub_f32 v26, v26, v121
    v_sub_f32 v27, v27, v121
    v_sub_f32 v28, v28, v121
    v_sub_f32 v29, v29, v121
    v_sub_f32 v30, v30, v121
    v_sub_f32 v31, v31, v121
    v_sub_f32 v76, v76, v121
    v_sub_f32 v77, v77, v121
    v_sub_f32 v78, v78, v121
    v_sub_f32 v79, v79, v121
    v_exp_f32 v126, -v126
    s_nop 0
    v_mul_f32 v96, v96, v126
    v_mul_f32 v97, v97, v126
    v_mul_f32 v98, v98, v126
    v_mul_f32 v99, v99, v126
    v_accvgpr_read_b32 v127, a32
    v_mul_f32 v127, v127, v126
    v_accvgpr_write_b32 a32, v127
    v_accvgpr_read_b32 v127, a33
    v_mul_f32 v127, v127, v126
    v_accvgpr_write_b32 a33, v127
    v_accvgpr_read_b32 v127, a34
    v_mul_f32 v127, v127, v126
    v_accvgpr_write_b32 a34, v127
    v_accvgpr_read_b32 v127, a35
    v_mul_f32 v127, v127, v126
    v_accvgpr_write_b32 a35, v127
    v_accvgpr_read_b32 v127, a36
    v_mul_f32 v127, v127, v126
    v_accvgpr_write_b32 a36, v127
    v_accvgpr_read_b32 v127, a37
    v_mul_f32 v127, v127, v126
    v_accvgpr_write_b32 a37, v127
    v_accvgpr_read_b32 v127, a38
    v_mul_f32 v127, v127, v126
    v_accvgpr_write_b32 a38, v127
    v_accvgpr_read_b32 v127, a39
    v_mul_f32 v127, v127, v126
    v_accvgpr_write_b32 a39, v127
    v_accvgpr_read_b32 v127, a40
    v_mul_f32 v127, v127, v126
    v_accvgpr_write_b32 a40, v127
    v_accvgpr_read_b32 v127, a41
    v_mul_f32 v127, v127, v126
    v_accvgpr_write_b32 a41, v127
    v_accvgpr_read_b32 v127, a42
    v_mul_f32 v127, v127, v126
    v_accvgpr_write_b32 a42, v127
    v_accvgpr_read_b32 v127, a43
    v_mul_f32 v127, v127, v126
    v_accvgpr_write_b32 a43, v127
    v_accvgpr_read_b32 v127, a44
    v_mul_f32 v127, v127, v126
    v_accvgpr_write_b32 a44, v127
    v_accvgpr_read_b32 v127, a45
    v_mul_f32 v127, v127, v126
    v_accvgpr_write_b32 a45, v127
    v_accvgpr_read_b32 v127, a46
    v_mul_f32 v127, v127, v126
    v_accvgpr_write_b32 a46, v127
    v_accvgpr_read_b32 v127, a47
    v_mul_f32 v127, v127, v126
    v_accvgpr_write_b32 a47, v127
    v_accvgpr_read_b32 v127, a48
    v_mul_f32 v127, v127, v126
    v_accvgpr_write_b32 a48, v127
    v_accvgpr_read_b32 v127, a49
    v_mul_f32 v127, v127, v126
    v_accvgpr_write_b32 a49, v127
    v_accvgpr_read_b32 v127, a50
    v_mul_f32 v127, v127, v126
    v_accvgpr_write_b32 a50, v127
    v_accvgpr_read_b32 v127, a51
    v_mul_f32 v127, v127, v126
    v_accvgpr_write_b32 a51, v127
    v_accvgpr_read_b32 v127, a52
    v_mul_f32 v127, v127, v126
    v_accvgpr_write_b32 a52, v127
    v_accvgpr_read_b32 v127, a53
    v_mul_f32 v127, v127, v126
    v_accvgpr_write_b32 a53, v127
    v_accvgpr_read_b32 v127, a54
    v_mul_f32 v127, v127, v126
    v_accvgpr_write_b32 a54, v127
    v_accvgpr_read_b32 v127, a55
    v_mul_f32 v127, v127, v126
    v_accvgpr_write_b32 a55, v127
    v_accvgpr_read_b32 v127, a56
    v_mul_f32 v127, v127, v126
    v_accvgpr_write_b32 a56, v127
    v_accvgpr_read_b32 v127, a57
    v_mul_f32 v127, v127, v126
    v_accvgpr_write_b32 a57, v127
    v_accvgpr_read_b32 v127, a58
    v_mul_f32 v127, v127, v126
    v_accvgpr_write_b32 a58, v127
    v_accvgpr_read_b32 v127, a59
    v_mul_f32 v127, v127, v126
    v_accvgpr_write_b32 a59, v127
    v_accvgpr_read_b32 v127, a60
    v_mul_f32 v127, v127, v126
    v_accvgpr_write_b32 a60, v127
    v_accvgpr_read_b32 v127, a61
    v_mul_f32 v127, v127, v126
    v_accvgpr_write_b32 a61, v127
    v_accvgpr_read_b32 v127, a62
    v_mul_f32 v127, v127, v126
    v_accvgpr_write_b32 a62, v127
    v_accvgpr_read_b32 v127, a63
    v_mul_f32 v127, v127, v126
    v_accvgpr_write_b32 a63, v127
    v_mov_b32 v126, v122
    s_nop 1
    v_permlane16_swap_b32 v122, v126
    v_max_f32 v122, v122, v126
    v_mov_b32 v126, v122
    s_nop 1
    v_permlane32_swap_b32 v122, v126
    v_max_f32 v122, v122, v126
    v_cmp_eq_f32 vcc, 0, v100
    v_max_f32 v126, 0, v122
    s_nop 0
    v_cndmask_b32 v122, v126, v122, vcc
    v_sub_f32 v40, v40, v122
    v_sub_f32 v41, v41, v122
    v_sub_f32 v42, v42, v122
    v_sub_f32 v43, v43, v122
    v_sub_f32 v44, v44, v122
    v_sub_f32 v45, v45, v122
    v_sub_f32 v46, v46, v122
    v_sub_f32 v47, v47, v122
    v_sub_f32 v80, v80, v122
    v_sub_f32 v81, v81, v122
    v_sub_f32 v82, v82, v122
    v_sub_f32 v83, v83, v122
    v_exp_f32 v126, -v126
    s_nop 0
    v_mul_f32 v100, v100, v126
    v_mul_f32 v101, v101, v126
    v_mul_f32 v102, v102, v126
    v_mul_f32 v103, v103, v126
    v_accvgpr_read_b32 v127, a64
    v_mul_f32 v127, v127, v126
    v_accvgpr_write_b32 a64, v127
    v_accvgpr_read_b32 v127, a65
    v_mul_f32 v127, v127, v126
    v_accvgpr_write_b32 a65, v127
    v_accvgpr_read_b32 v127, a66
    v_mul_f32 v127, v127, v126
    v_accvgpr_write_b32 a66, v127
    v_accvgpr_read_b32 v127, a67
    v_mul_f32 v127, v127, v126
    v_accvgpr_write_b32 a67, v127
    v_accvgpr_read_b32 v127, a68
    v_mul_f32 v127, v127, v126
    v_accvgpr_write_b32 a68, v127
    v_accvgpr_read_b32 v127, a69
    v_mul_f32 v127, v127, v126
    v_accvgpr_write_b32 a69, v127
    v_accvgpr_read_b32 v127, a70
    v_mul_f32 v127, v127, v126
    v_accvgpr_write_b32 a70, v127
    v_accvgpr_read_b32 v127, a71
    v_mul_f32 v127, v127, v126
    v_accvgpr_write_b32 a71, v127
    v_accvgpr_read_b32 v127, a72
    v_mul_f32 v127, v127, v126
    v_accvgpr_write_b32 a72, v127
    v_accvgpr_read_b32 v127, a73
    v_mul_f32 v127, v127, v126
    v_accvgpr_write_b32 a73, v127
    v_accvgpr_read_b32 v127, a74
    v_mul_f32 v127, v127, v126
    v_accvgpr_write_b32 a74, v127
    v_accvgpr_read_b32 v127, a75
    v_mul_f32 v127, v127, v126
    v_accvgpr_write_b32 a75, v127
    v_accvgpr_read_b32 v127, a76
    v_mul_f32 v127, v127, v126
    v_accvgpr_write_b32 a76, v127
    v_accvgpr_read_b32 v127, a77
    v_mul_f32 v127, v127, v126
    v_accvgpr_write_b32 a77, v127
    v_accvgpr_read_b32 v127, a78
    v_mul_f32 v127, v127, v126
    v_accvgpr_write_b32 a78, v127
    v_accvgpr_read_b32 v127, a79
    v_mul_f32 v127, v127, v126
    v_accvgpr_write_b32 a79, v127
    v_accvgpr_read_b32 v127, a80
    v_mul_f32 v127, v127, v126
    v_accvgpr_write_b32 a80, v127
    v_accvgpr_read_b32 v127, a81
    v_mul_f32 v127, v127, v126
    v_accvgpr_write_b32 a81, v127
    v_accvgpr_read_b32 v127, a82
    v_mul_f32 v127, v127, v126
    v_accvgpr_write_b32 a82, v127
    v_accvgpr_read_b32 v127, a83
    v_mul_f32 v127, v127, v126
    v_accvgpr_write_b32 a83, v127
    v_accvgpr_read_b32 v127, a84
    v_mul_f32 v127, v127, v126
    v_accvgpr_write_b32 a84, v127
    v_accvgpr_read_b32 v127, a85
    v_mul_f32 v127, v127, v126
    v_accvgpr_write_b32 a85, v127
    v_accvgpr_read_b32 v127, a86
    v_mul_f32 v127, v127, v126
    v_accvgpr_write_b32 a86, v127
    v_accvgpr_read_b32 v127, a87
    v_mul_f32 v127, v127, v126
    v_accvgpr_write_b32 a87, v127
    v_accvgpr_read_b32 v127, a88
    v_mul_f32 v127, v127, v126
    v_accvgpr_write_b32 a88, v127
    v_accvgpr_read_b32 v127, a89
    v_mul_f32 v127, v127, v126
    v_accvgpr_write_b32 a89, v127
    v_accvgpr_read_b32 v127, a90
    v_mul_f32 v127, v127, v126
    v_accvgpr_write_b32 a90, v127
    v_accvgpr_read_b32 v127, a91
    v_mul_f32 v127, v127, v126
    v_accvgpr_write_b32 a91, v127
    v_accvgpr_read_b32 v127, a92
    v_mul_f32 v127, v127, v126
    v_accvgpr_write_b32 a92, v127
    v_accvgpr_read_b32 v127, a93
    v_mul_f32 v127, v127, v126
    v_accvgpr_write_b32 a93, v127
    v_accvgpr_read_b32 v127, a94
    v_mul_f32 v127, v127, v126
    v_accvgpr_write_b32 a94, v127
    v_accvgpr_read_b32 v127, a95
    v_mul_f32 v127, v127, v126
    v_accvgpr_write_b32 a95, v127
    v_mov_b32 v126, v123
    s_nop 1
    v_permlane16_swap_b32 v123, v126
    v_max_f32 v123, v123, v126
    v_mov_b32 v126, v123
    s_nop 1
    v_permlane32_swap_b32 v123, v126
    v_max_f32 v123, v123, v126
    v_cmp_eq_f32 vcc, 0, v104
    v_max_f32 v126, 0, v123
    s_nop 0
    v_cndmask_b32 v123, v126, v123, vcc
    v_sub_f32 v56, v56, v123
    v_sub_f32 v57, v57, v123
    v_sub_f32 v58, v58, v123
    v_sub_f32 v59, v59, v123
    v_sub_f32 v60, v60, v123
    v_sub_f32 v61, v61, v123
    v_sub_f32 v62, v62, v123
    v_sub_f32 v63, v63, v123
    v_sub_f32 v84, v84, v123
    v_sub_f32 v85, v85, v123
    v_sub_f32 v86, v86, v123
    v_sub_f32 v87, v87, v123
    v_exp_f32 v126, -v126
    s_nop 0
    v_mul_f32 v104, v104, v126
    v_mul_f32 v105, v105, v126
    v_mul_f32 v106, v106, v126
    v_mul_f32 v107, v107, v126
    v_accvgpr_read_b32 v127, a96
    v_mul_f32 v127, v127, v126
    v_accvgpr_write_b32 a96, v127
    v_accvgpr_read_b32 v127, a97
    v_mul_f32 v127, v127, v126
    v_accvgpr_write_b32 a97, v127
    v_accvgpr_read_b32 v127, a98
    v_mul_f32 v127, v127, v126
    v_accvgpr_write_b32 a98, v127
    v_accvgpr_read_b32 v127, a99
    v_mul_f32 v127, v127, v126
    v_accvgpr_write_b32 a99, v127
    v_accvgpr_read_b32 v127, a100
    v_mul_f32 v127, v127, v126
    v_accvgpr_write_b32 a100, v127
    v_accvgpr_read_b32 v127, a101
    v_mul_f32 v127, v127, v126
    v_accvgpr_write_b32 a101, v127
    v_accvgpr_read_b32 v127, a102
    v_mul_f32 v127, v127, v126
    v_accvgpr_write_b32 a102, v127
    v_accvgpr_read_b32 v127, a103
    v_mul_f32 v127, v127, v126
    v_accvgpr_write_b32 a103, v127
    v_accvgpr_read_b32 v127, a104
    v_mul_f32 v127, v127, v126
    v_accvgpr_write_b32 a104, v127
    v_accvgpr_read_b32 v127, a105
    v_mul_f32 v127, v127, v126
    v_accvgpr_write_b32 a105, v127
    v_accvgpr_read_b32 v127, a106
    v_mul_f32 v127, v127, v126
    v_accvgpr_write_b32 a106, v127
    v_accvgpr_read_b32 v127, a107
    v_mul_f32 v127, v127, v126
    v_accvgpr_write_b32 a107, v127
    v_accvgpr_read_b32 v127, a108
    v_mul_f32 v127, v127, v126
    v_accvgpr_write_b32 a108, v127
    v_accvgpr_read_b32 v127, a109
    v_mul_f32 v127, v127, v126
    v_accvgpr_write_b32 a109, v127
    v_accvgpr_read_b32 v127, a110
    v_mul_f32 v127, v127, v126
    v_accvgpr_write_b32 a110, v127
    v_accvgpr_read_b32 v127, a111
    v_mul_f32 v127, v127, v126
    v_accvgpr_write_b32 a111, v127
    v_accvgpr_read_b32 v127, a112
    v_mul_f32 v127, v127, v126
    v_accvgpr_write_b32 a112, v127
    v_accvgpr_read_b32 v127, a113
    v_mul_f32 v127, v127, v126
    v_accvgpr_write_b32 a113, v127
    v_accvgpr_read_b32 v127, a114
    v_mul_f32 v127, v127, v126
    v_accvgpr_write_b32 a114, v127
    v_accvgpr_read_b32 v127, a115
    v_mul_f32 v127, v127, v126
    v_accvgpr_write_b32 a115, v127
    v_accvgpr_read_b32 v127, a116
    v_mul_f32 v127, v127, v126
    v_accvgpr_write_b32 a116, v127
    v_accvgpr_read_b32 v127, a117
    v_mul_f32 v127, v127, v126
    v_accvgpr_write_b32 a117, v127
    v_accvgpr_read_b32 v127, a118
    v_mul_f32 v127, v127, v126
    v_accvgpr_write_b32 a118, v127
    v_accvgpr_read_b32 v127, a119
    v_mul_f32 v127, v127, v126
    v_accvgpr_write_b32 a119, v127
    v_accvgpr_read_b32 v127, a120
    v_mul_f32 v127, v127, v126
    v_accvgpr_write_b32 a120, v127
    v_accvgpr_read_b32 v127, a121
    v_mul_f32 v127, v127, v126
    v_accvgpr_write_b32 a121, v127
    v_accvgpr_read_b32 v127, a122
    v_mul_f32 v127, v127, v126
    v_accvgpr_write_b32 a122, v127
    v_accvgpr_read_b32 v127, a123
    v_mul_f32 v127, v127, v126
    v_accvgpr_write_b32 a123, v127
    v_accvgpr_read_b32 v127, a124
    v_mul_f32 v127, v127, v126
    v_accvgpr_write_b32 a124, v127
    v_accvgpr_read_b32 v127, a125
    v_mul_f32 v127, v127, v126
    v_accvgpr_write_b32 a125, v127
    v_accvgpr_read_b32 v127, a126
    v_mul_f32 v127, v127, v126
    v_accvgpr_write_b32 a126, v127
    v_accvgpr_read_b32 v127, a127
    v_mul_f32 v127, v127, v126
    v_accvgpr_write_b32 a127, v127
    s_nop 3
    s_branch attn_kernel_n15
.globl oproj_kernel
.p2align 8
.type oproj_kernel,@function
oproj_kernel:
    s_cmp_ge_u32 s2, 256
    s_cbranch_scc1 oproj_kernel_done
    s_load_dwordx2 s[4:5], s[0:1], 32
    s_load_dwordx2 s[6:7], s[0:1], 72
    s_load_dwordx2 s[12:13], s[0:1], 96
    s_load_dwordx2 s[8:9], s[0:1], 88
    s_load_dwordx2 s[10:11], s[0:1], 80
    v_and_b32 v178, 63, v0
    v_lshrrev_b32 v181, 6, v0
    v_lshrrev_b32 v179, 4, v178
    v_and_b32 v180, 15, v178
    v_readfirstlane_b32 s28, v181
    s_waitcnt lgkmcnt(0)
    s_and_b32 s33, s2, 3
    s_lshr_b32 s36, s2, 2
    s_and_b32 s36, s36, 1
    s_lshr_b32 s34, s2, 3
    s_and_b32 s34, s34, 3
    s_lshr_b32 s35, s2, 5
    s_cmp_eq_u32 s36, 0
    s_cselect_b32 s20, s4, s6
    s_cselect_b32 s21, s5, s7
    s_mov_b32 s22, 4194304
    s_mov_b32 s23, 0x00020000
    s_mul_i32 s29, s36, 9437184
    s_mul_i32 s30, s35, 1179648
    s_add_u32 s29, s29, s30
    s_add_u32 s16, s12, s29
    s_addc_u32 s17, s13, 0
    s_mov_b32 s18, 1179648
    s_mov_b32 s19, 0x00020000
    s_lshl_b32 s44, s36, 3
    s_add_u32 s44, s44, s35
    s_lshl_b32 s44, s44, 2
    s_add_u32 s44, s44, s34
    s_mul_i32 s29, s44, 147456
    s_add_u32 s29, s29, 19922944
    s_add_u32 s24, s12, s29
    s_addc_u32 s25, s13, 0
    s_mov_b32 s26, 147456
    s_mov_b32 s27, 0x00020000
    s_mov_b32 s48, s8
    s_mov_b32 s49, s9
    s_mov_b32 s50, 256
    s_mov_b32 s51, 0x00020000
    s_mov_b32 s52, s10
    s_mov_b32 s53, s11
    s_mov_b32 s54, 2359296
    s_mov_b32 s55, 0x00020000
    s_lshl_b32 s37, s28, 10
    s_mul_i32 s38, s33, 294912
    s_lshl_b32 s39, s33, 20
    s_lshl_b32 s29, s34, 8
    s_add_u32 s39, s39, s29
    s_and_b32 s29, s28, 1
    s_add_u32 s29, s29, 16
    s_lshl_b32 s42, s29, 10
    v_lshlrev_b32 v176, 4, v178
    s_lshl_b32 s29, s28, 2
    v_add_u32 v182, s29, v179
    s_lshr_b32 s29, s28, 1
    s_lshl_b32 s29, s29, 2
    v_add_u32 v183, s29, v179
    v_lshlrev_b32 v183, 1, v183
    v_xor_b32 v183, v180, v183
    v_lshlrev_b32 v183, 4, v183
    v_lshl_add_u32 v177, v182, 10, v183
    v_add_u32 v160, 0, v176
    v_add_u32 v162, 34816, v176
    v_add_u32 v164, 69632, v176
    v_add_u32 v166, 104448, v176
    v_lshrrev_b32 v182, 2, v180
    v_lshl_add_u32 v183, v179, 3, v182
    v_and_b32 v184, 1, v179
    v_lshl_add_u32 v184, v184, 2, v182
    v_and_b32 v185, 3, v180
    v_lshlrev_b32 v185, 3, v185
    v_lshl_add_u32 v185, v183, 8, v185
    s_lshl_b32 s29, s28, 1
    s_add_u32 s30, s29, 0
    v_xor_b32 v182, s30, v184
    v_lshl_add_u32 v182, v182, 5, v185
    v_add_u32 v168, 18432, v182
    v_add_u32 v170, 53248, v182
    v_add_u32 v172, 88064, v182
    v_add_u32 v174, 122880, v182
    s_add_u32 s30, s29, 1
    v_xor_b32 v182, s30, v184
    v_lshl_add_u32 v182, v182, 5, v185
    v_add_u32 v169, 18432, v182
    v_add_u32 v171, 53248, v182
    v_add_u32 v173, 88064, v182
    v_add_u32 v175, 122880, v182
    s_add_u32 m0, s37, 0
    s_add_u32 s32, s38, 0
    s_add_u32 s32, s32, s37
    buffer_load_dwordx4 v176, s[16:19], s32 offen lds
    s_add_u32 m0, s37, 4096
    s_add_u32 s32, s38, 4096
    s_add_u32 s32, s32, s37
    buffer_load_dwordx4 v176, s[16:19], s32 offen lds
    s_add_u32 m0, s37, 8192
    s_add_u32 s32, s38, 8192
    s_add_u32 s32, s32, s37
    buffer_load_dwordx4 v176, s[16:19], s32 offen lds
    s_add_u32 m0, s37, 12288
    s_add_u32 s32, s38, 12288
    s_add_u32 s32, s32, s37
    buffer_load_dwordx4 v176, s[16:19], s32 offen lds
    s_add_u32 m0, s42, 0
    s_add_u32 s32, s38, s42
    buffer_load_dwordx4 v176, s[16:19], s32 offen lds
    s_add_u32 s38, s38, 18432
    s_add_u32 m0, s37, 18432
    s_add_u32 s32, s39, 0
    buffer_load_dwordx4 v177, s[20:23], s32 offen lds
    s_add_u32 m0, s37, 22528
    s_add_u32 s32, s39, 16384
    buffer_load_dwordx4 v177, s[20:23], s32 offen lds
    s_add_u32 m0, s37, 26624
    s_add_u32 s32, s39, 32768
    buffer_load_dwordx4 v177, s[20:23], s32 offen lds
    s_add_u32 m0, s37, 30720
    s_add_u32 s32, s39, 49152
    buffer_load_dwordx4 v177, s[20:23], s32 offen lds
    s_add_u32 s39, s39, 65536
    s_add_u32 m0, s37, 34816
    s_add_u32 s32, s38, 0
    s_add_u32 s32, s32, s37
    buffer_load_dwordx4 v176, s[16:19], s32 offen lds
    s_add_u32 m0, s37, 38912
    s_add_u32 s32, s38, 4096
    s_add_u32 s32, s32, s37
    buffer_load_dwordx4 v176, s[16:19], s32 offen lds
    s_add_u32 m0, s37, 43008
    s_add_u32 s32, s38, 8192
    s_add_u32 s32, s32, s37
    buffer_load_dwordx4 v176, s[16:19], s32 offen lds
    s_add_u32 m0, s37, 47104
    s_add_u32 s32, s38, 12288
    s_add_u32 s32, s32, s37
    buffer_load_dwordx4 v176, s[16:19], s32 offen lds
    s_add_u32 m0, s42, 34816
    s_add_u32 s32, s38, s42
    buffer_load_dwordx4 v176, s[16:19], s32 offen lds
    s_add_u32 s38, s38, 18432
    s_add_u32 m0, s37, 53248
    s_add_u32 s32, s39, 0
    buffer_load_dwordx4 v177, s[20:23], s32 offen lds
    s_add_u32 m0, s37, 57344
    s_add_u32 s32, s39, 16384
    buffer_load_dwordx4 v177, s[20:23], s32 offen lds
    s_add_u32 m0, s37, 61440
    s_add_u32 s32, s39, 32768
    buffer_load_dwordx4 v177, s[20:23], s32 offen lds
    s_add_u32 m0, s37, 65536
    s_add_u32 s32, s39, 49152
    buffer_load_dwordx4 v177, s[20:23], s32 offen lds
    s_add_u32 s39, s39, 65536
    s_add_u32 m0, s37, 69632
    s_add_u32 s32, s38, 0
    s_add_u32 s32, s32, s37
    buffer_load_dwordx4 v176, s[16:19], s32 offen lds
    s_add_u32 m0, s37, 73728
    s_add_u32 s32, s38, 4096
    s_add_u32 s32, s32, s37
    buffer_load_dwordx4 v176, s[16:19], s32 offen lds
    s_add_u32 m0, s37, 77824
    s_add_u32 s32, s38, 8192
    s_add_u32 s32, s32, s37
    buffer_load_dwordx4 v176, s[16:19], s32 offen lds
    s_add_u32 m0, s37, 81920
    s_add_u32 s32, s38, 12288
    s_add_u32 s32, s32, s37
    buffer_load_dwordx4 v176, s[16:19], s32 offen lds
    s_add_u32 m0, s42, 69632
    s_add_u32 s32, s38, s42
    buffer_load_dwordx4 v176, s[16:19], s32 offen lds
    s_add_u32 s38, s38, 18432
    s_add_u32 m0, s37, 88064
    s_add_u32 s32, s39, 0
    buffer_load_dwordx4 v177, s[20:23], s32 offen lds
    s_add_u32 m0, s37, 92160
    s_add_u32 s32, s39, 16384
    buffer_load_dwordx4 v177, s[20:23], s32 offen lds
    s_add_u32 m0, s37, 96256
    s_add_u32 s32, s39, 32768
    buffer_load_dwordx4 v177, s[20:23], s32 offen lds
    s_add_u32 m0, s37, 100352
    s_add_u32 s32, s39, 49152
    buffer_load_dwordx4 v177, s[20:23], s32 offen lds
    s_add_u32 s39, s39, 65536
    v_mov_b32 v0, 0
    v_mov_b32 v1, 0
    v_mov_b32 v2, 0
    v_mov_b32 v3, 0
    v_mov_b32 v4, 0
    v_mov_b32 v5, 0
    v_mov_b32 v6, 0
    v_mov_b32 v7, 0
    v_mov_b32 v8, 0
    v_mov_b32 v9, 0
    v_mov_b32 v10, 0
    v_mov_b32 v11, 0
    v_mov_b32 v12, 0
    v_mov_b32 v13, 0
    v_mov_b32 v14, 0
    v_mov_b32 v15, 0
    v_mov_b32 v16, 0
    v_mov_b32 v17, 0
    v_mov_b32 v18, 0
    v_mov_b32 v19, 0
    v_mov_b32 v20, 0
    v_mov_b32 v21, 0
    v_mov_b32 v22, 0
    v_mov_b32 v23, 0
    v_mov_b32 v24, 0
    v_mov_b32 v25, 0
    v_mov_b32 v26, 0
    v_mov_b32 v27, 0
    v_mov_b32 v28, 0
    v_mov_b32 v29, 0
    v_mov_b32 v30, 0
    v_mov_b32 v31, 0
    v_mov_b32 v32, 0
    v_mov_b32 v33, 0
    v_mov_b32 v34, 0
    v_mov_b32 v35, 0
    v_mov_b32 v36, 0
    v_mov_b32 v37, 0
    v_mov_b32 v38, 0
    v_mov_b32 v39, 0
    v_mov_b32 v40, 0
    v_mov_b32 v41, 0
    v_mov_b32 v42, 0
    v_mov_b32 v43, 0
    v_mov_b32 v44, 0
    v_mov_b32 v45, 0
    v_mov_b32 v46, 0
    v_mov_b32 v47, 0
    v_mov_b32 v48, 0
    v_mov_b32 v49, 0
    v_mov_b32 v50, 0
    v_mov_b32 v51, 0
    v_mov_b32 v52, 0
    v_mov_b32 v53, 0
    v_mov_b32 v54, 0
    v_mov_b32 v55, 0
    v_mov_b32 v56, 0
    v_mov_b32 v57, 0
    v_mov_b32 v58, 0
    v_mov_b32 v59, 0
    v_mov_b32 v60, 0
    v_mov_b32 v61, 0
    v_mov_b32 v62, 0
    v_mov_b32 v63, 0
    v_mov_b32 v64, 0
    v_mov_b32 v65, 0
    v_mov_b32 v66, 0
    v_mov_b32 v67, 0
    v_mov_b32 v68, 0
    v_mov_b32 v69, 0
    v_mov_b32 v70, 0
    v_mov_b32 v71, 0
    s_mov_b32 s40, 0
    s_waitcnt vmcnt(9) lgkmcnt(0)
    s_barrier
    ds_read_b64_tr_b16 v[108:109], v168
    ds_read_b64_tr_b16 v[110:111], v168 offset:1024
    ds_read_b64_tr_b16 v[112:113], v169
    ds_read_b64_tr_b16 v[114:115], v169 offset:1024
    ds_read_b128 v[72:75], v160
    ds_read_b128 v[76:79], v160 offset:1024
    ds_read_b128 v[80:83], v160 offset:2048
    ds_read_b128 v[84:87], v160 offset:3072
    ds_read_b128 v[88:91], v160 offset:4096
    ds_read_b128 v[92:95], v160 offset:5120
    ds_read_b128 v[96:99], v160 offset:6144
    ds_read_b128 v[100:103], v160 offset:7168
    ds_read_b128 v[104:107], v160 offset:8192
    s_nop 3
oproj_kernel_loop:
    ds_read_b64_tr_b16 v[152:153], v168 offset:8192
    s_add_u32 m0, s37, 104448
    s_add_u32 s32, s38, 0
    s_add_u32 s32, s32, s37
    buffer_load_dwordx4 v176, s[16:19], s32 offen lds
    s_waitcnt lgkmcnt(9)
    v_mfma_f32_16x16x32_bf16 v[0:3], v[108:111], v[72:75], v[0:3]
    ds_read_b64_tr_b16 v[154:155], v168 offset:9216
    s_add_u32 m0, s37, 108544
    s_add_u32 s32, s38, 4096
    s_add_u32 s32, s32, s37
    buffer_load_dwordx4 v176, s[16:19], s32 offen lds
    v_mfma_f32_16x16x32_bf16 v[36:39], v[112:115], v[72:75], v[36:39]
    ds_read_b64_tr_b16 v[156:157], v169 offset:8192
    s_add_u32 m0, s37, 112640
    s_add_u32 s32, s38, 8192
    s_add_u32 s32, s32, s37
    buffer_load_dwordx4 v176, s[16:19], s32 offen lds
    s_waitcnt lgkmcnt(10)
    v_mfma_f32_16x16x32_bf16 v[4:7], v[108:111], v[76:79], v[4:7]
    ds_read_b64_tr_b16 v[158:159], v169 offset:9216
    s_add_u32 m0, s37, 116736
    s_add_u32 s32, s38, 12288
    s_add_u32 s32, s32, s37
    buffer_load_dwordx4 v176, s[16:19], s32 offen lds
    v_mfma_f32_16x16x32_bf16 v[40:43], v[112:115], v[76:79], v[40:43]
    ds_read_b128 v[116:119], v160 offset:9216
    s_add_u32 m0, s42, 104448
    s_add_u32 s32, s38, s42
    buffer_load_dwordx4 v176, s[16:19], s32 offen lds
    s_add_u32 s38, s38, 18432
    s_waitcnt lgkmcnt(11)
    v_mfma_f32_16x16x32_bf16 v[8:11], v[108:111], v[80:83], v[8:11]
    ds_read_b128 v[120:123], v160 offset:10240
    ds_read_b128 v[124:127], v160 offset:11264
    v_mfma_f32_16x16x32_bf16 v[44:47], v[112:115], v[80:83], v[44:47]
    ds_read_b128 v[128:131], v160 offset:12288
    ds_read_b128 v[132:135], v160 offset:13312
    s_waitcnt lgkmcnt(14)
    v_mfma_f32_16x16x32_bf16 v[12:15], v[108:111], v[84:87], v[12:15]
    ds_read_b128 v[136:139], v160 offset:14336
    ds_read_b128 v[140:143], v160 offset:15360
    v_mfma_f32_16x16x32_bf16 v[48:51], v[112:115], v[84:87], v[48:51]
    ds_read_b128 v[144:147], v160 offset:16384
    ds_read_b128 v[148:151], v160 offset:17408
    s_waitcnt lgkmcnt(15)
    v_mfma_f32_16x16x32_bf16 v[16:19], v[108:111], v[88:91], v[16:19]
    v_mfma_f32_16x16x32_bf16 v[52:55], v[112:115], v[88:91], v[52:55]
    v_mfma_f32_16x16x32_bf16 v[20:23], v[108:111], v[92:95], v[20:23]
    v_mfma_f32_16x16x32_bf16 v[56:59], v[112:115], v[92:95], v[56:59]
    v_mfma_f32_16x16x32_bf16 v[24:27], v[108:111], v[96:99], v[24:27]
    v_mfma_f32_16x16x32_bf16 v[60:63], v[112:115], v[96:99], v[60:63]
    s_waitcnt lgkmcnt(14)
    v_mfma_f32_16x16x32_bf16 v[28:31], v[108:111], v[100:103], v[28:31]
    v_mfma_f32_16x16x32_bf16 v[64:67], v[112:115], v[100:103], v[64:67]
    s_waitcnt lgkmcnt(13)
    v_mfma_f32_16x16x32_bf16 v[32:35], v[108:111], v[104:107], v[32:35]
    v_mfma_f32_16x16x32_bf16 v[68:71], v[112:115], v[104:107], v[68:71]
    ds_read_b64_tr_b16 v[108:109], v170
    s_add_u32 m0, s37, 122880
    s_add_u32 s32, s39, 0
    buffer_load_dwordx4 v177, s[20:23], s32 offen lds
    s_waitcnt lgkmcnt(9)
    v_mfma_f32_16x16x32_bf16 v[0:3], v[152:155], v[116:119], v[0:3]
    ds_read_b64_tr_b16 v[110:111], v170 offset:1024
    s_add_u32 m0, s37, 126976
    s_add_u32 s32, s39, 16384
    buffer_load_dwordx4 v177, s[20:23], s32 offen lds
    v_mfma_f32_16x16x32_bf16 v[36:39], v[156:159], v[116:119], v[36:39]
    ds_read_b64_tr_b16 v[112:113], v171
    s_add_u32 m0, s37, 131072
    s_add_u32 s32, s39, 32768
    buffer_load_dwordx4 v177, s[20:23], s32 offen lds
    s_waitcnt lgkmcnt(10)
    v_mfma_f32_16x16x32_bf16 v[4:7], v[152:155], v[120:123], v[4:7]
    ds_read_b64_tr_b16 v[114:115], v171 offset:1024
    s_add_u32 m0, s37, 135168
    s_add_u32 s32, s39, 49152
    buffer_load_dwordx4 v177, s[20:23], s32 offen lds
    s_add_u32 s39, s39, 65536
    v_mfma_f32_16x16x32_bf16 v[40:43], v[156:159], v[120:123], v[40:43]
    ds_read_b128 v[72:75], v162
    ds_read_b128 v[76:79], v162 offset:1024
    s_waitcnt lgkmcnt(12)
    v_mfma_f32_16x16x32_bf16 v[8:11], v[152:155], v[124:127], v[8:11]
    ds_read_b128 v[80:83], v162 offset:2048
    ds_read_b128 v[84:87], v162 offset:3072
    v_mfma_f32_16x16x32_bf16 v[44:47], v[156:159], v[124:127], v[44:47]
    ds_read_b128 v[88:91], v162 offset:4096
    ds_read_b128 v[92:95], v162 offset:5120
    s_waitcnt lgkmcnt(15)
    v_mfma_f32_16x16x32_bf16 v[12:15], v[152:155], v[128:131], v[12:15]
    ds_read_b128 v[96:99], v162 offset:6144
    ds_read_b128 v[100:103], v162 offset:7168
    v_mfma_f32_16x16x32_bf16 v[48:51], v[156:159], v[128:131], v[48:51]
    ds_read_b128 v[104:107], v162 offset:8192
    s_waitcnt lgkmcnt(15)
    v_mfma_f32_16x16x32_bf16 v[16:19], v[152:155], v[132:135], v[16:19]
    v_mfma_f32_16x16x32_bf16 v[52:55], v[156:159], v[132:135], v[52:55]
    v_mfma_f32_16x16x32_bf16 v[20:23], v[152:155], v[136:139], v[20:23]
    v_mfma_f32_16x16x32_bf16 v[56:59], v[156:159], v[136:139], v[56:59]
    v_mfma_f32_16x16x32_bf16 v[24:27], v[152:155], v[140:143], v[24:27]
    v_mfma_f32_16x16x32_bf16 v[60:63], v[156:159], v[140:143], v[60:63]
    s_waitcnt lgkmcnt(14)
    v_mfma_f32_16x16x32_bf16 v[28:31], v[152:155], v[144:147], v[28:31]
    v_mfma_f32_16x16x32_bf16 v[64:67], v[156:159], v[144:147], v[64:67]
    s_waitcnt lgkmcnt(13)
    v_mfma_f32_16x16x32_bf16 v[32:35], v[152:155], v[148:151], v[32:35]
    v_mfma_f32_16x16x32_bf16 v[68:71], v[156:159], v[148:151], v[68:71]
    s_waitcnt vmcnt(9)
    s_barrier
    s_cmp_eq_u32 s40, 3
    s_cselect_b32 s18, 0, s18
    s_cselect_b32 s22, 0, s22
    ds_read_b64_tr_b16 v[152:153], v170 offset:8192
    s_add_u32 m0, s37, 0
    s_add_u32 s32, s38, 0
    s_add_u32 s32, s32, s37
    buffer_load_dwordx4 v176, s[16:19], s32 offen lds
    s_waitcnt lgkmcnt(9)
    v_mfma_f32_16x16x32_bf16 v[0:3], v[108:111], v[72:75], v[0:3]
    ds_read_b64_tr_b16 v[154:155], v170 offset:9216
    s_add_u32 m0, s37, 4096
    s_add_u32 s32, s38, 4096
    s_add_u32 s32, s32, s37
    buffer_load_dwordx4 v176, s[16:19], s32 offen lds
    v_mfma_f32_16x16x32_bf16 v[36:39], v[112:115], v[72:75], v[36:39]
    ds_read_b64_tr_b16 v[156:157], v171 offset:8192
    s_add_u32 m0, s37, 8192
    s_add_u32 s32, s38, 8192
    s_add_u32 s32, s32, s37
    buffer_load_dwordx4 v176, s[16:19], s32 offen lds
    s_waitcnt lgkmcnt(10)
    v_mfma_f32_16x16x32_bf16 v[4:7], v[108:111], v[76:79], v[4:7]
    ds_read_b64_tr_b16 v[158:159], v171 offset:9216
    s_add_u32 m0, s37, 12288
    s_add_u32 s32, s38, 12288
    s_add_u32 s32, s32, s37
    buffer_load_dwordx4 v176, s[16:19], s32 offen lds
    v_mfma_f32_16x16x32_bf16 v[40:43], v[112:115], v[76:79], v[40:43]
    ds_read_b128 v[116:119], v162 offset:9216
    s_add_u32 m0, s42, 0
    s_add_u32 s32, s38, s42
    buffer_load_dwordx4 v176, s[16:19], s32 offen lds
    s_add_u32 s38, s38, 18432
    s_waitcnt lgkmcnt(11)
    v_mfma_f32_16x16x32_bf16 v[8:11], v[108:111], v[80:83], v[8:11]
    ds_read_b128 v[120:123], v162 offset:10240
    ds_read_b128 v[124:127], v162 offset:11264
    v_mfma_f32_16x16x32_bf16 v[44:47], v[112:115], v[80:83], v[44:47]
    ds_read_b128 v[128:131], v162 offset:12288
    ds_read_b128 v[132:135], v162 offset:13312
    s_waitcnt lgkmcnt(14)
    v_mfma_f32_16x16x32_bf16 v[12:15], v[108:111], v[84:87], v[12:15]
    ds_read_b128 v[136:139], v162 offset:14336
    ds_read_b128 v[140:143], v162 offset:15360
    v_mfma_f32_16x16x32_bf16 v[48:51], v[112:115], v[84:87], v[48:51]
    ds_read_b128 v[144:147], v162 offset:16384
    ds_read_b128 v[148:151], v162 offset:17408
    s_waitcnt lgkmcnt(15)
    v_mfma_f32_16x16x32_bf16 v[16:19], v[108:111], v[88:91], v[16:19]
    v_mfma_f32_16x16x32_bf16 v[52:55], v[112:115], v[88:91], v[52:55]
    v_mfma_f32_16x16x32_bf16 v[20:23], v[108:111], v[92:95], v[20:23]
    v_mfma_f32_16x16x32_bf16 v[56:59], v[112:115], v[92:95], v[56:59]
    v_mfma_f32_16x16x32_bf16 v[24:27], v[108:111], v[96:99], v[24:27]
    v_mfma_f32_16x16x32_bf16 v[60:63], v[112:115], v[96:99], v[60:63]
    s_waitcnt lgkmcnt(14)
    v_mfma_f32_16x16x32_bf16 v[28:31], v[108:111], v[100:103], v[28:31]
    v_mfma_f32_16x16x32_bf16 v[64:67], v[112:115], v[100:103], v[64:67]
    s_waitcnt lgkmcnt(13)
    v_mfma_f32_16x16x32_bf16 v[32:35], v[108:111], v[104:107], v[32:35]
    v_mfma_f32_16x16x32_bf16 v[68:71], v[112:115], v[104:107], v[68:71]
    ds_read_b64_tr_b16 v[108:109], v172
    s_add_u32 m0, s37, 18432
    s_add_u32 s32, s39, 0
    buffer_load_dwordx4 v177, s[20:23], s32 offen lds
    s_waitcnt lgkmcnt(9)
    v_mfma_f32_16x16x32_bf16 v[0:3], v[152:155], v[116:119], v[0:3]
    ds_read_b64_tr_b16 v[110:111], v172 offset:1024
    s_add_u32 m0, s37, 22528
    s_add_u32 s32, s39, 16384
    buffer_load_dwordx4 v177, s[20:23], s32 offen lds
    v_mfma_f32_16x16x32_bf16 v[36:39], v[156:159], v[116:119], v[36:39]
    ds_read_b64_tr_b16 v[112:113], v173
    s_add_u32 m0, s37, 26624
    s_add_u32 s32, s39, 32768
    buffer_load_dwordx4 v177, s[20:23], s32 offen lds
    s_waitcnt lgkmcnt(10)
    v_mfma_f32_16x16x32_bf16 v[4:7], v[152:155], v[120:123], v[4:7]
    ds_read_b64_tr_b16 v[114:115], v173 offset:1024
    s_add_u32 m0, s37, 30720
    s_add_u32 s32, s39, 49152
    buffer_load_dwordx4 v177, s[20:23], s32 offen lds
    s_add_u32 s39, s39, 65536
    v_mfma_f32_16x16x32_bf16 v[40:43], v[156:159], v[120:123], v[40:43]
    ds_read_b128 v[72:75], v164
    ds_read_b128 v[76:79], v164 offset:1024
    s_waitcnt lgkmcnt(12)
    v_mfma_f32_16x16x32_bf16 v[8:11], v[152:155], v[124:127], v[8:11]
    ds_read_b128 v[80:83], v164 offset:2048
    ds_read_b128 v[84:87], v164 offset:3072
    v_mfma_f32_16x16x32_bf16 v[44:47], v[156:159], v[124:127], v[44:47]
    ds_read_b128 v[88:91], v164 offset:4096
    ds_read_b128 v[92:95], v164 offset:5120
    s_waitcnt lgkmcnt(15)
    v_mfma_f32_16x16x32_bf16 v[12:15], v[152:155], v[128:131], v[12:15]
    ds_read_b128 v[96:99], v164 offset:6144
    ds_read_b128 v[100:103], v164 offset:7168
    v_mfma_f32_16x16x32_bf16 v[48:51], v[156:159], v[128:131], v[48:51]
    ds_read_b128 v[104:107], v164 offset:8192
    s_waitcnt lgkmcnt(15)
    v_mfma_f32_16x16x32_bf16 v[16:19], v[152:155], v[132:135], v[16:19]
    v_mfma_f32_16x16x32_bf16 v[52:55], v[156:159], v[132:135], v[52:55]
    v_mfma_f32_16x16x32_bf16 v[20:23], v[152:155], v[136:139], v[20:23]
    v_mfma_f32_16x16x32_bf16 v[56:59], v[156:159], v[136:139], v[56:59]
    v_mfma_f32_16x16x32_bf16 v[24:27], v[152:155], v[140:143], v[24:27]
    v_mfma_f32_16x16x32_bf16 v[60:63], v[156:159], v[140:143], v[60:63]
    s_waitcnt lgkmcnt(14)
    v_mfma_f32_16x16x32_bf16 v[28:31], v[152:155], v[144:147], v[28:31]
    v_mfma_f32_16x16x32_bf16 v[64:67], v[156:159], v[144:147], v[64:67]
    s_waitcnt lgkmcnt(13)
    v_mfma_f32_16x16x32_bf16 v[32:35], v[152:155], v[148:151], v[32:35]
    v_mfma_f32_16x16x32_bf16 v[68:71], v[156:159], v[148:151], v[68:71]
    s_waitcnt vmcnt(9)
    s_barrier
    ds_read_b64_tr_b16 v[152:153], v172 offset:8192
    s_add_u32 m0, s37, 34816
    s_add_u32 s32, s38, 0
    s_add_u32 s32, s32, s37
    buffer_load_dwordx4 v176, s[16:19], s32 offen lds
    s_waitcnt lgkmcnt(9)
    v_mfma_f32_16x16x32_bf16 v[0:3], v[108:111], v[72:75], v[0:3]
    ds_read_b64_tr_b16 v[154:155], v172 offset:9216
    s_add_u32 m0, s37, 38912
    s_add_u32 s32, s38, 4096
    s_add_u32 s32, s32, s37
    buffer_load_dwordx4 v176, s[16:19], s32 offen lds
    v_mfma_f32_16x16x32_bf16 v[36:39], v[112:115], v[72:75], v[36:39]
    ds_read_b64_tr_b16 v[156:157], v173 offset:8192
    s_add_u32 m0, s37, 43008
    s_add_u32 s32, s38, 8192
    s_add_u32 s32, s32, s37
    buffer_load_dwordx4 v176, s[16:19], s32 offen lds
    s_waitcnt lgkmcnt(10)
    v_mfma_f32_16x16x32_bf16 v[4:7], v[108:111], v[76:79], v[4:7]
    ds_read_b64_tr_b16 v[158:159], v173 offset:9216
    s_add_u32 m0, s37, 47104
    s_add_u32 s32, s38, 12288
    s_add_u32 s32, s32, s37
    buffer_load_dwordx4 v176, s[16:19], s32 offen lds
    v_mfma_f32_16x16x32_bf16 v[40:43], v[112:115], v[76:79], v[40:43]
    ds_read_b128 v[116:119], v164 offset:9216
    s_add_u32 m0, s42, 34816
    s_add_u32 s32, s38, s42
    buffer_load_dwordx4 v176, s[16:19], s32 offen lds
    s_add_u32 s38, s38, 18432
    s_waitcnt lgkmcnt(11)
    v_mfma_f32_16x16x32_bf16 v[8:11], v[108:111], v[80:83], v[8:11]
    ds_read_b128 v[120:123], v164 offset:10240
    ds_read_b128 v[124:127], v164 offset:11264
    v_mfma_f32_16x16x32_bf16 v[44:47], v[112:115], v[80:83], v[44:47]
    ds_read_b128 v[128:131], v164 offset:12288
    ds_read_b128 v[132:135], v164 offset:13312
    s_waitcnt lgkmcnt(14)
    v_mfma_f32_16x16x32_bf16 v[12:15], v[108:111], v[84:87], v[12:15]
    ds_read_b128 v[136:139], v164 offset:14336
    ds_read_b128 v[140:143], v164 offset:15360
    v_mfma_f32_16x16x32_bf16 v[48:51], v[112:115], v[84:87], v[48:51]
    ds_read_b128 v[144:147], v164 offset:16384
    ds_read_b128 v[148:151], v164 offset:17408
    s_waitcnt lgkmcnt(15)
    v_mfma_f32_16x16x32_bf16 v[16:19], v[108:111], v[88:91], v[16:19]
    v_mfma_f32_16x16x32_bf16 v[52:55], v[112:115], v[88:91], v[52:55]
    v_mfma_f32_16x16x32_bf16 v[20:23], v[108:111], v[92:95], v[20:23]
    v_mfma_f32_16x16x32_bf16 v[56:59], v[112:115], v[92:95], v[56:59]
    v_mfma_f32_16x16x32_bf16 v[24:27], v[108:111], v[96:99], v[24:27]
    v_mfma_f32_16x16x32_bf16 v[60:63], v[112:115], v[96:99], v[60:63]
    s_waitcnt lgkmcnt(14)
    v_mfma_f32_16x16x32_bf16 v[28:31], v[108:111], v[100:103], v[28:31]
    v_mfma_f32_16x16x32_bf16 v[64:67], v[112:115], v[100:103], v[64:67]
    s_waitcnt lgkmcnt(13)
    v_mfma_f32_16x16x32_bf16 v[32:35], v[108:111], v[104:107], v[32:35]
    v_mfma_f32_16x16x32_bf16 v[68:71], v[112:115], v[104:107], v[68:71]
    ds_read_b64_tr_b16 v[108:109], v174
    s_add_u32 m0, s37, 53248
    s_add_u32 s32, s39, 0
    buffer_load_dwordx4 v177, s[20:23], s32 offen lds
    s_waitcnt lgkmcnt(9)
    v_mfma_f32_16x16x32_bf16 v[0:3], v[152:155], v[116:119], v[0:3]
    ds_read_b64_tr_b16 v[110:111], v174 offset:1024
    s_add_u32 m0, s37, 57344
    s_add_u32 s32, s39, 16384
    buffer_load_dwordx4 v177, s[20:23], s32 offen lds
    v_mfma_f32_16x16x32_bf16 v[36:39], v[156:159], v[116:119], v[36:39]
    ds_read_b64_tr_b16 v[112:113], v175
    s_add_u32 m0, s37, 61440
    s_add_u32 s32, s39, 32768
    buffer_load_dwordx4 v177, s[20:23], s32 offen lds
    s_waitcnt lgkmcnt(10)
    v_mfma_f32_16x16x32_bf16 v[4:7], v[152:155], v[120:123], v[4:7]
    ds_read_b64_tr_b16 v[114:115], v175 offset:1024
    s_add_u32 m0, s37, 65536
    s_add_u32 s32, s39, 49152
    buffer_load_dwordx4 v177, s[20:23], s32 offen lds
    s_add_u32 s39, s39, 65536
    v_mfma_f32_16x16x32_bf16 v[40:43], v[156:159], v[120:123], v[40:43]
    ds_read_b128 v[72:75], v166
    ds_read_b128 v[76:79], v166 offset:1024
    s_waitcnt lgkmcnt(12)
    v_mfma_f32_16x16x32_bf16 v[8:11], v[152:155], v[124:127], v[8:11]
    ds_read_b128 v[80:83], v166 offset:2048
    ds_read_b128 v[84:87], v166 offset:3072
    v_mfma_f32_16x16x32_bf16 v[44:47], v[156:159], v[124:127], v[44:47]
    ds_read_b128 v[88:91], v166 offset:4096
    ds_read_b128 v[92:95], v166 offset:5120
    s_waitcnt lgkmcnt(15)
    v_mfma_f32_16x16x32_bf16 v[12:15], v[152:155], v[128:131], v[12:15]
    ds_read_b128 v[96:99], v166 offset:6144
    ds_read_b128 v[100:103], v166 offset:7168
    v_mfma_f32_16x16x32_bf16 v[48:51], v[156:159], v[128:131], v[48:51]
    ds_read_b128 v[104:107], v166 offset:8192
    s_waitcnt lgkmcnt(15)
    v_mfma_f32_16x16x32_bf16 v[16:19], v[152:155], v[132:135], v[16:19]
    v_mfma_f32_16x16x32_bf16 v[52:55], v[156:159], v[132:135], v[52:55]
    v_mfma_f32_16x16x32_bf16 v[20:23], v[152:155], v[136:139], v[20:23]
    v_mfma_f32_16x16x32_bf16 v[56:59], v[156:159], v[136:139], v[56:59]
    v_mfma_f32_16x16x32_bf16 v[24:27], v[152:155], v[140:143], v[24:27]
    v_mfma_f32_16x16x32_bf16 v[60:63], v[156:159], v[140:143], v[60:63]
    s_waitcnt lgkmcnt(14)
    v_mfma_f32_16x16x32_bf16 v[28:31], v[152:155], v[144:147], v[28:31]
    v_mfma_f32_16x16x32_bf16 v[64:67], v[156:159], v[144:147], v[64:67]
    s_waitcnt lgkmcnt(13)
    v_mfma_f32_16x16x32_bf16 v[32:35], v[152:155], v[148:151], v[32:35]
    v_mfma_f32_16x16x32_bf16 v[68:71], v[156:159], v[148:151], v[68:71]
    s_waitcnt vmcnt(9)
    s_barrier
    ds_read_b64_tr_b16 v[152:153], v174 offset:8192
    s_add_u32 m0, s37, 69632
    s_add_u32 s32, s38, 0
    s_add_u32 s32, s32, s37
    buffer_load_dwordx4 v176, s[16:19], s32 offen lds
    s_waitcnt lgkmcnt(9)
    v_mfma_f32_16x16x32_bf16 v[0:3], v[108:111], v[72:75], v[0:3]
    ds_read_b64_tr_b16 v[154:155], v174 offset:9216
    s_add_u32 m0, s37, 73728
    s_add_u32 s32, s38, 4096
    s_add_u32 s32, s32, s37
    buffer_load_dwordx4 v176, s[16:19], s32 offen lds
    v_mfma_f32_16x16x32_bf16 v[36:39], v[112:115], v[72:75], v[36:39]
    ds_read_b64_tr_b16 v[156:157], v175 offset:8192
    s_add_u32 m0, s37, 77824
    s_add_u32 s32, s38, 8192
    s_add_u32 s32, s32, s37
    buffer_load_dwordx4 v176, s[16:19], s32 offen lds
    s_waitcnt lgkmcnt(10)
    v_mfma_f32_16x16x32_bf16 v[4:7], v[108:111], v[76:79], v[4:7]
    ds_read_b64_tr_b16 v[158:159], v175 offset:9216
    s_add_u32 m0, s37, 81920
    s_add_u32 s32, s38, 12288
    s_add_u32 s32, s32, s37
    buffer_load_dwordx4 v176, s[16:19], s32 offen lds
    v_mfma_f32_16x16x32_bf16 v[40:43], v[112:115], v[76:79], v[40:43]
    ds_read_b128 v[116:119], v166 offset:9216
    s_add_u32 m0, s42, 69632
    s_add_u32 s32, s38, s42
    buffer_load_dwordx4 v176, s[16:19], s32 offen lds
    s_add_u32 s38, s38, 18432
    s_waitcnt lgkmcnt(11)
    v_mfma_f32_16x16x32_bf16 v[8:11], v[108:111], v[80:83], v[8:11]
    ds_read_b128 v[120:123], v166 offset:10240
    ds_read_b128 v[124:127], v166 offset:11264
    v_mfma_f32_16x16x32_bf16 v[44:47], v[112:115], v[80:83], v[44:47]
    ds_read_b128 v[128:131], v166 offset:12288
    ds_read_b128 v[132:135], v166 offset:13312
    s_waitcnt lgkmcnt(14)
    v_mfma_f32_16x16x32_bf16 v[12:15], v[108:111], v[84:87], v[12:15]
    ds_read_b128 v[136:139], v166 offset:14336
    ds_read_b128 v[140:143], v166 offset:15360
    v_mfma_f32_16x16x32_bf16 v[48:51], v[112:115], v[84:87], v[48:51]
    ds_read_b128 v[144:147], v166 offset:16384
    ds_read_b128 v[148:151], v166 offset:17408
    s_waitcnt lgkmcnt(15)
    v_mfma_f32_16x16x32_bf16 v[16:19], v[108:111], v[88:91], v[16:19]
    v_mfma_f32_16x16x32_bf16 v[52:55], v[112:115], v[88:91], v[52:55]
    v_mfma_f32_16x16x32_bf16 v[20:23], v[108:111], v[92:95], v[20:23]
    v_mfma_f32_16x16x32_bf16 v[56:59], v[112:115], v[92:95], v[56:59]
    v_mfma_f32_16x16x32_bf16 v[24:27], v[108:111], v[96:99], v[24:27]
    v_mfma_f32_16x16x32_bf16 v[60:63], v[112:115], v[96:99], v[60:63]
    s_waitcnt lgkmcnt(14)
    v_mfma_f32_16x16x32_bf16 v[28:31], v[108:111], v[100:103], v[28:31]
    v_mfma_f32_16x16x32_bf16 v[64:67], v[112:115], v[100:103], v[64:67]
    s_waitcnt lgkmcnt(13)
    v_mfma_f32_16x16x32_bf16 v[32:35], v[108:111], v[104:107], v[32:35]
    v_mfma_f32_16x16x32_bf16 v[68:71], v[112:115], v[104:107], v[68:71]
    ds_read_b64_tr_b16 v[108:109], v168
    s_add_u32 m0, s37, 88064
    s_add_u32 s32, s39, 0
    buffer_load_dwordx4 v177, s[20:23], s32 offen lds
    s_waitcnt lgkmcnt(9)
    v_mfma_f32_16x16x32_bf16 v[0:3], v[152:155], v[116:119], v[0:3]
    ds_read_b64_tr_b16 v[110:111], v168 offset:1024
    s_add_u32 m0, s37, 92160
    s_add_u32 s32, s39, 16384
    buffer_load_dwordx4 v177, s[20:23], s32 offen lds
    v_mfma_f32_16x16x32_bf16 v[36:39], v[156:159], v[116:119], v[36:39]
    ds_read_b64_tr_b16 v[112:113], v169
    s_add_u32 m0, s37, 96256
    s_add_u32 s32, s39, 32768
    buffer_load_dwordx4 v177, s[20:23], s32 offen lds
    s_waitcnt lgkmcnt(10)
    v_mfma_f32_16x16x32_bf16 v[4:7], v[152:155], v[120:123], v[4:7]
    ds_read_b64_tr_b16 v[114:115], v169 offset:1024
    s_add_u32 m0, s37, 100352
    s_add_u32 s32, s39, 49152
    buffer_load_dwordx4 v177, s[20:23], s32 offen lds
    s_add_u32 s39, s39, 65536
    v_mfma_f32_16x16x32_bf16 v[40:43], v[156:159], v[120:123], v[40:43]
    ds_read_b128 v[72:75], v160
    ds_read_b128 v[76:79], v160 offset:1024
    s_waitcnt lgkmcnt(12)
    v_mfma_f32_16x16x32_bf16 v[8:11], v[152:155], v[124:127], v[8:11]
    ds_read_b128 v[80:83], v160 offset:2048
    ds_read_b128 v[84:87], v160 offset:3072
    v_mfma_f32_16x16x32_bf16 v[44:47], v[156:159], v[124:127], v[44:47]
    ds_read_b128 v[88:91], v160 offset:4096
    ds_read_b128 v[92:95], v160 offset:5120
    s_waitcnt lgkmcnt(15)
    v_mfma_f32_16x16x32_bf16 v[12:15], v[152:155], v[128:131], v[12:15]
    ds_read_b128 v[96:99], v160 offset:6144
    ds_read_b128 v[100:103], v160 offset:7168
    v_mfma_f32_16x16x32_bf16 v[48:51], v[156:159], v[128:131], v[48:51]
    ds_read_b128 v[104:107], v160 offset:8192
    s_waitcnt lgkmcnt(15)
    v_mfma_f32_16x16x32_bf16 v[16:19], v[152:155], v[132:135], v[16:19]
    v_mfma_f32_16x16x32_bf16 v[52:55], v[156:159], v[132:135], v[52:55]
    v_mfma_f32_16x16x32_bf16 v[20:23], v[152:155], v[136:139], v[20:23]
    v_mfma_f32_16x16x32_bf16 v[56:59], v[156:159], v[136:139], v[56:59]
    v_mfma_f32_16x16x32_bf16 v[24:27], v[152:155], v[140:143], v[24:27]
    v_mfma_f32_16x16x32_bf16 v[60:63], v[156:159], v[140:143], v[60:63]
    s_waitcnt lgkmcnt(14)
    v_mfma_f32_16x16x32_bf16 v[28:31], v[152:155], v[144:147], v[28:31]
    v_mfma_f32_16x16x32_bf16 v[64:67], v[156:159], v[144:147], v[64:67]
    s_waitcnt lgkmcnt(13)
    v_mfma_f32_16x16x32_bf16 v[32:35], v[152:155], v[148:151], v[32:35]
    v_mfma_f32_16x16x32_bf16 v[68:71], v[156:159], v[148:151], v[68:71]
    s_waitcnt vmcnt(9)
    s_barrier
    s_add_u32 s40, s40, 1
    s_cmp_lt_u32 s40, 4
    s_nop 3
    s_cbranch_scc1 oproj_kernel_loop
    s_waitcnt vmcnt(0) lgkmcnt(0)
    v_lshlrev_b32 v182, 4, v178
    s_mul_i32 s29, s28, 9216
    s_mul_i32 s30, s33, 36864
    s_add_u32 s30, s30, s29
    v_cvt_pk_bf16_f32 v72, v0, v1
    v_cvt_pk_bf16_f32 v73, v2, v3
    v_cvt_pk_bf16_f32 v74, v36, v37
    v_cvt_pk_bf16_f32 v75, v38, v39
    s_add_u32 s31, s30, 0
    buffer_store_dwordx4 v[72:75], v182, s[24:27], s31 offen sc0 sc1
    v_cvt_pk_bf16_f32 v76, v4, v5
    v_cvt_pk_bf16_f32 v77, v6, v7
    v_cvt_pk_bf16_f32 v78, v40, v41
    v_cvt_pk_bf16_f32 v79, v42, v43
    buffer_store_dwordx4 v[76:79], v182, s[24:27], s31 offen offset:1024 sc0 sc1
    v_cvt_pk_bf16_f32 v80, v8, v9
    v_cvt_pk_bf16_f32 v81, v10, v11
    v_cvt_pk_bf16_f32 v82, v44, v45
    v_cvt_pk_bf16_f32 v83, v46, v47
    buffer_store_dwordx4 v[80:83], v182, s[24:27], s31 offen offset:2048 sc0 sc1
    v_cvt_pk_bf16_f32 v84, v12, v13
    v_cvt_pk_bf16_f32 v85, v14, v15
    v_cvt_pk_bf16_f32 v86, v48, v49
    v_cvt_pk_bf16_f32 v87, v50, v51
    buffer_store_dwordx4 v[84:87], v182, s[24:27], s31 offen offset:3072 sc0 sc1
    v_cvt_pk_bf16_f32 v88, v16, v17
    v_cvt_pk_bf16_f32 v89, v18, v19
    v_cvt_pk_bf16_f32 v90, v52, v53
    v_cvt_pk_bf16_f32 v91, v54, v55
    s_add_u32 s31, s30, 4096
    buffer_store_dwordx4 v[88:91], v182, s[24:27], s31 offen sc0 sc1
    v_cvt_pk_bf16_f32 v92, v20, v21
    v_cvt_pk_bf16_f32 v93, v22, v23
    v_cvt_pk_bf16_f32 v94, v56, v57
    v_cvt_pk_bf16_f32 v95, v58, v59
    buffer_store_dwordx4 v[92:95], v182, s[24:27], s31 offen offset:1024 sc0 sc1
    v_cvt_pk_bf16_f32 v96, v24, v25
    v_cvt_pk_bf16_f32 v97, v26, v27
    v_cvt_pk_bf16_f32 v98, v60, v61
    v_cvt_pk_bf16_f32 v99, v62, v63
    buffer_store_dwordx4 v[96:99], v182, s[24:27], s31 offen offset:2048 sc0 sc1
    v_cvt_pk_bf16_f32 v100, v28, v29
    v_cvt_pk_bf16_f32 v101, v30, v31
    v_cvt_pk_bf16_f32 v102, v64, v65
    v_cvt_pk_bf16_f32 v103, v66, v67
    buffer_store_dwordx4 v[100:103], v182, s[24:27], s31 offen offset:3072 sc0 sc1
    v_cvt_pk_bf16_f32 v104, v32, v33
    v_cvt_pk_bf16_f32 v105, v34, v35
    v_cvt_pk_bf16_f32 v106, v68, v69
    v_cvt_pk_bf16_f32 v107, v70, v71
    s_add_u32 s31, s30, 8192
    buffer_store_dwordx4 v[104:107], v182, s[24:27], s31 offen sc0 sc1
oproj_kernel_fin:
oproj_kernel_done:
    s_endpgm
.globl reduce_kernel
.p2align 8
.type reduce_kernel,@function
reduce_kernel:
    s_cmp_ge_u32 s2, 576
    s_cbranch_scc1 reduce_kernel_done
    s_load_dwordx2 s[4:5], s[0:1], 80
    s_load_dwordx2 s[12:13], s[0:1], 96
    v_lshrrev_b32 v1, 6, v0
    s_nop 0
    v_readfirstlane_b32 s20, v1
    v_and_b32 v2, 63, v0
    v_lshrrev_b32 v3, 4, v2
    v_and_b32 v4, 15, v2
    v_lshlrev_b32 v5, 4, v2
    v_lshlrev_b32 v6, 3, v3
    v_lshl_add_u32 v6, v4, 11, v6
    s_waitcnt lgkmcnt(0)
    s_add_u32 s8, s12, 19922944
    s_addc_u32 s9, s13, 0
    s_mov_b32 s10, 9437184
    s_mov_b32 s11, 0x00020000
    s_mov_b32 s16, s4
    s_mov_b32 s17, s5
    s_mov_b32 s18, 2359296
    s_mov_b32 s19, 0x00020000
    s_mul_hi_u32 s21, s2, 477218589
    s_mul_i32 s22, s21, 9
    s_sub_u32 s22, s2, s22
    s_mul_i32 s23, s21, 147456
    s_mul_i32 s24, s20, 9216
    s_add_u32 s23, s23, s24
    s_lshl_b32 s24, s22, 10
    s_add_u32 s23, s23, s24
    s_add_u32 s25, s23, 0
    buffer_load_dwordx4 v[56:59], v5, s[8:11], s25 offen
    s_add_u32 s25, s23, 36864
    buffer_load_dwordx4 v[60:63], v5, s[8:11], s25 offen
    s_add_u32 s25, s23, 73728
    buffer_load_dwordx4 v[64:67], v5, s[8:11], s25 offen
    s_add_u32 s25, s23, 110592
    buffer_load_dwordx4 v[68:71], v5, s[8:11], s25 offen
    s_and_b32 s26, s21, 3
    s_lshr_b32 s27, s21, 2
    s_and_b32 s28, s27, 7
    s_lshr_b32 s27, s27, 3
    s_mul_i32 s29, s28, 294912
    s_lshl_b32 s27, s27, 10
    s_add_u32 s29, s29, s27
    s_lshl_b32 s26, s26, 8
    s_add_u32 s29, s29, s26
    s_lshl_b32 s26, s20, 6
    s_add_u32 s29, s29, s26
    s_lshl_b32 s26, s22, 15
    s_add_u32 s29, s29, s26
    s_waitcnt vmcnt(3)
    v_lshlrev_b32 v16, 16, v56
    v_and_b32 v17, 0xffff0000, v56
    v_lshlrev_b32 v18, 16, v57
    v_and_b32 v19, 0xffff0000, v57
    v_lshlrev_b32 v20, 16, v58
    v_and_b32 v21, 0xffff0000, v58
    v_lshlrev_b32 v22, 16, v59
    v_and_b32 v23, 0xffff0000, v59
    s_waitcnt vmcnt(2)
    v_lshlrev_b32 v24, 16, v60
    v_and_b32 v25, 0xffff0000, v60
    v_lshlrev_b32 v26, 16, v61
    v_and_b32 v27, 0xffff0000, v61
    v_lshlrev_b32 v28, 16, v62
    v_and_b32 v29, 0xffff0000, v62
    v_lshlrev_b32 v30, 16, v63
    v_and_b32 v31, 0xffff0000, v63
    s_waitcnt vmcnt(1)
    v_lshlrev_b32 v32, 16, v64
    v_and_b32 v33, 0xffff0000, v64
    v_lshlrev_b32 v34, 16, v65
    v_and_b32 v35, 0xffff0000, v65
    v_lshlrev_b32 v36, 16, v66
    v_and_b32 v37, 0xffff0000, v66
    v_lshlrev_b32 v38, 16, v67
    v_and_b32 v39, 0xffff0000, v67
    s_waitcnt vmcnt(0)
    v_lshlrev_b32 v40, 16, v68
    v_and_b32 v41, 0xffff0000, v68
    v_lshlrev_b32 v42, 16, v69
    v_and_b32 v43, 0xffff0000, v69
    v_lshlrev_b32 v44, 16, v70
    v_and_b32 v45, 0xffff0000, v70
    v_lshlrev_b32 v46, 16, v71
    v_and_b32 v47, 0xffff0000, v71
    v_add_f32 v16, v16, v24
    v_add_f32 v17, v17, v25
    v_add_f32 v18, v18, v26
    v_add_f32 v19, v19, v27
    v_add_f32 v20, v20, v28
    v_add_f32 v21, v21, v29
    v_add_f32 v22, v22, v30
    v_add_f32 v23, v23, v31
    v_add_f32 v32, v32, v40
    v_add_f32 v33, v33, v41
    v_add_f32 v34, v34, v42
    v_add_f32 v35, v35, v43
    v_add_f32 v36, v36, v44
    v_add_f32 v37, v37, v45
    v_add_f32 v38, v38, v46
    v_add_f32 v39, v39, v47
    v_add_f32 v16, v16, v32
    v_add_f32 v17, v17, v33
    v_add_f32 v18, v18, v34
    v_add_f32 v19, v19, v35
    v_add_f32 v20, v20, v36
    v_add_f32 v21, v21, v37
    v_add_f32 v22, v22, v38
    v_add_f32 v23, v23, v39
    v_cvt_pk_bf16_f32 v48, v16, v17
    v_cvt_pk_bf16_f32 v49, v18, v19
    v_cvt_pk_bf16_f32 v50, v20, v21
    v_cvt_pk_bf16_f32 v51, v22, v23
    buffer_store_dwordx2 v[48:49], v6, s[16:19], s29 offen
    buffer_store_dwordx2 v[50:51], v6, s[16:19], s29 offen offset:32
reduce_kernel_done:
    s_endpgm
.section .rodata,"a"
.p2align 6
.amdhsa_kernel attn_kernel
  .amdhsa_next_free_vgpr 500
  .amdhsa_next_free_sgpr 102
  .amdhsa_accum_offset 244
  .amdhsa_group_segment_fixed_size 0
  .amdhsa_kernarg_size 104
  .amdhsa_user_sgpr_count 2
  .amdhsa_user_sgpr_kernarg_segment_ptr 1
  .amdhsa_system_sgpr_workgroup_id_x 1
.end_amdhsa_kernel
.p2align 6
.amdhsa_kernel oproj_kernel
  .amdhsa_next_free_vgpr 186
  .amdhsa_next_free_sgpr 102
  .amdhsa_accum_offset 188
  .amdhsa_group_segment_fixed_size 0
  .amdhsa_kernarg_size 104
  .amdhsa_user_sgpr_count 2
  .amdhsa_user_sgpr_kernarg_segment_ptr 1
  .amdhsa_system_sgpr_workgroup_id_x 1
.end_amdhsa_kernel
.p2align 6
.amdhsa_kernel reduce_kernel
  .amdhsa_next_free_vgpr 72
  .amdhsa_next_free_sgpr 102
  .amdhsa_accum_offset 72
  .amdhsa_group_segment_fixed_size 0
  .amdhsa_kernarg_size 104
  .amdhsa_user_sgpr_count 2
  .amdhsa_user_sgpr_kernarg_segment_ptr 1
  .amdhsa_system_sgpr_workgroup_id_x 1
.end_amdhsa_kernel
```
